```python
import torch

def _softmax(x, axis=-1):
    return torch.softmax(x, dim=axis)
def _gelu(x):
    return torch.nn.functional.gelu(x, approximate="tanh")
def _silu(x):
    return torch.nn.functional.silu(x)
def _sigmoid(x):
    return torch.sigmoid(x)
def _layernorm(x, axis=-1, eps=1e-5):
    m = x.mean(dim=axis, keepdim=True)
    v = x.var(dim=axis, keepdim=True, unbiased=False)
    return (x - m) / torch.sqrt(v + eps)
def _scatter_add(tgt, idx, src, axis=0):
    return tgt.clone().index_add_(axis, idx, src)
def _segment_sum(src, seg, n):
    out = torch.zeros((n,) + src.shape[1:], dtype=src.dtype)
    return out.index_add_(0, seg, src)
def _pad(x, pw):
    flat = tuple(v for pair in reversed(pw) for v in pair)
    return torch.nn.functional.pad(x, flat)

kernel_name = 'concat_heads__linear_attn_block__sliding_local_dilated__prompt'

def setup_inputs():

    _w = (lambda a: (lambda t: t.to(torch.bfloat16) if t.is_floating_point() else t)(torch.as_tensor(a)))
    def _A_setup():
        B, S, D = 1, 2048, 448
        return {
            "x": _w((lambda *s: torch.randn(*s, dtype=torch.bfloat16) * 0.05)(B, S, D)),
            "wqkv": _w((lambda *s: torch.randn(*s, dtype=torch.bfloat16) * 1.6)(D, 3 * D)),
            "wo": _w((lambda *s: torch.randn(*s, dtype=torch.bfloat16) * 0.8)(D, D)),
        }
    _A_in = _A_setup()

    def _B_setup():
        B, S, D = 1, 2048, 448
        return {
            "x": _w((lambda *s: torch.randn(*s, dtype=torch.bfloat16) * 0.2)(B, S, D)),
            "wqkv": _w((lambda *s: torch.randn(*s, dtype=torch.bfloat16) * 0.2)(D, 3 * D)),
            "wo": _w((lambda *s: torch.randn(*s, dtype=torch.bfloat16) * 0.05)(D, D)),
        }
    _B_in = _B_setup()

    return {
        "A_x": _A_in["x"],
        "A_wqkv": _A_in["wqkv"],
        "A_wo": _A_in["wo"],
        "B_x": _B_in["x"],
        "B_wqkv": _B_in["wqkv"],
        "B_wo": _B_in["wo"],
    }

def reference(A_x, A_wqkv, A_wo, B_x, B_wqkv, B_wo):
    def _A_ref(x, wqkv, wo):
        B, S, D = x.shape
        H = 16; Dh = D // H
        qkv = (lambda x, *d: x.permute(*d))((x @ wqkv).reshape(B, S, 3, H, Dh), 2, 0, 3, 1, 4)
        q, k, v = qkv[0], qkv[1], qkv[2]
        phi = lambda t: torch.where(t > 0, t + 1, torch.exp(t)) + 1e-6
        pq, pk = phi(q), phi(k)
        kv = torch.einsum("bhsd,bhse->bhde", pk, v)
        z = torch.einsum("bhsd->bhd", pk)
        num = torch.einsum("bhqd,bhde->bhqe", pq, kv)
        den = torch.einsum("bhqd,bhd->bhq", pq, z)[..., None] + 1e-6
        o = num / den
        return (lambda x, *d: x.permute(*d))(o, 0, 2, 1, 3).reshape(B, S, D) @ wo

    def _B_ref(x, wqkv, wo):
        B, S, D = x.shape
        H = 16; Dh = D // H
        W, dil = 8, 2
        qkv = (lambda x, *d: x.permute(*d))((x @ wqkv).reshape(B, S, 3, H, Dh), 2, 0, 3, 1, 4)
        q, k, v = qkv[0], qkv[1], qkv[2]
        scale = Dh ** -0.5
        pos = torch.arange(S)
        off = torch.arange(W) * dil
        idx = pos[:, None] - off[None, :]
        mask = idx >= 0
        idx_c = torch.where(mask, idx, 0).reshape(-1)
        kg = k[:, :, idx_c, :].reshape(B, H, S, W, Dh)
        vg = v[:, :, idx_c, :].reshape(B, H, S, W, Dh)
        logits = torch.einsum("bhsd,bhswd->bhsw", q, kg) * scale
        logits = torch.where(mask[None, None, :, :], logits, -1e9)
        attn = _softmax(logits, axis=-1)
        o = torch.einsum("bhsw,bhswd->bhsd", attn, vg)
        return (lambda x, *d: x.permute(*d))(o, 0, 2, 1, 3).reshape(B, S, D) @ wo

    a = _A_ref(A_x, A_wqkv, A_wo)
    b = _B_ref(B_x, B_wqkv, B_wo)
    return torch.concatenate([a, b], axis=-1)
```

```asm
; @launch grid=(256,1,1) block=(512,1,1) lds=163840
.amdgcn_target "amdgcn-amd-amdhsa--gfx950"
.text
.globl concat_heads__linear_attn_block__sliding_local_dilated__prompt_kernel
.p2align 8
.type concat_heads__linear_attn_block__sliding_local_dilated__prompt_kernel,@function
concat_heads__linear_attn_block__sliding_local_dilated__prompt_kernel:
    s_cmp_ge_u32 s2, 256
    s_cbranch_scc1 K_END
    s_bfe_u32 s24, s2, 0x10002
    v_lshrrev_b32 v1, 6, v0
    s_mul_i32 s3, s24, 24
    v_readfirstlane_b32 s48, v1
    s_load_dwordx2 s[28:29], s[0:1], s3
    s_load_dwordx2 s[32:33], s[0:1], s3 offset:8
    s_load_dwordx2 s[36:37], s[0:1], s3 offset:16
    v_and_b32 v2, 63, v0
    s_bitcmp1_b32 s48, 2
    s_cbranch_scc0 C_X
    s_setprio 3
    s_branch L_X
C_X:
    s_and_b32 s3, s2, 248
    s_cbranch_scc1 CPS_1
    s_getpc_b64 s[8:9]
CPC_2:
    s_sub_u32 s8, s8, CPC_2-concat_heads__linear_attn_block__sliding_local_dilated__prompt_kernel
    s_subb_u32 s9, s9, 0
    s_and_b32 s9, s9, 0xffff
    s_mov_b32 s10, K_END-concat_heads__linear_attn_block__sliding_local_dilated__prompt_kernel
    s_mov_b32 s11, 0x20000
    s_cmp_eq_u32 s24, 0
    s_cselect_b32 s3, C_A-C_B, 0
    s_lshl_b32 s14, s48, 13
    s_add_u32 s3, s3, s14
    s_add_u32 s3, s3, C_B-concat_heads__linear_attn_block__sliding_local_dilated__prompt_kernel-8192
    s_cmp_eq_u32 s48, 0
    s_cselect_b32 s3, 0, s3
    v_lshlrev_b32 v5, 7, v2
    v_lshlrev_b32 v5, 6, v2
    s_add_u32 s15, s3, 4096
    buffer_load_dword v30, v5, s[8:11], s15 offen
    buffer_load_dword v30, v5, s[8:11], s3 offen
    s_cmp_eq_u32 s24, 0
    s_cbranch_scc0 CPS_1
    s_lshl_b32 s14, s48, 11
    s_add_u32 s3, s14, C_A-concat_heads__linear_attn_block__sliding_local_dilated__prompt_kernel+24576
    s_mov_b64 exec, 0xffffffff
    buffer_load_dword v30, v5, s[8:11], s3 offen
    s_mov_b64 exec, -1
CPS_1:
    s_cmp_eq_u32 s24, 0
    s_cbranch_scc1 C_A
    s_branch C_B
L_X:
    s_lshr_b32 s23, s2, 3
    s_and_b32 s27, s2, 3
    s_and_b32 s3, s23, 3
    s_lshl2_add_u32 s25, s27, s3
    s_lshr_b32 s26, s23, 2
    s_mul_i32 s56, s26, 112
    s_lshr_b32 s80, s23, 4
    s_lshl2_add_u32 s80, s80, s3
    s_lshl_b32 s82, s80, 2
    s_lshr_b32 s82, 0x10653210, s82
    s_and_b32 s82, s82, 7
    s_mul_i32 s81, s27, 2
    s_add_u32 s81, s81, s82
    s_mul_i32 s3, s81, 37
    s_lshr_b32 s3, s3, 8
    s_mul_i32 s3, s3, 7
    s_sub_u32 s81, s81, s3
    s_and_b32 s49, s48, 3
    v_lshrrev_b32 v3, 3, v2
    v_lshrrev_b32 v4, 4, v2
    v_and_b32 v5, 7, v2
    v_xor_b32 v5, v5, v4
    s_lshl_b32 s3, s25, 2
    s_add_u32 s3, s3, s49
    s_lshl_b32 s3, s3, 5
    v_add_u32 v6, s3, v3
    v_mul_u32_u24 v6, 896, v6
    v_lshl_add_u32 v16, v5, 4, v6
    v_xor_b32 v17, 64, v16
    v_add_u32 v17, 7168, v17
    s_lshl_b32 s51, s49, 12
    s_lshr_b32 s3, s49, 1
    s_xor_b32 s3, s3, s49
    s_mul_i32 s3, s3, 10752
    s_add_u32 s56, s56, s3
    s_mul_i32 s50, s49, 896
    s_mov_b32 s30, 0x1c0000
    s_mov_b32 s31, 0x20000
    s_mov_b32 s34, 0x126000
    s_mov_b32 s35, 0x20000
    s_mul_i32 s83, s81, 172032
    s_add_u32 s83, s83, s56
    s_lshl_b32 s85, s81, 7
    s_add_u32 s86, s85, 14336
    s_mul_i32 s4, s24, 30720
    s_add_u32 s4, s4, s51
    s_waitcnt lgkmcnt(0)
    s_and_b32 s29, s29, 0xffff
    s_and_b32 s33, s33, 0xffff
    s_add_u32 m0, s4, 14336
    s_nop 0
    buffer_load_dwordx4 v16, s[28:31], s85 offen  lds
    s_load_dwordx2 s[40:41], s[0:1], 64
    s_load_dwordx2 s[88:89], s[0:1], 48
    s_load_dwordx2 s[44:45], s[0:1], 56
    s_addk_i32 m0, 1024
    s_nop 0
    buffer_load_dwordx4 v17, s[28:31], s85 offen  lds
    s_addk_i32 m0, 1024
    s_nop 0
    buffer_load_dwordx4 v16, s[28:31], s86 offen  lds
    s_addk_i32 m0, 1024
    s_nop 0
    buffer_load_dwordx4 v17, s[28:31], s86 offen  lds
    v_mul_u32_u24 v4, 4682, v2
    v_lshrrev_b32 v4, 16, v4
    v_mul_u32_u24 v6, 14, v4
    v_sub_u32 v6, v2, v6
    v_mul_u32_u24 v4, 2688, v4
    v_cmp_lt_u32 vcc, 6, v6
    v_lshl_add_u32 v4, v6, 4, v4
    v_cndmask_b32 v6, 0, 1, vcc
    s_movk_i32 s57, 784
    s_mov_b32 s58, 85904
    v_mad_u32_u24 v8, v6, s57, v4
    v_add_u32 v8, 896, v8
    v_mad_u32_u24 v12, v6, s58, v4
    s_lshl_b32 s3, s25, 7
    s_sub_u32 s3, s3, 16
    s_max_i32 s3, s3, 0
    s_lshl2_add_u32 s3, s49, s3
    v_add_u32 v6, s3, v3
    v_mul_u32_u24 v6, 896, v6
    s_lshl_b32 s3, s49, 1
    v_xor_b32 v5, s3, v5
    v_lshl_add_u32 v18, v5, 4, v6
    s_lshl_b32 s52, s49, 9
    s_mul_i32 s5, s24, 140288
    s_add_u32 s5, s5, s50
    s_mul_i32 s6, s24, 18432
    s_add_u32 s6, s6, s51
    s_mul_i32 s7, s24, -30720
    s_add_u32 s7, s7, s50
    s_mov_b32 s8, 43008
    s_add_u32 m0, s5, 0
    s_mov_b32 exec_hi, 0xffffff
    buffer_load_dwordx4 v8, s[32:35], s83 offen  lds
    s_addk_i32 m0, 3584
    s_add_u32 s84, s83, s8
    buffer_load_dwordx4 v8, s[32:35], s84 offen  lds
    s_addk_i32 m0, 3584
    s_add_u32 s84, s84, s8
    buffer_load_dwordx4 v8, s[32:35], s84 offen  lds
    s_addk_i32 m0, 3584
    s_add_u32 s84, s84, s8
    buffer_load_dwordx4 v8, s[32:35], s84 offen  lds
    s_cmp_eq_u32 s24, 0
    s_cbranch_scc1 LX_0
    s_addk_i32 m0, 3584
    s_add_u32 s84, s83, s8
    buffer_load_dwordx4 v12, s[32:35], s83 offen  lds
    s_addk_i32 m0, 3584
    s_nop 0
    buffer_load_dwordx4 v12, s[32:35], s84 offen  lds
    s_add_u32 m0, s52, 43008
    s_mov_b32 exec_hi, 0
    buffer_load_dwordx4 v18, s[28:31], s85 offen  lds
LX_0:
    s_mov_b32 exec_hi, -1
    s_sub_u32 s81, s81, s82
    s_cselect_b32 s3, 7, 0
    s_add_u32 s81, s81, s3
    s_mov_b32 s82, 0x6325140
    s_mov_b32 s3, 0x5140362
    s_mov_b32 s57, 0x1406325
    s_mov_b32 s58, 0x3625140
    s_bitcmp1_b32 s80, 0
    s_cselect_b32 s82, 0x4236051, s82
    s_cselect_b32 s3, 0x561423, s3
    s_cselect_b32 s57, 0x514236, s57
    s_cselect_b32 s58, 0x4230561, s58
    s_bitcmp1_b32 s80, 1
    s_cselect_b32 s82, s3, s82
    s_cselect_b32 s57, s58, s57
    s_bitcmp1_b32 s80, 2
    s_cselect_b32 s82, s57, s82
    s_mul_i32 s81, s81, 0x1111111
    s_add_u32 s82, s82, s81
    s_add_u32 s3, s82, 0x1111111
    s_and_b32 s3, s3, 0x8888888
    s_lshr_b32 s3, s3, 3
    s_mul_i32 s3, s3, 7
    s_sub_u32 s82, s82, s3
    s_lshr_b32 s81, s82, 4
    s_and_b32 s3, s81, 15
    s_lshr_b32 s81, s81, 4
    s_mul_i32 s83, s3, 172032
    s_add_u32 s83, s83, s56
    s_lshl_b32 s85, s3, 7
    s_add_u32 s86, s85, 14336
    s_add_u32 m0, s6, 45056
    s_nop 0
    buffer_load_dwordx4 v16, s[28:31], s85 offen  lds
    s_addk_i32 m0, 1024
    s_nop 0
    buffer_load_dwordx4 v17, s[28:31], s85 offen  lds
    s_addk_i32 m0, 1024
    s_nop 0
    buffer_load_dwordx4 v16, s[28:31], s86 offen  lds
    s_addk_i32 m0, 1024
    s_nop 0
    buffer_load_dwordx4 v17, s[28:31], s86 offen  lds
    s_add_u32 m0, s7, 30720
    s_mov_b32 exec_hi, 0xffffff
    buffer_load_dwordx4 v8, s[32:35], s83 offen  lds
    s_addk_i32 m0, 3584
    s_add_u32 s84, s83, s8
    buffer_load_dwordx4 v8, s[32:35], s84 offen  lds
    s_addk_i32 m0, 3584
    s_add_u32 s84, s84, s8
    buffer_load_dwordx4 v8, s[32:35], s84 offen  lds
    s_addk_i32 m0, 3584
    s_add_u32 s84, s84, s8
    buffer_load_dwordx4 v8, s[32:35], s84 offen  lds
    s_cmp_eq_u32 s24, 0
    s_cbranch_scc1 LX_1
    s_addk_i32 m0, 3584
    s_add_u32 s84, s83, s8
    buffer_load_dwordx4 v12, s[32:35], s83 offen  lds
    s_addk_i32 m0, 3584
    s_nop 0
    buffer_load_dwordx4 v12, s[32:35], s84 offen  lds
    s_add_u32 m0, s52, 61440
    s_mov_b32 exec_hi, 0
    buffer_load_dwordx4 v18, s[28:31], s85 offen  lds
LX_1:
    s_mov_b32 exec_hi, -1
    s_and_b32 s22, s2, 7
    s_lshr_b32 s55, s26, 1
    s_mul_i32 s55, s55, 224
    s_getreg_b32 s92, hwreg(HW_REG_XCC_ID)
    s_and_b32 s92, s92, 15
    s_mov_b32 s70, 0x3fb8aa3b
    s_mov_b32 s71, 0x3fb8aa3b
    s_lshl_b32 s60, s24, 4
    s_add_u32 s60, s60, s25
    s_lshl_b32 s59, s60, 17
    s_lshl_b32 s60, s60, 7
    s_add_u32 s60, s60, 0x800000
    s_mov_b32 s42, 0x1c00000
    s_mov_b32 s43, 0x20000
    s_mov_b32 s38, 0x62000
    s_mov_b32 s39, 0x20000
    s_mov_b32 s46, 0x100
    s_mov_b32 s47, 0x20000
    s_mov_b32 s90, 0x380000
    s_mov_b32 s91, 0x20000
    s_waitcnt lgkmcnt(0)
    s_and_b32 s41, s41, 0xffff
    s_and_b32 s37, s37, 0xffff
    s_and_b32 s45, s45, 0xffff
    s_and_b32 s89, s89, 0xffff
    v_mov_b32 v3, 0
    buffer_load_dword v31, v3, s[40:43], s60 offen sc0 sc1
    s_cmp_eq_u32 s24, 0
    s_cbranch_scc1 L_A
L_B:
    s_setprio 0
    v_lshlrev_b32 v3, 2, v2
    v_mov_b32 v4, 0
    v_add_u32 v3, 161792, v3
    ds_write_b32 v3, v4
    s_waitcnt lgkmcnt(0)
    s_waitcnt vmcnt(12)
    s_barrier
    s_and_b32 s3, s81, 15
    s_lshr_b32 s81, s81, 4
    s_mul_i32 s83, s3, 172032
    s_add_u32 s83, s83, s56
    s_lshl_b32 s85, s3, 7
    s_add_u32 s86, s85, 14336
    s_add_u32 m0, s51, 81920
    s_nop 0
    buffer_load_dwordx4 v16, s[28:31], s85 offen  lds
    v_add_u32 v3, 0, v2
    v_mul_u32_u24 v4, 4682, v3
    v_lshrrev_b32 v4, 16, v4
    v_mul_u32_u24 v5, 14, v4
    v_sub_u32 v3, v3, v5
    v_cmp_lt_u32 vcc, 6, v3
    v_cndmask_b32 v5, 0, 1, vcc
    v_mul_u32_u24 v6, 7, v5
    v_sub_u32 v3, v3, v6
    v_min_u32 v4, 27, v4
    v_cmp_lt_u32 vcc, 13, v4
    v_cndmask_b32 v6, 0, 1, vcc
    v_mul_u32_u24 v24, 14, v6
    v_sub_u32 v4, v4, v24
    v_lshrrev_b32 v24, 2, v4
    v_and_b32 v25, 3, v4
    v_cmp_lt_u32 vcc, 10, v4
    v_cndmask_b32 v26, 0, 1, vcc
    v_mul_u32_u24 v27, 3, v26
    v_sub_u32 v27, v4, v27
    v_subrev_u32 v27, 4, v27
    v_cmp_lt_u32 vcc, 7, v4
    v_cndmask_b32 v24, v24, v26, vcc
    v_cndmask_b32 v25, v25, v27, vcc
    s_add_u32 m0, s51, 82944
    s_nop 0
    buffer_load_dwordx4 v17, s[28:31], s85 offen  lds
    v_lshl_add_u32 v24, v6, 1, v24
    v_lshl_add_u32 v4, v24, 2, v25
    v_add_u32 v26, 12, v4
    v_lshlrev_b32 v27, 2, v25
    v_add_u32 v27, 3, v27
    v_cmp_eq_u32 s[4:5], 3, v24
    v_cndmask_b32 v26, v26, v27, s[4:5]
    v_cndmask_b32 v4, v4, v26, vcc
    v_mul_u32_u24 v5, 112, v5
    v_mul_u32_u24 v4, 896, v4
    v_lshl_add_u32 v3, v3, 4, v4
    v_add3_u32 v44, s55, v3, v5
    v_add_u32 v3, 64, v2
    v_mul_u32_u24 v4, 4682, v3
    v_lshrrev_b32 v4, 16, v4
    v_mul_u32_u24 v5, 14, v4
    v_sub_u32 v3, v3, v5
    v_cmp_lt_u32 vcc, 6, v3
    v_cndmask_b32 v5, 0, 1, vcc
    v_mul_u32_u24 v6, 7, v5
    v_sub_u32 v3, v3, v6
    v_min_u32 v4, 27, v4
    v_cmp_lt_u32 vcc, 13, v4
    v_cndmask_b32 v6, 0, 1, vcc
    s_add_u32 m0, s51, 83968
    s_nop 0
    buffer_load_dwordx4 v16, s[28:31], s86 offen  lds
    v_mul_u32_u24 v24, 14, v6
    v_sub_u32 v4, v4, v24
    v_lshrrev_b32 v24, 2, v4
    v_and_b32 v25, 3, v4
    v_cmp_lt_u32 vcc, 10, v4
    v_cndmask_b32 v26, 0, 1, vcc
    v_mul_u32_u24 v27, 3, v26
    v_sub_u32 v27, v4, v27
    v_subrev_u32 v27, 4, v27
    v_cmp_lt_u32 vcc, 7, v4
    v_cndmask_b32 v24, v24, v26, vcc
    v_cndmask_b32 v25, v25, v27, vcc
    v_lshl_add_u32 v24, v6, 1, v24
    v_lshl_add_u32 v4, v24, 2, v25
    v_add_u32 v26, 12, v4
    v_lshlrev_b32 v27, 2, v25
    v_add_u32 v27, 3, v27
    v_cmp_eq_u32 s[4:5], 3, v24
    v_cndmask_b32 v26, v26, v27, s[4:5]
    v_cndmask_b32 v4, v4, v26, vcc
    v_mul_u32_u24 v5, 112, v5
    v_mul_u32_u24 v4, 896, v4
    v_lshl_add_u32 v3, v3, 4, v4
    v_add3_u32 v45, s55, v3, v5
    s_add_u32 m0, s51, 84992
    s_nop 0
    buffer_load_dwordx4 v17, s[28:31], s86 offen  lds
    v_add_u32 v3, 128, v2
    v_mul_u32_u24 v4, 4682, v3
    v_lshrrev_b32 v4, 16, v4
    v_mul_u32_u24 v5, 14, v4
    v_sub_u32 v3, v3, v5
    v_cmp_lt_u32 vcc, 6, v3
    v_cndmask_b32 v5, 0, 1, vcc
    v_mul_u32_u24 v6, 7, v5
    v_sub_u32 v3, v3, v6
    v_min_u32 v4, 27, v4
    v_cmp_lt_u32 vcc, 13, v4
    v_cndmask_b32 v6, 0, 1, vcc
    v_mul_u32_u24 v24, 14, v6
    v_sub_u32 v4, v4, v24
    v_lshrrev_b32 v24, 2, v4
    v_and_b32 v25, 3, v4
    v_cmp_lt_u32 vcc, 10, v4
    v_cndmask_b32 v26, 0, 1, vcc
    v_mul_u32_u24 v27, 3, v26
    v_sub_u32 v27, v4, v27
    v_subrev_u32 v27, 4, v27
    v_cmp_lt_u32 vcc, 7, v4
    v_cndmask_b32 v24, v24, v26, vcc
    v_cndmask_b32 v25, v25, v27, vcc
    s_mov_b32 exec_hi, 0
    s_add_u32 m0, s52, 79872
    s_nop 0
    buffer_load_dwordx4 v18, s[28:31], s85 offen  lds
    s_mov_b32 exec_hi, 0xffffff
    s_add_u32 m0, s50, 21504
    s_nop 0
    buffer_load_dwordx4 v8, s[32:35], s83 offen  lds
    s_add_u32 m0, s50, 25088
    s_add_u32 s84, s83, 43008
    buffer_load_dwordx4 v8, s[32:35], s84 offen  lds
    s_add_u32 m0, s50, 28672
    s_add_u32 s84, s83, 86016
    buffer_load_dwordx4 v8, s[32:35], s84 offen  lds
    s_add_u32 m0, s50, 32256
    s_add_u32 s84, s83, 129024
    buffer_load_dwordx4 v8, s[32:35], s84 offen  lds
    s_add_u32 m0, s50, 35840
    s_nop 0
    buffer_load_dwordx4 v12, s[32:35], s83 offen  lds
    s_add_u32 m0, s50, 39424
    s_add_u32 s84, s83, 43008
    buffer_load_dwordx4 v12, s[32:35], s84 offen  lds
    s_mov_b32 exec_hi, -1
    s_waitcnt vmcnt(12)
    s_barrier
    s_and_b32 s3, s81, 15
    s_lshr_b32 s81, s81, 4
    s_mul_i32 s83, s3, 172032
    s_add_u32 s83, s83, s56
    s_lshl_b32 s85, s3, 7
    s_add_u32 s86, s85, 14336
    s_add_u32 m0, s51, 45056
    s_nop 0
    buffer_load_dwordx4 v16, s[28:31], s85 offen  lds
    v_lshl_add_u32 v24, v6, 1, v24
    v_lshl_add_u32 v4, v24, 2, v25
    v_add_u32 v26, 12, v4
    v_lshlrev_b32 v27, 2, v25
    v_add_u32 v27, 3, v27
    v_cmp_eq_u32 s[4:5], 3, v24
    v_cndmask_b32 v26, v26, v27, s[4:5]
    v_cndmask_b32 v4, v4, v26, vcc
    v_mul_u32_u24 v5, 112, v5
    v_mul_u32_u24 v4, 896, v4
    v_lshl_add_u32 v3, v3, 4, v4
    v_add3_u32 v46, s55, v3, v5
    v_add_u32 v3, 192, v2
    v_mul_u32_u24 v4, 4682, v3
    v_lshrrev_b32 v4, 16, v4
    v_mul_u32_u24 v5, 14, v4
    v_sub_u32 v3, v3, v5
    v_cmp_lt_u32 vcc, 6, v3
    v_cndmask_b32 v5, 0, 1, vcc
    v_mul_u32_u24 v6, 7, v5
    v_sub_u32 v3, v3, v6
    v_min_u32 v4, 27, v4
    v_cmp_lt_u32 vcc, 13, v4
    v_cndmask_b32 v6, 0, 1, vcc
    s_add_u32 m0, s51, 46080
    s_nop 0
    buffer_load_dwordx4 v17, s[28:31], s85 offen  lds
    v_mul_u32_u24 v24, 14, v6
    v_sub_u32 v4, v4, v24
    v_lshrrev_b32 v24, 2, v4
    v_and_b32 v25, 3, v4
    v_cmp_lt_u32 vcc, 10, v4
    v_cndmask_b32 v26, 0, 1, vcc
    v_mul_u32_u24 v27, 3, v26
    v_sub_u32 v27, v4, v27
    v_subrev_u32 v27, 4, v27
    v_cmp_lt_u32 vcc, 7, v4
    v_cndmask_b32 v24, v24, v26, vcc
    v_cndmask_b32 v25, v25, v27, vcc
    v_lshl_add_u32 v24, v6, 1, v24
    v_lshl_add_u32 v4, v24, 2, v25
    v_add_u32 v26, 12, v4
    v_lshlrev_b32 v27, 2, v25
    v_add_u32 v27, 3, v27
    v_cmp_eq_u32 s[4:5], 3, v24
    v_cndmask_b32 v26, v26, v27, s[4:5]
    v_cndmask_b32 v4, v4, v26, vcc
    v_mul_u32_u24 v5, 112, v5
    v_mul_u32_u24 v4, 896, v4
    v_lshl_add_u32 v3, v3, 4, v4
    v_add3_u32 v47, s55, v3, v5
    s_add_u32 m0, s51, 47104
    s_nop 0
    buffer_load_dwordx4 v16, s[28:31], s86 offen  lds
    v_add_u32 v3, 256, v2
    v_mul_u32_u24 v4, 4682, v3
    v_lshrrev_b32 v4, 16, v4
    v_mul_u32_u24 v5, 14, v4
    v_sub_u32 v3, v3, v5
    v_cmp_lt_u32 vcc, 6, v3
    v_cndmask_b32 v5, 0, 1, vcc
    v_mul_u32_u24 v6, 7, v5
    v_sub_u32 v3, v3, v6
    v_min_u32 v4, 27, v4
    v_cmp_lt_u32 vcc, 13, v4
    v_cndmask_b32 v6, 0, 1, vcc
    v_mul_u32_u24 v24, 14, v6
    v_sub_u32 v4, v4, v24
    v_lshrrev_b32 v24, 2, v4
    v_and_b32 v25, 3, v4
    v_cmp_lt_u32 vcc, 10, v4
    v_cndmask_b32 v26, 0, 1, vcc
    v_mul_u32_u24 v27, 3, v26
    v_sub_u32 v27, v4, v27
    v_subrev_u32 v27, 4, v27
    v_cmp_lt_u32 vcc, 7, v4
    v_cndmask_b32 v24, v24, v26, vcc
    v_cndmask_b32 v25, v25, v27, vcc
    s_add_u32 m0, s51, 48128
    s_nop 0
    buffer_load_dwordx4 v17, s[28:31], s86 offen  lds
    v_lshl_add_u32 v24, v6, 1, v24
    v_lshl_add_u32 v4, v24, 2, v25
    v_add_u32 v26, 12, v4
    v_lshlrev_b32 v27, 2, v25
    v_add_u32 v27, 3, v27
    v_cmp_eq_u32 s[4:5], 3, v24
    v_cndmask_b32 v26, v26, v27, s[4:5]
    v_cndmask_b32 v4, v4, v26, vcc
    v_mul_u32_u24 v5, 112, v5
    v_mul_u32_u24 v4, 896, v4
    v_lshl_add_u32 v3, v3, 4, v4
    v_add3_u32 v48, s55, v3, v5
    v_add_u32 v3, 320, v2
    v_mul_u32_u24 v4, 4682, v3
    v_lshrrev_b32 v4, 16, v4
    v_mul_u32_u24 v5, 14, v4
    v_sub_u32 v3, v3, v5
    v_cmp_lt_u32 vcc, 6, v3
    v_cndmask_b32 v5, 0, 1, vcc
    v_mul_u32_u24 v6, 7, v5
    v_sub_u32 v3, v3, v6
    v_min_u32 v4, 27, v4
    v_cmp_lt_u32 vcc, 13, v4
    v_cndmask_b32 v6, 0, 1, vcc
    s_mov_b32 exec_hi, 0
    s_add_u32 m0, s52, 43008
    s_nop 0
    buffer_load_dwordx4 v18, s[28:31], s85 offen  lds
    s_mov_b32 exec_hi, 0xffffff
    s_add_u32 m0, s50, 118784
    s_nop 0
    buffer_load_dwordx4 v8, s[32:35], s83 offen  lds
    s_add_u32 m0, s50, 122368
    s_add_u32 s84, s83, 43008
    buffer_load_dwordx4 v8, s[32:35], s84 offen  lds
    s_add_u32 m0, s50, 125952
    s_add_u32 s84, s83, 86016
    buffer_load_dwordx4 v8, s[32:35], s84 offen  lds
    s_add_u32 m0, s50, 129536
    s_add_u32 s84, s83, 129024
    buffer_load_dwordx4 v8, s[32:35], s84 offen  lds
    s_add_u32 m0, s50, 133120
    s_nop 0
    buffer_load_dwordx4 v12, s[32:35], s83 offen  lds
    s_add_u32 m0, s50, 136704
    s_add_u32 s84, s83, 43008
    buffer_load_dwordx4 v12, s[32:35], s84 offen  lds
    s_mov_b32 exec_hi, -1
    s_waitcnt vmcnt(11)
    s_barrier
    v_readfirstlane_b32 s93, v31
    s_nop 3
    s_add_u32 s93, s93, 16
    s_and_b32 s61, s93, 0x7ff0
    s_or_b32 s61, s61, s92
    s_or_b32 s61, s61, 0x8000
    s_lshl_b32 s61, s61, 16
    s_and_b32 s3, s81, 15
    s_lshr_b32 s81, s81, 4
    s_mul_i32 s83, s3, 172032
    s_add_u32 s83, s83, s56
    s_lshl_b32 s85, s3, 7
    s_add_u32 s86, s85, 14336
    s_add_u32 m0, s51, 63488
    s_nop 0
    buffer_load_dwordx4 v16, s[28:31], s85 offen  lds
    v_mul_u32_u24 v24, 14, v6
    v_sub_u32 v4, v4, v24
    v_lshrrev_b32 v24, 2, v4
    v_and_b32 v25, 3, v4
    v_cmp_lt_u32 vcc, 10, v4
    v_cndmask_b32 v26, 0, 1, vcc
    v_mul_u32_u24 v27, 3, v26
    v_sub_u32 v27, v4, v27
    v_subrev_u32 v27, 4, v27
    v_cmp_lt_u32 vcc, 7, v4
    v_cndmask_b32 v24, v24, v26, vcc
    v_cndmask_b32 v25, v25, v27, vcc
    v_lshl_add_u32 v24, v6, 1, v24
    v_lshl_add_u32 v4, v24, 2, v25
    v_add_u32 v26, 12, v4
    v_lshlrev_b32 v27, 2, v25
    v_add_u32 v27, 3, v27
    v_cmp_eq_u32 s[4:5], 3, v24
    v_cndmask_b32 v26, v26, v27, s[4:5]
    v_cndmask_b32 v4, v4, v26, vcc
    v_mul_u32_u24 v5, 112, v5
    v_mul_u32_u24 v4, 896, v4
    v_lshl_add_u32 v3, v3, 4, v4
    v_add3_u32 v49, s55, v3, v5
    s_add_u32 m0, s51, 64512
    s_nop 0
    buffer_load_dwordx4 v17, s[28:31], s85 offen  lds
    v_add_u32 v3, 384, v2
    v_mul_u32_u24 v4, 4682, v3
    v_lshrrev_b32 v4, 16, v4
    v_mul_u32_u24 v5, 14, v4
    v_sub_u32 v3, v3, v5
    v_cmp_lt_u32 vcc, 6, v3
    v_cndmask_b32 v5, 0, 1, vcc
    v_mul_u32_u24 v6, 7, v5
    v_sub_u32 v3, v3, v6
    v_min_u32 v4, 27, v4
    v_cmp_lt_u32 vcc, 13, v4
    v_cndmask_b32 v6, 0, 1, vcc
    v_mul_u32_u24 v24, 14, v6
    v_sub_u32 v4, v4, v24
    v_lshrrev_b32 v24, 2, v4
    v_and_b32 v25, 3, v4
    v_cmp_lt_u32 vcc, 10, v4
    v_cndmask_b32 v26, 0, 1, vcc
    v_mul_u32_u24 v27, 3, v26
    v_sub_u32 v27, v4, v27
    v_subrev_u32 v27, 4, v27
    v_cmp_lt_u32 vcc, 7, v4
    v_cndmask_b32 v24, v24, v26, vcc
    v_cndmask_b32 v25, v25, v27, vcc
    s_add_u32 m0, s51, 65536
    s_nop 0
    buffer_load_dwordx4 v16, s[28:31], s86 offen  lds
    v_lshl_add_u32 v24, v6, 1, v24
    v_lshl_add_u32 v4, v24, 2, v25
    v_add_u32 v26, 12, v4
    v_lshlrev_b32 v27, 2, v25
    v_add_u32 v27, 3, v27
    v_cmp_eq_u32 s[4:5], 3, v24
    v_cndmask_b32 v26, v26, v27, s[4:5]
    v_cndmask_b32 v4, v4, v26, vcc
    v_mul_u32_u24 v5, 112, v5
    v_mul_u32_u24 v4, 896, v4
    v_lshl_add_u32 v3, v3, 4, v4
    v_add3_u32 v50, s55, v3, v5
    s_add_u32 m0, s51, 66560
    s_nop 0
    buffer_load_dwordx4 v17, s[28:31], s86 offen  lds
    s_mov_b32 exec_hi, 0
    s_add_u32 m0, s52, 61440
    s_nop 0
    buffer_load_dwordx4 v18, s[28:31], s85 offen  lds
    s_mov_b32 exec_hi, 0xffffff
    s_add_u32 m0, s50, 140288
    s_nop 0
    buffer_load_dwordx4 v8, s[32:35], s83 offen  lds
    s_add_u32 m0, s50, 143872
    s_add_u32 s84, s83, 43008
    buffer_load_dwordx4 v8, s[32:35], s84 offen  lds
    s_add_u32 m0, s50, 147456
    s_add_u32 s84, s83, 86016
    buffer_load_dwordx4 v8, s[32:35], s84 offen  lds
    s_add_u32 m0, s50, 151040
    s_add_u32 s84, s83, 129024
    buffer_load_dwordx4 v8, s[32:35], s84 offen  lds
    s_add_u32 m0, s50, 154624
    s_nop 0
    buffer_load_dwordx4 v12, s[32:35], s83 offen  lds
    s_add_u32 m0, s50, 158208
    s_add_u32 s84, s83, 43008
    buffer_load_dwordx4 v12, s[32:35], s84 offen  lds
    s_mov_b32 exec_hi, -1
    s_waitcnt vmcnt(11)
    s_barrier
    s_and_b32 s3, s81, 15
    s_lshr_b32 s81, s81, 4
    s_mul_i32 s83, s3, 172032
    s_add_u32 s83, s83, s56
    s_lshl_b32 s85, s3, 7
    s_add_u32 s86, s85, 14336
    s_add_u32 m0, s51, 81920
    s_nop 0
    buffer_load_dwordx4 v16, s[28:31], s85 offen  lds
    s_add_u32 m0, s51, 82944
    s_nop 0
    buffer_load_dwordx4 v17, s[28:31], s85 offen  lds
    s_add_u32 m0, s51, 83968
    s_nop 0
    buffer_load_dwordx4 v16, s[28:31], s86 offen  lds
    s_add_u32 m0, s51, 84992
    s_nop 0
    buffer_load_dwordx4 v17, s[28:31], s86 offen  lds
    s_mov_b32 exec_hi, 0
    s_add_u32 m0, s52, 79872
    s_nop 0
    buffer_load_dwordx4 v18, s[28:31], s85 offen  lds
    s_mov_b32 exec_hi, 0xffffff
    s_add_u32 m0, s50, 0
    s_nop 0
    buffer_load_dwordx4 v8, s[32:35], s83 offen  lds
    s_add_u32 m0, s50, 3584
    s_add_u32 s84, s83, 43008
    buffer_load_dwordx4 v8, s[32:35], s84 offen  lds
    s_add_u32 m0, s50, 7168
    s_add_u32 s84, s83, 86016
    buffer_load_dwordx4 v8, s[32:35], s84 offen  lds
    s_add_u32 m0, s50, 10752
    s_add_u32 s84, s83, 129024
    buffer_load_dwordx4 v8, s[32:35], s84 offen  lds
    s_add_u32 m0, s50, 14336
    s_nop 0
    buffer_load_dwordx4 v12, s[32:35], s83 offen  lds
    s_add_u32 m0, s50, 17920
    s_add_u32 s84, s83, 43008
    buffer_load_dwordx4 v12, s[32:35], s84 offen  lds
    s_mov_b32 exec_hi, -1
    s_waitcnt vmcnt(11)
    s_barrier
    s_and_b32 s3, s81, 15
    s_lshr_b32 s81, s81, 4
    s_mul_i32 s83, s3, 172032
    s_add_u32 s83, s83, s56
    s_lshl_b32 s85, s3, 7
    s_add_u32 s86, s85, 14336
    s_add_u32 m0, s51, 45056
    s_nop 0
    buffer_load_dwordx4 v16, s[28:31], s85 offen  lds
    s_add_u32 m0, s51, 46080
    s_nop 0
    buffer_load_dwordx4 v17, s[28:31], s85 offen  lds
    s_add_u32 m0, s51, 47104
    s_nop 0
    buffer_load_dwordx4 v16, s[28:31], s86 offen  lds
    s_add_u32 m0, s51, 48128
    s_nop 0
    buffer_load_dwordx4 v17, s[28:31], s86 offen  lds
    s_mov_b32 exec_hi, 0
    s_add_u32 m0, s52, 43008
    s_nop 0
    buffer_load_dwordx4 v18, s[28:31], s85 offen  lds
    s_mov_b32 exec_hi, 0xffffff
    s_add_u32 m0, s50, 21504
    s_nop 0
    buffer_load_dwordx4 v8, s[32:35], s83 offen  lds
    s_add_u32 m0, s50, 25088
    s_add_u32 s84, s83, 43008
    buffer_load_dwordx4 v8, s[32:35], s84 offen  lds
    s_add_u32 m0, s50, 28672
    s_add_u32 s84, s83, 86016
    buffer_load_dwordx4 v8, s[32:35], s84 offen  lds
    s_add_u32 m0, s50, 32256
    s_add_u32 s84, s83, 129024
    buffer_load_dwordx4 v8, s[32:35], s84 offen  lds
    s_add_u32 m0, s50, 35840
    s_nop 0
    buffer_load_dwordx4 v12, s[32:35], s83 offen  lds
    s_add_u32 m0, s50, 39424
    s_add_u32 s84, s83, 43008
    buffer_load_dwordx4 v12, s[32:35], s84 offen  lds
    s_mov_b32 exec_hi, -1
    s_waitcnt vmcnt(11)
    s_barrier
    s_lshl_b32 s3, s49, 2
    s_lshr_b32 s52, 0xa860, s3
    s_and_b32 s52, s52, 15
    s_mul_i32 s53, s52, 6272
    s_add_u32 s53, s53, 61440
    s_mul_i32 s54, s49, 50176
    s_add_u32 s54, s54, 200704
    s_add_u32 m0, s53, 0
    s_nop 0
    buffer_load_dwordx4 v44, s[36:39], s54 offen  lds
    s_add_u32 m0, s53, 1024
    s_nop 0
    buffer_load_dwordx4 v45, s[36:39], s54 offen  lds
    s_add_u32 m0, s53, 2048
    s_nop 0
    buffer_load_dwordx4 v46, s[36:39], s54 offen  lds
    s_add_u32 m0, s53, 3072
    s_nop 0
    buffer_load_dwordx4 v47, s[36:39], s54 offen  lds
    s_add_u32 m0, s53, 4096
    s_nop 0
    buffer_load_dwordx4 v48, s[36:39], s54 offen  lds
    s_add_u32 m0, s53, 5120
    s_nop 0
    buffer_load_dwordx4 v49, s[36:39], s54 offen  lds
    s_mov_b64 exec, 0xff
    s_add_u32 m0, s53, 6144
    s_nop 0
    buffer_load_dwordx4 v50, s[36:39], s54 offen  lds
    s_mov_b64 exec, -1
    s_add_u32 m0, s53, 6272
    s_add_u32 s84, s54, 25088
    buffer_load_dwordx4 v44, s[36:39], s84 offen  lds
    s_add_u32 m0, s53, 7296
    s_add_u32 s84, s54, 25088
    buffer_load_dwordx4 v45, s[36:39], s84 offen  lds
    s_add_u32 m0, s53, 8320
    s_add_u32 s84, s54, 25088
    buffer_load_dwordx4 v46, s[36:39], s84 offen  lds
    s_add_u32 m0, s53, 9344
    s_add_u32 s84, s54, 25088
    buffer_load_dwordx4 v47, s[36:39], s84 offen  lds
    s_add_u32 m0, s53, 10368
    s_add_u32 s84, s54, 25088
    buffer_load_dwordx4 v48, s[36:39], s84 offen  lds
    s_add_u32 m0, s53, 11392
    s_add_u32 s84, s54, 25088
    buffer_load_dwordx4 v49, s[36:39], s84 offen  lds
    s_mov_b64 exec, 0xff
    s_add_u32 m0, s53, 12416
    s_add_u32 s84, s54, 25088
    buffer_load_dwordx4 v50, s[36:39], s84 offen  lds
    s_mov_b64 exec, -1
    s_waitcnt vmcnt(14)
    s_barrier
    s_lshl_b32 s3, s49, 2
    s_lshr_b32 s52, 0xec42, s3
    s_and_b32 s52, s52, 15
    s_mul_i32 s53, s52, 6272
    s_add_u32 s53, s53, 61440
    s_mul_i32 s54, s49, 50176
    s_add_u32 m0, s53, 0
    s_nop 0
    buffer_load_dwordx4 v44, s[36:39], s54 offen  lds
    s_add_u32 m0, s53, 1024
    s_nop 0
    buffer_load_dwordx4 v45, s[36:39], s54 offen  lds
    s_add_u32 m0, s53, 2048
    s_nop 0
    buffer_load_dwordx4 v46, s[36:39], s54 offen  lds
    s_add_u32 m0, s53, 3072
    s_nop 0
    buffer_load_dwordx4 v47, s[36:39], s54 offen  lds
    s_add_u32 m0, s53, 4096
    s_nop 0
    buffer_load_dwordx4 v48, s[36:39], s54 offen  lds
    s_add_u32 m0, s53, 5120
    s_nop 0
    buffer_load_dwordx4 v49, s[36:39], s54 offen  lds
    s_mov_b64 exec, 0xff
    s_add_u32 m0, s53, 6144
    s_nop 0
    buffer_load_dwordx4 v50, s[36:39], s54 offen  lds
    s_mov_b64 exec, -1
    s_add_u32 m0, s53, 6272
    s_add_u32 s84, s54, 25088
    buffer_load_dwordx4 v44, s[36:39], s84 offen  lds
    s_add_u32 m0, s53, 7296
    s_add_u32 s84, s54, 25088
    buffer_load_dwordx4 v45, s[36:39], s84 offen  lds
    s_add_u32 m0, s53, 8320
    s_add_u32 s84, s54, 25088
    buffer_load_dwordx4 v46, s[36:39], s84 offen  lds
    s_add_u32 m0, s53, 9344
    s_add_u32 s84, s54, 25088
    buffer_load_dwordx4 v47, s[36:39], s84 offen  lds
    s_add_u32 m0, s53, 10368
    s_add_u32 s84, s54, 25088
    buffer_load_dwordx4 v48, s[36:39], s84 offen  lds
    s_add_u32 m0, s53, 11392
    s_add_u32 s84, s54, 25088
    buffer_load_dwordx4 v49, s[36:39], s84 offen  lds
    s_mov_b64 exec, 0xff
    s_add_u32 m0, s53, 12416
    s_add_u32 s84, s54, 25088
    buffer_load_dwordx4 v50, s[36:39], s84 offen  lds
    s_mov_b64 exec, -1
    v_lshrrev_b32 v7, 4, v2
    v_lshrrev_b32 v3, 1, v7
    v_bfe_u32 v8, v2, 2, 2
    v_mul_u32_u24 v9, 14, v3
    v_and_b32 v4, 1, v7
    v_lshl_add_u32 v6, v4, 2, v9
    v_add_u32 v6, v6, v8
    v_mul_u32_u24 v5, 3, v4
    v_min_u32 v8, 2, v8
    v_add3_u32 v9, v9, v5, v8
    v_add_u32 v9, 8, v9
    v_and_b32 v5, 3, v2
    v_lshlrev_b32 v5, 3, v5
    v_add_u32 v5, 61440, v5
    v_mul_u32_u24 v8, 224, v6
    v_add_u32 v8, v8, v5
    v_mul_u32_u24 v9, 224, v9
    v_add_u32 v9, v9, v5
    v_add_u32 v5, 37632, v8
    v_add_u32 v7, 37632, v9
    v_lshlrev_b32 v6, 4, v2
    s_and_b32 s3, s48, 3
    s_and_b32 s27, s26, 1
    s_lshl2_add_u32 s3, s27, s3
    s_lshl_b32 s27, s3, 11
    s_add_u32 s80, s59, s27
    s_add_u32 s80, s80, 0x10000
    s_add_u32 s81, s80, 16384
    s_add_u32 s82, s80, 32768
    s_add_u32 s83, s80, 49152
    s_lshl3_add_u32 s3, s25, s3
    s_mul_i32 s87, s3, 28672
    s_mul_i32 s3, s24, 896
    s_add_u32 s87, s87, s3
    s_add_u32 s87, s87, s55
    v_and_b32 v13, 15, v2
    v_lshrrev_b32 v15, 4, v2
    v_mul_u32_u24 v13, 1792, v13
    v_and_b32 v10, 1, v15
    v_lshl_add_u32 v14, v15, 3, v13
    v_lshl_add_u32 v10, v10, 5, v13
    v_lshrrev_b32 v15, 1, v15
    s_and_b32 s3, s48, 3
    v_lshl_add_u32 v10, v15, 4, v10
    s_lshl_b32 s27, s3, 3
    s_mul_i32 s3, s3, 7168
    s_add_u32 s27, s27, 161808
    s_add_u32 s3, s3, 0
    v_mov_b32 v11, s27
    v_add_u32 v12, s3, v6
    v_mov_b32 v4, 1
    s_mov_b32 s78, 0
    s_mov_b32 s79, 15
    s_mov_b32 s68, 0x10000
    v_mov_b32 v3, 161792
    s_waitcnt vmcnt(14)
    s_mov_b64 exec, 1
    ds_add_u32 v3, v4
    s_mov_b64 exec, -1
SP_3:
    ds_read_b32 v13, v3 offset:0
    s_waitcnt lgkmcnt(0)
    v_readfirstlane_b32 s3, v13
    s_nop 3
    s_cmp_eq_u32 s3, 8
    s_cbranch_scc1 SD_4
    s_sleep 1
    s_branch SP_3
SD_4:
    s_branch P2_BL
L_A:
    v_mov_b32 v4, 0
    v_mov_b32 v5, 0
    v_mov_b32 v6, 0
    v_mov_b32 v7, 0
    s_cmp_eq_u32 s25, 0
    s_cbranch_scc0 ZS_5
    s_lshl2_add_u32 s3, s26, s49
    s_mul_i32 s3, s3, 1024
    s_add_u32 s3, s3, 0xa00000
    v_lshlrev_b32 v3, 4, v2
    buffer_store_dwordx4 v[4:7], v3, s[40:43], s3 offen sc0 sc1
ZS_5:
    v_lshlrev_b32 v3, 2, v2
    v_mov_b32 v4, 0
    v_add_u32 v3, 161792, v3
    ds_write_b32 v3, v4
    s_waitcnt lgkmcnt(0)
    s_setprio 0
    s_waitcnt vmcnt(9)
    s_barrier
    s_and_b32 s3, s81, 15
    s_lshr_b32 s81, s81, 4
    s_mul_i32 s83, s3, 172032
    s_add_u32 s83, s83, s56
    s_lshl_b32 s85, s3, 7
    s_add_u32 s86, s85, 14336
    s_add_u32 m0, s51, 75776
    s_nop 0
    buffer_load_dwordx4 v16, s[28:31], s85 offen  lds
    v_add_u32 v3, 0, v2
    v_mul_u32_u24 v4, 4682, v3
    v_lshrrev_b32 v4, 16, v4
    v_mul_u32_u24 v5, 14, v4
    v_sub_u32 v3, v3, v5
    v_cmp_lt_u32 vcc, 6, v3
    v_cndmask_b32 v5, 0, 1, vcc
    v_mul_u32_u24 v6, 7, v5
    v_sub_u32 v3, v3, v6
    v_min_u32 v4, 27, v4
    v_cmp_lt_u32 vcc, 13, v4
    v_cndmask_b32 v6, 0, 1, vcc
    v_mul_u32_u24 v24, 14, v6
    v_sub_u32 v4, v4, v24
    v_lshrrev_b32 v24, 2, v4
    v_and_b32 v25, 3, v4
    v_cmp_lt_u32 vcc, 10, v4
    v_cndmask_b32 v26, 0, 1, vcc
    v_mul_u32_u24 v27, 3, v26
    v_sub_u32 v27, v4, v27
    v_subrev_u32 v27, 4, v27
    v_cmp_lt_u32 vcc, 7, v4
    v_cndmask_b32 v24, v24, v26, vcc
    v_cndmask_b32 v25, v25, v27, vcc
    s_add_u32 m0, s51, 76800
    s_nop 0
    buffer_load_dwordx4 v17, s[28:31], s85 offen  lds
    v_lshl_add_u32 v24, v6, 1, v24
    v_mul_u32_u24 v24, 7, v24
    v_add_u32 v4, v24, v25
    v_mul_u32_u24 v5, 112, v5
    v_mul_u32_u24 v4, 896, v4
    v_lshl_add_u32 v3, v3, 4, v4
    v_add3_u32 v44, s55, v3, v5
    v_add_u32 v3, 64, v2
    v_mul_u32_u24 v4, 4682, v3
    v_lshrrev_b32 v4, 16, v4
    v_mul_u32_u24 v5, 14, v4
    v_sub_u32 v3, v3, v5
    v_cmp_lt_u32 vcc, 6, v3
    v_cndmask_b32 v5, 0, 1, vcc
    v_mul_u32_u24 v6, 7, v5
    v_sub_u32 v3, v3, v6
    v_min_u32 v4, 27, v4
    v_cmp_lt_u32 vcc, 13, v4
    v_cndmask_b32 v6, 0, 1, vcc
    v_mul_u32_u24 v24, 14, v6
    v_sub_u32 v4, v4, v24
    v_lshrrev_b32 v24, 2, v4
    v_and_b32 v25, 3, v4
    v_cmp_lt_u32 vcc, 10, v4
    s_add_u32 m0, s51, 77824
    s_nop 0
    buffer_load_dwordx4 v16, s[28:31], s86 offen  lds
    v_cndmask_b32 v26, 0, 1, vcc
    v_mul_u32_u24 v27, 3, v26
    v_sub_u32 v27, v4, v27
    v_subrev_u32 v27, 4, v27
    v_cmp_lt_u32 vcc, 7, v4
    v_cndmask_b32 v24, v24, v26, vcc
    v_cndmask_b32 v25, v25, v27, vcc
    v_lshl_add_u32 v24, v6, 1, v24
    v_mul_u32_u24 v24, 7, v24
    v_add_u32 v4, v24, v25
    v_mul_u32_u24 v5, 112, v5
    v_mul_u32_u24 v4, 896, v4
    v_lshl_add_u32 v3, v3, 4, v4
    v_add3_u32 v45, s55, v3, v5
    v_add_u32 v3, 128, v2
    v_mul_u32_u24 v4, 4682, v3
    v_lshrrev_b32 v4, 16, v4
    v_mul_u32_u24 v5, 14, v4
    v_sub_u32 v3, v3, v5
    v_cmp_lt_u32 vcc, 6, v3
    v_cndmask_b32 v5, 0, 1, vcc
    v_mul_u32_u24 v6, 7, v5
    v_sub_u32 v3, v3, v6
    v_min_u32 v4, 27, v4
    s_add_u32 m0, s51, 78848
    s_nop 0
    buffer_load_dwordx4 v17, s[28:31], s86 offen  lds
    v_cmp_lt_u32 vcc, 13, v4
    v_cndmask_b32 v6, 0, 1, vcc
    v_mul_u32_u24 v24, 14, v6
    v_sub_u32 v4, v4, v24
    v_lshrrev_b32 v24, 2, v4
    v_and_b32 v25, 3, v4
    v_cmp_lt_u32 vcc, 10, v4
    v_cndmask_b32 v26, 0, 1, vcc
    v_mul_u32_u24 v27, 3, v26
    v_sub_u32 v27, v4, v27
    v_subrev_u32 v27, 4, v27
    v_cmp_lt_u32 vcc, 7, v4
    v_cndmask_b32 v24, v24, v26, vcc
    v_cndmask_b32 v25, v25, v27, vcc
    v_lshl_add_u32 v24, v6, 1, v24
    v_mul_u32_u24 v24, 7, v24
    v_add_u32 v4, v24, v25
    v_mul_u32_u24 v5, 112, v5
    v_mul_u32_u24 v4, 896, v4
    v_lshl_add_u32 v3, v3, 4, v4
    v_add3_u32 v46, s55, v3, v5
    v_add_u32 v3, 192, v2
    v_mul_u32_u24 v4, 4682, v3
    v_lshrrev_b32 v4, 16, v4
    s_mov_b32 exec_hi, 0xffffff
    s_add_u32 m0, s50, 61440
    s_nop 0
    buffer_load_dwordx4 v8, s[32:35], s83 offen  lds
    s_add_u32 m0, s50, 65024
    s_add_u32 s84, s83, 43008
    buffer_load_dwordx4 v8, s[32:35], s84 offen  lds
    s_add_u32 m0, s50, 68608
    s_add_u32 s84, s83, 86016
    buffer_load_dwordx4 v8, s[32:35], s84 offen  lds
    s_add_u32 m0, s50, 72192
    s_add_u32 s84, s83, 129024
    buffer_load_dwordx4 v8, s[32:35], s84 offen  lds
    s_mov_b32 exec_hi, -1
    s_waitcnt vmcnt(9)
    s_barrier
    s_and_b32 s3, s81, 15
    s_lshr_b32 s81, s81, 4
    s_mul_i32 s83, s3, 172032
    s_add_u32 s83, s83, s56
    s_lshl_b32 s85, s3, 7
    s_add_u32 s86, s85, 14336
    s_add_u32 m0, s51, 106496
    s_nop 0
    buffer_load_dwordx4 v16, s[28:31], s85 offen  lds
    v_mul_u32_u24 v5, 14, v4
    v_sub_u32 v3, v3, v5
    v_cmp_lt_u32 vcc, 6, v3
    v_cndmask_b32 v5, 0, 1, vcc
    v_mul_u32_u24 v6, 7, v5
    v_sub_u32 v3, v3, v6
    v_min_u32 v4, 27, v4
    v_cmp_lt_u32 vcc, 13, v4
    v_cndmask_b32 v6, 0, 1, vcc
    v_mul_u32_u24 v24, 14, v6
    v_sub_u32 v4, v4, v24
    v_lshrrev_b32 v24, 2, v4
    v_and_b32 v25, 3, v4
    v_cmp_lt_u32 vcc, 10, v4
    v_cndmask_b32 v26, 0, 1, vcc
    v_mul_u32_u24 v27, 3, v26
    v_sub_u32 v27, v4, v27
    v_subrev_u32 v27, 4, v27
    v_cmp_lt_u32 vcc, 7, v4
    v_cndmask_b32 v24, v24, v26, vcc
    v_cndmask_b32 v25, v25, v27, vcc
    v_lshl_add_u32 v24, v6, 1, v24
    v_mul_u32_u24 v24, 7, v24
    v_add_u32 v4, v24, v25
    s_add_u32 m0, s51, 107520
    s_nop 0
    buffer_load_dwordx4 v17, s[28:31], s85 offen  lds
    v_mul_u32_u24 v5, 112, v5
    v_mul_u32_u24 v4, 896, v4
    v_lshl_add_u32 v3, v3, 4, v4
    v_add3_u32 v47, s55, v3, v5
    v_add_u32 v3, 256, v2
    v_mul_u32_u24 v4, 4682, v3
    v_lshrrev_b32 v4, 16, v4
    v_mul_u32_u24 v5, 14, v4
    v_sub_u32 v3, v3, v5
    v_cmp_lt_u32 vcc, 6, v3
    v_cndmask_b32 v5, 0, 1, vcc
    v_mul_u32_u24 v6, 7, v5
    v_sub_u32 v3, v3, v6
    v_min_u32 v4, 27, v4
    v_cmp_lt_u32 vcc, 13, v4
    v_cndmask_b32 v6, 0, 1, vcc
    v_mul_u32_u24 v24, 14, v6
    v_sub_u32 v4, v4, v24
    v_lshrrev_b32 v24, 2, v4
    v_and_b32 v25, 3, v4
    v_cmp_lt_u32 vcc, 10, v4
    v_cndmask_b32 v26, 0, 1, vcc
    v_mul_u32_u24 v27, 3, v26
    v_sub_u32 v27, v4, v27
    s_add_u32 m0, s51, 108544
    s_nop 0
    buffer_load_dwordx4 v16, s[28:31], s86 offen  lds
    v_subrev_u32 v27, 4, v27
    v_cmp_lt_u32 vcc, 7, v4
    v_cndmask_b32 v24, v24, v26, vcc
    v_cndmask_b32 v25, v25, v27, vcc
    v_lshl_add_u32 v24, v6, 1, v24
    v_mul_u32_u24 v24, 7, v24
    v_add_u32 v4, v24, v25
    v_mul_u32_u24 v5, 112, v5
    v_mul_u32_u24 v4, 896, v4
    v_lshl_add_u32 v3, v3, 4, v4
    v_add3_u32 v48, s55, v3, v5
    v_add_u32 v3, 320, v2
    v_mul_u32_u24 v4, 4682, v3
    v_lshrrev_b32 v4, 16, v4
    v_mul_u32_u24 v5, 14, v4
    v_sub_u32 v3, v3, v5
    v_cmp_lt_u32 vcc, 6, v3
    v_cndmask_b32 v5, 0, 1, vcc
    v_mul_u32_u24 v6, 7, v5
    v_sub_u32 v3, v3, v6
    v_min_u32 v4, 27, v4
    v_cmp_lt_u32 vcc, 13, v4
    v_cndmask_b32 v6, 0, 1, vcc
    v_mul_u32_u24 v24, 14, v6
    s_add_u32 m0, s51, 109568
    s_nop 0
    buffer_load_dwordx4 v17, s[28:31], s86 offen  lds
    v_sub_u32 v4, v4, v24
    v_lshrrev_b32 v24, 2, v4
    v_and_b32 v25, 3, v4
    v_cmp_lt_u32 vcc, 10, v4
    v_cndmask_b32 v26, 0, 1, vcc
    v_mul_u32_u24 v27, 3, v26
    v_sub_u32 v27, v4, v27
    v_subrev_u32 v27, 4, v27
    v_cmp_lt_u32 vcc, 7, v4
    v_cndmask_b32 v24, v24, v26, vcc
    v_cndmask_b32 v25, v25, v27, vcc
    v_lshl_add_u32 v24, v6, 1, v24
    v_mul_u32_u24 v24, 7, v24
    v_add_u32 v4, v24, v25
    v_mul_u32_u24 v5, 112, v5
    v_mul_u32_u24 v4, 896, v4
    v_lshl_add_u32 v3, v3, 4, v4
    v_add3_u32 v49, s55, v3, v5
    v_add_u32 v3, 384, v2
    v_mul_u32_u24 v4, 4682, v3
    v_lshrrev_b32 v4, 16, v4
    v_mul_u32_u24 v5, 14, v4
    v_sub_u32 v3, v3, v5
    v_cmp_lt_u32 vcc, 6, v3
    s_mov_b32 exec_hi, 0xffffff
    s_add_u32 m0, s50, 92160
    s_nop 0
    buffer_load_dwordx4 v8, s[32:35], s83 offen  lds
    s_add_u32 m0, s50, 95744
    s_add_u32 s84, s83, 43008
    buffer_load_dwordx4 v8, s[32:35], s84 offen  lds
    s_add_u32 m0, s50, 99328
    s_add_u32 s84, s83, 86016
    buffer_load_dwordx4 v8, s[32:35], s84 offen  lds
    s_add_u32 m0, s50, 102912
    s_add_u32 s84, s83, 129024
    buffer_load_dwordx4 v8, s[32:35], s84 offen  lds
    s_mov_b32 exec_hi, -1
    s_waitcnt vmcnt(8)
    s_barrier
    s_and_b32 s3, s81, 15
    s_lshr_b32 s81, s81, 4
    s_mul_i32 s83, s3, 172032
    s_add_u32 s83, s83, s56
    s_lshl_b32 s85, s3, 7
    s_add_u32 s86, s85, 14336
    s_add_u32 m0, s51, 137216
    s_nop 0
    buffer_load_dwordx4 v16, s[28:31], s85 offen  lds
    v_cndmask_b32 v5, 0, 1, vcc
    v_mul_u32_u24 v6, 7, v5
    v_sub_u32 v3, v3, v6
    v_min_u32 v4, 27, v4
    v_cmp_lt_u32 vcc, 13, v4
    v_cndmask_b32 v6, 0, 1, vcc
    v_mul_u32_u24 v24, 14, v6
    v_sub_u32 v4, v4, v24
    v_lshrrev_b32 v24, 2, v4
    v_and_b32 v25, 3, v4
    v_cmp_lt_u32 vcc, 10, v4
    v_cndmask_b32 v26, 0, 1, vcc
    v_mul_u32_u24 v27, 3, v26
    v_sub_u32 v27, v4, v27
    v_subrev_u32 v27, 4, v27
    v_cmp_lt_u32 vcc, 7, v4
    v_cndmask_b32 v24, v24, v26, vcc
    v_cndmask_b32 v25, v25, v27, vcc
    v_lshl_add_u32 v24, v6, 1, v24
    v_mul_u32_u24 v24, 7, v24
    v_add_u32 v4, v24, v25
    v_mul_u32_u24 v5, 112, v5
    v_mul_u32_u24 v4, 896, v4
    v_lshl_add_u32 v3, v3, 4, v4
    s_add_u32 m0, s51, 138240
    s_nop 0
    buffer_load_dwordx4 v17, s[28:31], s85 offen  lds
    v_add3_u32 v50, s55, v3, v5
    s_add_u32 m0, s51, 139264
    s_nop 0
    buffer_load_dwordx4 v16, s[28:31], s86 offen  lds
    s_add_u32 m0, s51, 140288
    s_nop 0
    buffer_load_dwordx4 v17, s[28:31], s86 offen  lds
    s_mov_b32 exec_hi, 0xffffff
    s_add_u32 m0, s50, 122880
    s_nop 0
    buffer_load_dwordx4 v8, s[32:35], s83 offen  lds
    s_add_u32 m0, s50, 126464
    s_add_u32 s84, s83, 43008
    buffer_load_dwordx4 v8, s[32:35], s84 offen  lds
    s_add_u32 m0, s50, 130048
    s_add_u32 s84, s83, 86016
    buffer_load_dwordx4 v8, s[32:35], s84 offen  lds
    s_add_u32 m0, s50, 133632
    s_add_u32 s84, s83, 129024
    buffer_load_dwordx4 v8, s[32:35], s84 offen  lds
    s_mov_b32 exec_hi, -1
    s_waitcnt vmcnt(8)
    s_barrier
    v_readfirstlane_b32 s93, v31
    s_nop 3
    s_add_u32 s93, s93, 16
    s_and_b32 s61, s93, 0x7ff0
    s_or_b32 s61, s61, s92
    s_or_b32 s61, s61, 0x8000
    s_lshl_b32 s61, s61, 16
    s_or_b32 s3, s25, s49
    s_cbranch_scc1 ZF_6
    s_lshl_b32 s3, s26, 2
    v_mov_b32 v22, 160
    v_mov_b32 v23, 1
    s_mov_b64 exec, 1
    buffer_store_dword v23, v22, s[44:47], s3 offen sc0 sc1
    s_mov_b64 exec, -1
ZF_6:
    s_and_b32 s3, s81, 15
    s_lshr_b32 s81, s81, 4
    s_mul_i32 s83, s3, 172032
    s_add_u32 s83, s83, s56
    s_lshl_b32 s85, s3, 7
    s_add_u32 s86, s85, 14336
    s_add_u32 m0, s51, 14336
    s_nop 0
    buffer_load_dwordx4 v16, s[28:31], s85 offen  lds
    s_add_u32 m0, s51, 15360
    s_nop 0
    buffer_load_dwordx4 v17, s[28:31], s85 offen  lds
    s_add_u32 m0, s51, 16384
    s_nop 0
    buffer_load_dwordx4 v16, s[28:31], s86 offen  lds
    s_add_u32 m0, s51, 17408
    s_nop 0
    buffer_load_dwordx4 v17, s[28:31], s86 offen  lds
    s_mov_b32 exec_hi, 0xffffff
    s_add_u32 m0, s50, 0
    s_nop 0
    buffer_load_dwordx4 v8, s[32:35], s83 offen  lds
    s_add_u32 m0, s50, 3584
    s_add_u32 s84, s83, 43008
    buffer_load_dwordx4 v8, s[32:35], s84 offen  lds
    s_add_u32 m0, s50, 7168
    s_add_u32 s84, s83, 86016
    buffer_load_dwordx4 v8, s[32:35], s84 offen  lds
    s_add_u32 m0, s50, 10752
    s_add_u32 s84, s83, 129024
    buffer_load_dwordx4 v8, s[32:35], s84 offen  lds
    s_mov_b32 exec_hi, -1
    s_waitcnt vmcnt(8)
    s_barrier
    s_and_b32 s3, s81, 15
    s_lshr_b32 s81, s81, 4
    s_mul_i32 s83, s3, 172032
    s_add_u32 s83, s83, s56
    s_lshl_b32 s85, s3, 7
    s_add_u32 s86, s85, 14336
    s_add_u32 m0, s51, 45056
    s_nop 0
    buffer_load_dwordx4 v16, s[28:31], s85 offen  lds
    s_add_u32 m0, s51, 46080
    s_nop 0
    buffer_load_dwordx4 v17, s[28:31], s85 offen  lds
    s_add_u32 m0, s51, 47104
    s_nop 0
    buffer_load_dwordx4 v16, s[28:31], s86 offen  lds
    s_add_u32 m0, s51, 48128
    s_nop 0
    buffer_load_dwordx4 v17, s[28:31], s86 offen  lds
    s_mov_b32 exec_hi, 0xffffff
    s_add_u32 m0, s50, 30720
    s_nop 0
    buffer_load_dwordx4 v8, s[32:35], s83 offen  lds
    s_add_u32 m0, s50, 34304
    s_add_u32 s84, s83, 43008
    buffer_load_dwordx4 v8, s[32:35], s84 offen  lds
    s_add_u32 m0, s50, 37888
    s_add_u32 s84, s83, 86016
    buffer_load_dwordx4 v8, s[32:35], s84 offen  lds
    s_add_u32 m0, s50, 41472
    s_add_u32 s84, s83, 129024
    buffer_load_dwordx4 v8, s[32:35], s84 offen  lds
    s_mov_b32 exec_hi, -1
    v_mov_b32 v53, v12
    s_bitcmp1_b32 s49, 1
    s_cbranch_scc1 T_AY
    s_bitcmp1_b32 s49, 0
    s_cbranch_scc1 T_A1
    s_branch T_A0
T_AY:
    s_bitcmp1_b32 s49, 0
    s_cbranch_scc1 T_A3
    s_branch T_A2
C_B:
    s_load_dwordx2 s[40:41], s[0:1], 64
    s_load_dwordx2 s[88:89], s[0:1], 48
    s_load_dwordx2 s[44:45], s[0:1], 56
    s_lshr_b32 s23, s2, 3
    s_and_b32 s27, s2, 3
    s_and_b32 s3, s23, 3
    s_lshl2_add_u32 s25, s27, s3
    s_lshr_b32 s26, s23, 2
    s_mul_i32 s56, s26, 112
    s_lshr_b32 s80, s23, 4
    s_lshl2_add_u32 s80, s80, s3
    s_lshl_b32 s82, s80, 2
    s_lshr_b32 s82, 0x10653210, s82
    s_and_b32 s82, s82, 7
    s_mul_i32 s81, s27, 2
    s_add_u32 s81, s81, s82
    s_mul_i32 s3, s81, 37
    s_lshr_b32 s3, s3, 8
    s_mul_i32 s3, s3, 7
    s_sub_u32 s81, s81, s3
    s_and_b32 s22, s2, 7
    s_lshr_b32 s55, s26, 1
    s_mul_i32 s55, s55, 224
    s_getreg_b32 s92, hwreg(HW_REG_XCC_ID)
    s_and_b32 s92, s92, 15
    s_mov_b32 s70, 0x3fb8aa3b
    s_mov_b32 s71, 0x3fb8aa3b
    s_lshl_b32 s60, s24, 4
    s_add_u32 s60, s60, s25
    s_lshl_b32 s59, s60, 17
    s_lshl_b32 s60, s60, 7
    s_add_u32 s60, s60, 0x800000
    s_and_b32 s3, s48, 3
    s_and_b32 s27, s26, 1
    s_lshl2_add_u32 s3, s27, s3
    s_lshl_b32 s27, s3, 11
    s_add_u32 s80, s59, s27
    s_add_u32 s81, s80, 16384
    s_add_u32 s82, s80, 32768
    s_add_u32 s83, s80, 49152
    s_lshl3_add_u32 s3, s25, s3
    s_mul_i32 s87, s3, 28672
    s_mul_i32 s3, s24, 896
    s_add_u32 s87, s87, s3
    s_add_u32 s87, s87, s55
    v_lshrrev_b32 v7, 4, v2
    v_lshrrev_b32 v3, 1, v7
    v_bfe_u32 v8, v2, 2, 2
    v_mul_u32_u24 v9, 14, v3
    v_and_b32 v4, 1, v7
    v_lshl_add_u32 v6, v4, 2, v9
    v_add_u32 v6, v6, v8
    v_mul_u32_u24 v5, 3, v4
    v_min_u32 v8, 2, v8
    v_add3_u32 v9, v9, v5, v8
    v_add_u32 v9, 8, v9
    v_and_b32 v5, 3, v2
    v_lshlrev_b32 v5, 3, v5
    v_add_u32 v5, 73984, v5
    v_mul_u32_u24 v8, 224, v6
    v_add_u32 v8, v8, v5
    v_mul_u32_u24 v9, 224, v9
    v_add_u32 v9, v9, v5
    v_lshrrev_b32 v3, 4, v2
    v_bfe_u32 v4, v2, 2, 2
    v_lshl_add_u32 v4, v3, 3, v4
    v_and_b32 v5, 1, v3
    v_lshlrev_b32 v5, 2, v5
    v_add_u32 v6, v4, v5
    v_xor_b32 v7, 4, v6
    v_mul_u32_u24 v6, 224, v6
    v_mul_u32_u24 v7, 224, v7
    v_and_b32 v5, 3, v2
    v_lshl_add_u32 v14, v5, 3, v6
    v_lshl_add_u32 v15, v5, 3, v7
    s_and_b32 s49, s48, 1
    s_lshr_b32 s50, s48, 1
    s_mul_i32 s3, s49, 56
    v_add_u32 v12, s3, v14
    v_add_u32 v13, s3, v15
    v_and_b32 v4, 15, v2
    v_lshrrev_b32 v5, 1, v4
    v_xor_b32 v5, v5, v3
    v_lshlrev_b32 v5, 4, v5
    v_lshl_add_u32 v18, v4, 7, v5
    s_lshl_b32 s3, s50, 13
    v_add_u32 v16, s3, v18
    v_xor_b32 v17, 64, v16
    s_lshl_b32 s3, s23, 2
    s_add_u32 s3, s3, s48
    s_and_b32 s27, s3, 63
    s_lshl_b32 s3, s3, 6
    v_add_u32 v4, s3, v2
    v_min_u32 v4, 6271, v4
    v_lshlrev_b32 v11, 6, v4
    v_mov_b32 v6, 161792
    v_mov_b32 v7, 1
    s_mov_b32 s30, 0x1c0000
    s_mov_b32 s31, 0x20000
    s_mov_b32 s34, 0x126000
    s_mov_b32 s35, 0x20000
    s_mov_b32 s42, 0x1c00000
    s_mov_b32 s43, 0x20000
    s_mov_b32 s38, 0x62000
    s_mov_b32 s39, 0x20000
    s_mov_b32 s46, 0x100
    s_mov_b32 s47, 0x20000
    s_mov_b32 s90, 0x380000
    s_mov_b32 s91, 0x20000
    s_waitcnt lgkmcnt(0)
    s_and_b32 s41, s41, 0xffff
    s_and_b32 s37, s37, 0xffff
    s_and_b32 s45, s45, 0xffff
    s_and_b32 s89, s89, 0xffff
    s_waitcnt lgkmcnt(0)
    s_and_b32 s29, s29, 0xffff
    s_and_b32 s33, s33, 0xffff
    v_mov_b32 v3, 0
    buffer_load_dword v31, v3, s[40:43], s60 offen sc0 sc1
    s_mul_i32 s3, s25, 229376
    s_mul_i32 s27, s24, 896
    s_add_u32 s3, s3, s27
    buffer_load_dword v30, v3, s[88:91], s3 offen
    buffer_load_dword v30, v3, s[36:39], s55 offen
    buffer_load_dword v30, v3, s[40:43], s59 offen
    s_and_b32 s3, s23, 3
    s_lshl_b32 s3, s3, 2
    s_lshr_b32 s3, 0x546, s3
    s_and_b32 s3, s3, 7
    s_and_b32 s27, s2, 3
    s_lshl1_add_u32 s3, s27, s3
    s_cmp_ge_u32 s3, 7
    s_cselect_b32 s27, 7, 0
    s_sub_u32 s3, s3, s27
    s_lshl_b32 s3, s3, 7
    s_lshl_b32 s27, s25, 7
    s_sub_u32 s27, s27, 16
    s_max_i32 s27, s27, 0
    s_mul_i32 s27, s27, 896
    s_add_u32 s3, s3, s27
    s_lshl2_add_u32 s27, s26, s48
    s_mul_i32 s27, s27, 9
    v_min_u32 v24, 8, v2
    v_add_u32 v24, s27, v24
    v_lshrrev_b32 v25, 1, v24
    v_and_b32 v24, 1, v24
    v_mul_u32_u24 v25, 896, v25
    v_lshl_add_u32 v24, v24, 6, v25
    s_mov_b32 s30, 0x1c0000
    s_mov_b32 s31, 0x20000
    buffer_load_dword v30, v24, s[28:31], s3 offen
    s_barrier
    v_add_u32 v24, 43008, v16
    v_add_u32 v25, 43008, v17
    v_add_u32 v20, 140288, v12
    v_add_u32 v21, 140288, v13
    ds_read_b128 a[52:55], v24 offset:2048
    ds_read_b128 a[56:59], v24 offset:4096
    ds_read_b128 a[60:63], v24 offset:6144
    ds_read_b128 a[64:67], v24 offset:8192
    ds_read_b128 a[48:51], v24 offset:0
    ds_read_b64_tr_b16 a[0:1], v20 offset:14336
    ds_read_b64_tr_b16 a[2:3], v21 offset:14336
    ds_read_b64_tr_b16 a[4:5], v20 offset:14368
    ds_read_b64_tr_b16 a[6:7], v21 offset:14368
    s_waitcnt lgkmcnt(2)
    v_mfma_f32_16x16x32_bf16 v[32:35], a[0:3], a[52:55], 0
    ds_read_b64_tr_b16 a[8:9], v20 offset:0
    ds_read_b64_tr_b16 a[10:11], v21 offset:0
    v_mfma_f32_16x16x32_bf16 v[40:43], a[0:3], a[56:59], 0
    ds_read_b64_tr_b16 a[12:13], v20 offset:32
    v_mfma_f32_16x16x32_bf16 v[48:51], a[0:3], a[60:63], 0
    ds_read_b64_tr_b16 a[14:15], v21 offset:32
    v_mfma_f32_16x16x32_bf16 v[56:59], a[0:3], a[64:67], 0
    ds_read_b64_tr_b16 a[16:17], v20 offset:112
    s_waitcnt lgkmcnt(5)
    v_mfma_f32_16x16x32_bf16 v[36:39], a[4:7], a[52:55], 0
    ds_read_b64_tr_b16 a[18:19], v21 offset:112
    v_mfma_f32_16x16x32_bf16 v[44:47], a[4:7], a[56:59], 0
    ds_read_b64_tr_b16 a[20:21], v20 offset:144
    v_mfma_f32_16x16x32_bf16 v[52:55], a[4:7], a[60:63], 0
    ds_read_b64_tr_b16 a[22:23], v21 offset:144
    v_mfma_f32_16x16x32_bf16 v[60:63], a[4:7], a[64:67], 0
    s_waitcnt lgkmcnt(6)
    v_mfma_f32_16x16x32_bf16 v[64:67], a[8:11], a[48:51], 0
    v_mfma_f32_16x16x32_bf16 v[72:75], a[8:11], a[52:55], 0
    ds_read_b128 a[72:75], v25 offset:2048
    v_mfma_f32_16x16x32_bf16 v[80:83], a[8:11], a[56:59], 0
    ds_read_b128 a[76:79], v25 offset:4096
    v_mfma_f32_16x16x32_bf16 v[88:91], a[8:11], a[60:63], 0
    ds_read_b128 a[80:83], v25 offset:6144
    v_mfma_f32_16x16x32_bf16 v[96:99], a[8:11], a[64:67], 0
    ds_read_b128 a[84:87], v25 offset:8192
    s_waitcnt lgkmcnt(8)
    v_mfma_f32_16x16x32_bf16 v[68:71], a[12:15], a[48:51], 0
    ds_read_b128 a[68:71], v25 offset:0
    v_mfma_f32_16x16x32_bf16 v[76:79], a[12:15], a[52:55], 0
    ds_read_b64_tr_b16 a[24:25], v20 offset:14448
    v_mfma_f32_16x16x32_bf16 v[84:87], a[12:15], a[56:59], 0
    ds_read_b64_tr_b16 a[26:27], v21 offset:14448
    v_mfma_f32_16x16x32_bf16 v[92:95], a[12:15], a[60:63], 0
    ds_read_b64_tr_b16 a[28:29], v20 offset:14480
    v_mfma_f32_16x16x32_bf16 v[100:103], a[12:15], a[64:67], 0
    ds_read_b64_tr_b16 a[30:31], v21 offset:14480
    s_waitcnt lgkmcnt(11)
    v_mfma_f32_16x16x32_bf16 v[104:107], a[48:51], a[16:19], 0
    ds_read_b64_tr_b16 a[32:33], v20 offset:7168
    v_mfma_f32_16x16x32_bf16 v[108:111], a[52:55], a[16:19], 0
    ds_read_b64_tr_b16 a[34:35], v21 offset:7168
    v_mfma_f32_16x16x32_bf16 v[112:115], a[56:59], a[16:19], 0
    v_mfma_f32_16x16x32_bf16 v[116:119], a[60:63], a[16:19], 0
    v_mfma_f32_16x16x32_bf16 v[120:123], a[64:67], a[16:19], 0
    ds_read_b64_tr_b16 a[36:37], v20 offset:7200
    s_waitcnt lgkmcnt(12)
    v_mfma_f32_16x16x32_bf16 v[124:127], a[48:51], a[20:23], 0
    ds_read_b64_tr_b16 a[38:39], v21 offset:7200
    v_mfma_f32_16x16x32_bf16 v[128:131], a[52:55], a[20:23], 0
    v_mfma_f32_16x16x32_bf16 v[132:135], a[56:59], a[20:23], 0
    v_mfma_f32_16x16x32_bf16 v[136:139], a[60:63], a[20:23], 0
    v_mfma_f32_16x16x32_bf16 v[140:143], a[64:67], a[20:23], 0
    ds_read_b64_tr_b16 a[40:41], v20 offset:7280
    s_waitcnt lgkmcnt(7)
    v_mfma_f32_16x16x32_bf16 v[32:35], a[24:27], a[72:75], v[32:35]
    ds_read_b64_tr_b16 a[42:43], v21 offset:7280
    v_mfma_f32_16x16x32_bf16 v[40:43], a[24:27], a[76:79], v[40:43]
    v_mfma_f32_16x16x32_bf16 v[48:51], a[24:27], a[80:83], v[48:51]
    v_mfma_f32_16x16x32_bf16 v[56:59], a[24:27], a[84:87], v[56:59]
    s_waitcnt lgkmcnt(6)
    v_mfma_f32_16x16x32_bf16 v[36:39], a[28:31], a[72:75], v[36:39]
    ds_read_b64_tr_b16 a[44:45], v20 offset:7312
    v_mfma_f32_16x16x32_bf16 v[44:47], a[28:31], a[76:79], v[44:47]
    ds_read_b64_tr_b16 a[46:47], v21 offset:7312
    v_mfma_f32_16x16x32_bf16 v[52:55], a[28:31], a[80:83], v[52:55]
    v_mfma_f32_16x16x32_bf16 v[60:63], a[28:31], a[84:87], v[60:63]
    s_waitcnt lgkmcnt(6)
    v_mfma_f32_16x16x32_bf16 v[64:67], a[32:35], a[68:71], v[64:67]
    v_mfma_f32_16x16x32_bf16 v[72:75], a[32:35], a[72:75], v[72:75]
    v_mfma_f32_16x16x32_bf16 v[80:83], a[32:35], a[76:79], v[80:83]
    v_mfma_f32_16x16x32_bf16 v[88:91], a[32:35], a[80:83], v[88:91]
    v_mfma_f32_16x16x32_bf16 v[96:99], a[32:35], a[84:87], v[96:99]
    s_waitcnt lgkmcnt(4)
    v_mfma_f32_16x16x32_bf16 v[68:71], a[36:39], a[68:71], v[68:71]
    v_mfma_f32_16x16x32_bf16 v[76:79], a[36:39], a[72:75], v[76:79]
    v_mfma_f32_16x16x32_bf16 v[84:87], a[36:39], a[76:79], v[84:87]
    v_mfma_f32_16x16x32_bf16 v[92:95], a[36:39], a[80:83], v[92:95]
    v_mfma_f32_16x16x32_bf16 v[100:103], a[36:39], a[84:87], v[100:103]
    s_waitcnt lgkmcnt(2)
    v_mfma_f32_16x16x32_bf16 v[104:107], a[68:71], a[40:43], v[104:107]
    v_mfma_f32_16x16x32_bf16 v[108:111], a[72:75], a[40:43], v[108:111]
    v_mfma_f32_16x16x32_bf16 v[112:115], a[76:79], a[40:43], v[112:115]
    v_mfma_f32_16x16x32_bf16 v[116:119], a[80:83], a[40:43], v[116:119]
    s_barrier
    v_add_u32 v24, 61440, v16
    v_add_u32 v25, 61440, v17
    v_add_u32 v22, 0, v12
    v_add_u32 v23, 0, v13
    ds_read_b128 a[92:95], v24 offset:2048
    v_mfma_f32_16x16x32_bf16 v[120:123], a[84:87], a[40:43], v[120:123]
    ds_read_b128 a[96:99], v24 offset:4096
    ds_read_b128 a[100:103], v24 offset:6144
    s_waitcnt lgkmcnt(3)
    v_mfma_f32_16x16x32_bf16 v[124:127], a[68:71], a[44:47], v[124:127]
    ds_read_b128 a[104:107], v24 offset:8192
    ds_read_b128 a[88:91], v24 offset:0
    v_mfma_f32_16x16x32_bf16 v[128:131], a[72:75], a[44:47], v[128:131]
    ds_read_b64_tr_b16 a[0:1], v22 offset:14336
    ds_read_b64_tr_b16 a[2:3], v23 offset:14336
    v_mfma_f32_16x16x32_bf16 v[132:135], a[76:79], a[44:47], v[132:135]
    ds_read_b64_tr_b16 a[4:5], v22 offset:14368
    ds_read_b64_tr_b16 a[6:7], v23 offset:14368
    v_mfma_f32_16x16x32_bf16 v[136:139], a[80:83], a[44:47], v[136:139]
    ds_read_b64_tr_b16 a[8:9], v22 offset:0
    v_mfma_f32_16x16x32_bf16 v[140:143], a[84:87], a[44:47], v[140:143]
    ds_read_b64_tr_b16 a[10:11], v23 offset:0
    s_waitcnt lgkmcnt(4)
    v_mfma_f32_16x16x32_bf16 v[32:35], a[0:3], a[92:95], v[32:35]
    ds_read_b64_tr_b16 a[12:13], v22 offset:32
    v_mfma_f32_16x16x32_bf16 v[40:43], a[0:3], a[96:99], v[40:43]
    ds_read_b64_tr_b16 a[14:15], v23 offset:32
    v_mfma_f32_16x16x32_bf16 v[48:51], a[0:3], a[100:103], v[48:51]
    ds_read_b64_tr_b16 a[16:17], v22 offset:112
    v_mfma_f32_16x16x32_bf16 v[56:59], a[0:3], a[104:107], v[56:59]
    ds_read_b64_tr_b16 a[18:19], v23 offset:112
    s_waitcnt lgkmcnt(6)
    v_mfma_f32_16x16x32_bf16 v[36:39], a[4:7], a[92:95], v[36:39]
    ds_read_b64_tr_b16 a[20:21], v22 offset:144
    v_mfma_f32_16x16x32_bf16 v[44:47], a[4:7], a[96:99], v[44:47]
    ds_read_b64_tr_b16 a[22:23], v23 offset:144
    v_mfma_f32_16x16x32_bf16 v[52:55], a[4:7], a[100:103], v[52:55]
    v_mfma_f32_16x16x32_bf16 v[60:63], a[4:7], a[104:107], v[60:63]
    s_waitcnt lgkmcnt(6)
    v_mfma_f32_16x16x32_bf16 v[64:67], a[8:11], a[88:91], v[64:67]
    v_mfma_f32_16x16x32_bf16 v[72:75], a[8:11], a[92:95], v[72:75]
    ds_read_b128 a[52:55], v25 offset:2048
    v_mfma_f32_16x16x32_bf16 v[80:83], a[8:11], a[96:99], v[80:83]
    ds_read_b128 a[56:59], v25 offset:4096
    v_mfma_f32_16x16x32_bf16 v[88:91], a[8:11], a[100:103], v[88:91]
    ds_read_b128 a[60:63], v25 offset:6144
    v_mfma_f32_16x16x32_bf16 v[96:99], a[8:11], a[104:107], v[96:99]
    ds_read_b128 a[64:67], v25 offset:8192
    s_waitcnt lgkmcnt(8)
    v_mfma_f32_16x16x32_bf16 v[68:71], a[12:15], a[88:91], v[68:71]
    ds_read_b128 a[48:51], v25 offset:0
    v_mfma_f32_16x16x32_bf16 v[76:79], a[12:15], a[92:95], v[76:79]
    ds_read_b64_tr_b16 a[24:25], v22 offset:14448
    v_mfma_f32_16x16x32_bf16 v[84:87], a[12:15], a[96:99], v[84:87]
    ds_read_b64_tr_b16 a[26:27], v23 offset:14448
    v_mfma_f32_16x16x32_bf16 v[92:95], a[12:15], a[100:103], v[92:95]
    ds_read_b64_tr_b16 a[28:29], v22 offset:14480
    v_mfma_f32_16x16x32_bf16 v[100:103], a[12:15], a[104:107], v[100:103]
    ds_read_b64_tr_b16 a[30:31], v23 offset:14480
    s_waitcnt lgkmcnt(11)
    v_mfma_f32_16x16x32_bf16 v[104:107], a[88:91], a[16:19], v[104:107]
    ds_read_b64_tr_b16 a[32:33], v22 offset:7168
    v_mfma_f32_16x16x32_bf16 v[108:111], a[92:95], a[16:19], v[108:111]
    ds_read_b64_tr_b16 a[34:35], v23 offset:7168
    v_mfma_f32_16x16x32_bf16 v[112:115], a[96:99], a[16:19], v[112:115]
    v_mfma_f32_16x16x32_bf16 v[116:119], a[100:103], a[16:19], v[116:119]
    v_mfma_f32_16x16x32_bf16 v[120:123], a[104:107], a[16:19], v[120:123]
    ds_read_b64_tr_b16 a[36:37], v22 offset:7200
    s_waitcnt lgkmcnt(12)
    v_mfma_f32_16x16x32_bf16 v[124:127], a[88:91], a[20:23], v[124:127]
    ds_read_b64_tr_b16 a[38:39], v23 offset:7200
    v_mfma_f32_16x16x32_bf16 v[128:131], a[92:95], a[20:23], v[128:131]
    v_mfma_f32_16x16x32_bf16 v[132:135], a[96:99], a[20:23], v[132:135]
    v_mfma_f32_16x16x32_bf16 v[136:139], a[100:103], a[20:23], v[136:139]
    v_mfma_f32_16x16x32_bf16 v[140:143], a[104:107], a[20:23], v[140:143]
    ds_read_b64_tr_b16 a[40:41], v22 offset:7280
    s_waitcnt lgkmcnt(7)
    v_mfma_f32_16x16x32_bf16 v[32:35], a[24:27], a[52:55], v[32:35]
    ds_read_b64_tr_b16 a[42:43], v23 offset:7280
    v_mfma_f32_16x16x32_bf16 v[40:43], a[24:27], a[56:59], v[40:43]
    v_mfma_f32_16x16x32_bf16 v[48:51], a[24:27], a[60:63], v[48:51]
    v_mfma_f32_16x16x32_bf16 v[56:59], a[24:27], a[64:67], v[56:59]
    s_waitcnt lgkmcnt(6)
    v_mfma_f32_16x16x32_bf16 v[36:39], a[28:31], a[52:55], v[36:39]
    ds_read_b64_tr_b16 a[44:45], v22 offset:7312
    v_mfma_f32_16x16x32_bf16 v[44:47], a[28:31], a[56:59], v[44:47]
    ds_read_b64_tr_b16 a[46:47], v23 offset:7312
    v_mfma_f32_16x16x32_bf16 v[52:55], a[28:31], a[60:63], v[52:55]
    v_mfma_f32_16x16x32_bf16 v[60:63], a[28:31], a[64:67], v[60:63]
    s_waitcnt lgkmcnt(6)
    v_mfma_f32_16x16x32_bf16 v[64:67], a[32:35], a[48:51], v[64:67]
    v_mfma_f32_16x16x32_bf16 v[72:75], a[32:35], a[52:55], v[72:75]
    v_mfma_f32_16x16x32_bf16 v[80:83], a[32:35], a[56:59], v[80:83]
    v_mfma_f32_16x16x32_bf16 v[88:91], a[32:35], a[60:63], v[88:91]
    v_mfma_f32_16x16x32_bf16 v[96:99], a[32:35], a[64:67], v[96:99]
    s_waitcnt lgkmcnt(4)
    v_mfma_f32_16x16x32_bf16 v[68:71], a[36:39], a[48:51], v[68:71]
    v_mfma_f32_16x16x32_bf16 v[76:79], a[36:39], a[52:55], v[76:79]
    v_mfma_f32_16x16x32_bf16 v[84:87], a[36:39], a[56:59], v[84:87]
    v_mfma_f32_16x16x32_bf16 v[92:95], a[36:39], a[60:63], v[92:95]
    v_mfma_f32_16x16x32_bf16 v[100:103], a[36:39], a[64:67], v[100:103]
    s_waitcnt lgkmcnt(2)
    v_mfma_f32_16x16x32_bf16 v[104:107], a[48:51], a[40:43], v[104:107]
    v_mfma_f32_16x16x32_bf16 v[108:111], a[52:55], a[40:43], v[108:111]
    v_mfma_f32_16x16x32_bf16 v[112:115], a[56:59], a[40:43], v[112:115]
    v_mfma_f32_16x16x32_bf16 v[116:119], a[60:63], a[40:43], v[116:119]
    s_barrier
    buffer_load_dword v30, v11, s[36:39], 0 offen
    v_add_u32 v24, 79872, v16
    v_add_u32 v25, 79872, v17
    v_add_u32 v20, 21504, v12
    v_add_u32 v21, 21504, v13
    ds_read_b128 a[72:75], v24 offset:2048
    v_mfma_f32_16x16x32_bf16 v[120:123], a[64:67], a[40:43], v[120:123]
    ds_read_b128 a[76:79], v24 offset:4096
    ds_read_b128 a[80:83], v24 offset:6144
    s_waitcnt lgkmcnt(3)
    v_mfma_f32_16x16x32_bf16 v[124:127], a[48:51], a[44:47], v[124:127]
    ds_read_b128 a[84:87], v24 offset:8192
    ds_read_b128 a[68:71], v24 offset:0
    v_mfma_f32_16x16x32_bf16 v[128:131], a[52:55], a[44:47], v[128:131]
    ds_read_b64_tr_b16 a[0:1], v20 offset:14336
    ds_read_b64_tr_b16 a[2:3], v21 offset:14336
    v_mfma_f32_16x16x32_bf16 v[132:135], a[56:59], a[44:47], v[132:135]
    ds_read_b64_tr_b16 a[4:5], v20 offset:14368
    ds_read_b64_tr_b16 a[6:7], v21 offset:14368
    v_mfma_f32_16x16x32_bf16 v[136:139], a[60:63], a[44:47], v[136:139]
    ds_read_b64_tr_b16 a[8:9], v20 offset:0
    v_mfma_f32_16x16x32_bf16 v[140:143], a[64:67], a[44:47], v[140:143]
    ds_read_b64_tr_b16 a[10:11], v21 offset:0
    s_waitcnt lgkmcnt(4)
    v_mfma_f32_16x16x32_bf16 v[32:35], a[0:3], a[72:75], v[32:35]
    ds_read_b64_tr_b16 a[12:13], v20 offset:32
    v_mfma_f32_16x16x32_bf16 v[40:43], a[0:3], a[76:79], v[40:43]
    ds_read_b64_tr_b16 a[14:15], v21 offset:32
    v_mfma_f32_16x16x32_bf16 v[48:51], a[0:3], a[80:83], v[48:51]
    ds_read_b64_tr_b16 a[16:17], v20 offset:112
    v_mfma_f32_16x16x32_bf16 v[56:59], a[0:3], a[84:87], v[56:59]
    ds_read_b64_tr_b16 a[18:19], v21 offset:112
    s_waitcnt lgkmcnt(6)
    v_mfma_f32_16x16x32_bf16 v[36:39], a[4:7], a[72:75], v[36:39]
    ds_read_b64_tr_b16 a[20:21], v20 offset:144
    v_mfma_f32_16x16x32_bf16 v[44:47], a[4:7], a[76:79], v[44:47]
    ds_read_b64_tr_b16 a[22:23], v21 offset:144
    v_mfma_f32_16x16x32_bf16 v[52:55], a[4:7], a[80:83], v[52:55]
    v_mfma_f32_16x16x32_bf16 v[60:63], a[4:7], a[84:87], v[60:63]
    s_waitcnt lgkmcnt(6)
    v_mfma_f32_16x16x32_bf16 v[64:67], a[8:11], a[68:71], v[64:67]
    v_mfma_f32_16x16x32_bf16 v[72:75], a[8:11], a[72:75], v[72:75]
    ds_read_b128 a[92:95], v25 offset:2048
    v_mfma_f32_16x16x32_bf16 v[80:83], a[8:11], a[76:79], v[80:83]
    ds_read_b128 a[96:99], v25 offset:4096
    v_mfma_f32_16x16x32_bf16 v[88:91], a[8:11], a[80:83], v[88:91]
    ds_read_b128 a[100:103], v25 offset:6144
    v_mfma_f32_16x16x32_bf16 v[96:99], a[8:11], a[84:87], v[96:99]
    ds_read_b128 a[104:107], v25 offset:8192
    s_waitcnt lgkmcnt(8)
    v_mfma_f32_16x16x32_bf16 v[68:71], a[12:15], a[68:71], v[68:71]
    ds_read_b128 a[88:91], v25 offset:0
    v_mfma_f32_16x16x32_bf16 v[76:79], a[12:15], a[72:75], v[76:79]
    ds_read_b64_tr_b16 a[24:25], v20 offset:14448
    v_mfma_f32_16x16x32_bf16 v[84:87], a[12:15], a[76:79], v[84:87]
    ds_read_b64_tr_b16 a[26:27], v21 offset:14448
    v_mfma_f32_16x16x32_bf16 v[92:95], a[12:15], a[80:83], v[92:95]
    ds_read_b64_tr_b16 a[28:29], v20 offset:14480
    v_mfma_f32_16x16x32_bf16 v[100:103], a[12:15], a[84:87], v[100:103]
    ds_read_b64_tr_b16 a[30:31], v21 offset:14480
    s_waitcnt lgkmcnt(11)
    v_mfma_f32_16x16x32_bf16 v[104:107], a[68:71], a[16:19], v[104:107]
    ds_read_b64_tr_b16 a[32:33], v20 offset:7168
    v_mfma_f32_16x16x32_bf16 v[108:111], a[72:75], a[16:19], v[108:111]
    ds_read_b64_tr_b16 a[34:35], v21 offset:7168
    v_mfma_f32_16x16x32_bf16 v[112:115], a[76:79], a[16:19], v[112:115]
    v_mfma_f32_16x16x32_bf16 v[116:119], a[80:83], a[16:19], v[116:119]
    v_mfma_f32_16x16x32_bf16 v[120:123], a[84:87], a[16:19], v[120:123]
    ds_read_b64_tr_b16 a[36:37], v20 offset:7200
    s_waitcnt lgkmcnt(12)
    v_mfma_f32_16x16x32_bf16 v[124:127], a[68:71], a[20:23], v[124:127]
    ds_read_b64_tr_b16 a[38:39], v21 offset:7200
    v_mfma_f32_16x16x32_bf16 v[128:131], a[72:75], a[20:23], v[128:131]
    v_mfma_f32_16x16x32_bf16 v[132:135], a[76:79], a[20:23], v[132:135]
    v_mfma_f32_16x16x32_bf16 v[136:139], a[80:83], a[20:23], v[136:139]
    v_mfma_f32_16x16x32_bf16 v[140:143], a[84:87], a[20:23], v[140:143]
    ds_read_b64_tr_b16 a[40:41], v20 offset:7280
    s_waitcnt lgkmcnt(7)
    v_mfma_f32_16x16x32_bf16 v[32:35], a[24:27], a[92:95], v[32:35]
    ds_read_b64_tr_b16 a[42:43], v21 offset:7280
    v_mfma_f32_16x16x32_bf16 v[40:43], a[24:27], a[96:99], v[40:43]
    v_mfma_f32_16x16x32_bf16 v[48:51], a[24:27], a[100:103], v[48:51]
    v_mfma_f32_16x16x32_bf16 v[56:59], a[24:27], a[104:107], v[56:59]
    s_waitcnt lgkmcnt(6)
    v_mfma_f32_16x16x32_bf16 v[36:39], a[28:31], a[92:95], v[36:39]
    ds_read_b64_tr_b16 a[44:45], v20 offset:7312
    v_mfma_f32_16x16x32_bf16 v[44:47], a[28:31], a[96:99], v[44:47]
    ds_read_b64_tr_b16 a[46:47], v21 offset:7312
    v_mfma_f32_16x16x32_bf16 v[52:55], a[28:31], a[100:103], v[52:55]
    v_mfma_f32_16x16x32_bf16 v[60:63], a[28:31], a[104:107], v[60:63]
    s_waitcnt lgkmcnt(6)
    v_mfma_f32_16x16x32_bf16 v[64:67], a[32:35], a[88:91], v[64:67]
    v_mfma_f32_16x16x32_bf16 v[72:75], a[32:35], a[92:95], v[72:75]
    v_mfma_f32_16x16x32_bf16 v[80:83], a[32:35], a[96:99], v[80:83]
    v_mfma_f32_16x16x32_bf16 v[88:91], a[32:35], a[100:103], v[88:91]
    v_mfma_f32_16x16x32_bf16 v[96:99], a[32:35], a[104:107], v[96:99]
    s_waitcnt lgkmcnt(4)
    v_mfma_f32_16x16x32_bf16 v[68:71], a[36:39], a[88:91], v[68:71]
    v_mfma_f32_16x16x32_bf16 v[76:79], a[36:39], a[92:95], v[76:79]
    v_mfma_f32_16x16x32_bf16 v[84:87], a[36:39], a[96:99], v[84:87]
    v_mfma_f32_16x16x32_bf16 v[92:95], a[36:39], a[100:103], v[92:95]
    v_mfma_f32_16x16x32_bf16 v[100:103], a[36:39], a[104:107], v[100:103]
    s_waitcnt lgkmcnt(2)
    v_mfma_f32_16x16x32_bf16 v[104:107], a[88:91], a[40:43], v[104:107]
    v_mfma_f32_16x16x32_bf16 v[108:111], a[92:95], a[40:43], v[108:111]
    v_mfma_f32_16x16x32_bf16 v[112:115], a[96:99], a[40:43], v[112:115]
    v_mfma_f32_16x16x32_bf16 v[116:119], a[100:103], a[40:43], v[116:119]
    s_barrier
    v_add_u32 v24, 43008, v16
    v_add_u32 v25, 43008, v17
    v_add_u32 v22, 118784, v12
    v_add_u32 v23, 118784, v13
    ds_read_b128 a[52:55], v24 offset:2048
    v_mfma_f32_16x16x32_bf16 v[120:123], a[104:107], a[40:43], v[120:123]
    ds_read_b128 a[56:59], v24 offset:4096
    ds_read_b128 a[60:63], v24 offset:6144
    s_waitcnt lgkmcnt(3)
    v_mfma_f32_16x16x32_bf16 v[124:127], a[88:91], a[44:47], v[124:127]
    ds_read_b128 a[64:67], v24 offset:8192
    ds_read_b128 a[48:51], v24 offset:0
    v_mfma_f32_16x16x32_bf16 v[128:131], a[92:95], a[44:47], v[128:131]
    ds_read_b64_tr_b16 a[0:1], v22 offset:14336
    ds_read_b64_tr_b16 a[2:3], v23 offset:14336
    v_mfma_f32_16x16x32_bf16 v[132:135], a[96:99], a[44:47], v[132:135]
    ds_read_b64_tr_b16 a[4:5], v22 offset:14368
    ds_read_b64_tr_b16 a[6:7], v23 offset:14368
    v_mfma_f32_16x16x32_bf16 v[136:139], a[100:103], a[44:47], v[136:139]
    ds_read_b64_tr_b16 a[8:9], v22 offset:0
    v_mfma_f32_16x16x32_bf16 v[140:143], a[104:107], a[44:47], v[140:143]
    ds_read_b64_tr_b16 a[10:11], v23 offset:0
    s_waitcnt lgkmcnt(4)
    v_mfma_f32_16x16x32_bf16 v[32:35], a[0:3], a[52:55], v[32:35]
    ds_read_b64_tr_b16 a[12:13], v22 offset:32
    v_mfma_f32_16x16x32_bf16 v[40:43], a[0:3], a[56:59], v[40:43]
    ds_read_b64_tr_b16 a[14:15], v23 offset:32
    v_mfma_f32_16x16x32_bf16 v[48:51], a[0:3], a[60:63], v[48:51]
    ds_read_b64_tr_b16 a[16:17], v22 offset:112
    v_mfma_f32_16x16x32_bf16 v[56:59], a[0:3], a[64:67], v[56:59]
    ds_read_b64_tr_b16 a[18:19], v23 offset:112
    s_waitcnt lgkmcnt(6)
    v_mfma_f32_16x16x32_bf16 v[36:39], a[4:7], a[52:55], v[36:39]
    ds_read_b64_tr_b16 a[20:21], v22 offset:144
    v_mfma_f32_16x16x32_bf16 v[44:47], a[4:7], a[56:59], v[44:47]
    ds_read_b64_tr_b16 a[22:23], v23 offset:144
    v_mfma_f32_16x16x32_bf16 v[52:55], a[4:7], a[60:63], v[52:55]
    v_mfma_f32_16x16x32_bf16 v[60:63], a[4:7], a[64:67], v[60:63]
    s_waitcnt lgkmcnt(6)
    v_mfma_f32_16x16x32_bf16 v[64:67], a[8:11], a[48:51], v[64:67]
    v_mfma_f32_16x16x32_bf16 v[72:75], a[8:11], a[52:55], v[72:75]
    ds_read_b128 a[72:75], v25 offset:2048
    v_mfma_f32_16x16x32_bf16 v[80:83], a[8:11], a[56:59], v[80:83]
    ds_read_b128 a[76:79], v25 offset:4096
    v_mfma_f32_16x16x32_bf16 v[88:91], a[8:11], a[60:63], v[88:91]
    ds_read_b128 a[80:83], v25 offset:6144
    v_mfma_f32_16x16x32_bf16 v[96:99], a[8:11], a[64:67], v[96:99]
    ds_read_b128 a[84:87], v25 offset:8192
    s_waitcnt lgkmcnt(8)
    v_mfma_f32_16x16x32_bf16 v[68:71], a[12:15], a[48:51], v[68:71]
    ds_read_b128 a[68:71], v25 offset:0
    v_mfma_f32_16x16x32_bf16 v[76:79], a[12:15], a[52:55], v[76:79]
    ds_read_b64_tr_b16 a[24:25], v22 offset:14448
    v_mfma_f32_16x16x32_bf16 v[84:87], a[12:15], a[56:59], v[84:87]
    ds_read_b64_tr_b16 a[26:27], v23 offset:14448
    v_mfma_f32_16x16x32_bf16 v[92:95], a[12:15], a[60:63], v[92:95]
    ds_read_b64_tr_b16 a[28:29], v22 offset:14480
    v_mfma_f32_16x16x32_bf16 v[100:103], a[12:15], a[64:67], v[100:103]
    ds_read_b64_tr_b16 a[30:31], v23 offset:14480
    s_waitcnt lgkmcnt(11)
    v_mfma_f32_16x16x32_bf16 v[104:107], a[48:51], a[16:19], v[104:107]
    ds_read_b64_tr_b16 a[32:33], v22 offset:7168
    v_mfma_f32_16x16x32_bf16 v[108:111], a[52:55], a[16:19], v[108:111]
    ds_read_b64_tr_b16 a[34:35], v23 offset:7168
    v_mfma_f32_16x16x32_bf16 v[112:115], a[56:59], a[16:19], v[112:115]
    v_mfma_f32_16x16x32_bf16 v[116:119], a[60:63], a[16:19], v[116:119]
    v_mfma_f32_16x16x32_bf16 v[120:123], a[64:67], a[16:19], v[120:123]
    ds_read_b64_tr_b16 a[36:37], v22 offset:7200
    s_waitcnt lgkmcnt(12)
    v_mfma_f32_16x16x32_bf16 v[124:127], a[48:51], a[20:23], v[124:127]
    ds_read_b64_tr_b16 a[38:39], v23 offset:7200
    v_mfma_f32_16x16x32_bf16 v[128:131], a[52:55], a[20:23], v[128:131]
    v_mfma_f32_16x16x32_bf16 v[132:135], a[56:59], a[20:23], v[132:135]
    v_mfma_f32_16x16x32_bf16 v[136:139], a[60:63], a[20:23], v[136:139]
    v_mfma_f32_16x16x32_bf16 v[140:143], a[64:67], a[20:23], v[140:143]
    ds_read_b64_tr_b16 a[40:41], v22 offset:7280
    s_waitcnt lgkmcnt(7)
    v_mfma_f32_16x16x32_bf16 v[32:35], a[24:27], a[72:75], v[32:35]
    ds_read_b64_tr_b16 a[42:43], v23 offset:7280
    v_mfma_f32_16x16x32_bf16 v[40:43], a[24:27], a[76:79], v[40:43]
    v_mfma_f32_16x16x32_bf16 v[48:51], a[24:27], a[80:83], v[48:51]
    v_mfma_f32_16x16x32_bf16 v[56:59], a[24:27], a[84:87], v[56:59]
    s_waitcnt lgkmcnt(6)
    v_mfma_f32_16x16x32_bf16 v[36:39], a[28:31], a[72:75], v[36:39]
    ds_read_b64_tr_b16 a[44:45], v22 offset:7312
    v_mfma_f32_16x16x32_bf16 v[44:47], a[28:31], a[76:79], v[44:47]
    ds_read_b64_tr_b16 a[46:47], v23 offset:7312
    v_mfma_f32_16x16x32_bf16 v[52:55], a[28:31], a[80:83], v[52:55]
    v_mfma_f32_16x16x32_bf16 v[60:63], a[28:31], a[84:87], v[60:63]
    s_waitcnt lgkmcnt(6)
    v_mfma_f32_16x16x32_bf16 v[64:67], a[32:35], a[68:71], v[64:67]
    v_mfma_f32_16x16x32_bf16 v[72:75], a[32:35], a[72:75], v[72:75]
    v_mfma_f32_16x16x32_bf16 v[80:83], a[32:35], a[76:79], v[80:83]
    v_mfma_f32_16x16x32_bf16 v[88:91], a[32:35], a[80:83], v[88:91]
    v_mfma_f32_16x16x32_bf16 v[96:99], a[32:35], a[84:87], v[96:99]
    s_waitcnt lgkmcnt(4)
    v_mfma_f32_16x16x32_bf16 v[68:71], a[36:39], a[68:71], v[68:71]
    v_mfma_f32_16x16x32_bf16 v[76:79], a[36:39], a[72:75], v[76:79]
    v_mfma_f32_16x16x32_bf16 v[84:87], a[36:39], a[76:79], v[84:87]
    v_mfma_f32_16x16x32_bf16 v[92:95], a[36:39], a[80:83], v[92:95]
    v_mfma_f32_16x16x32_bf16 v[100:103], a[36:39], a[84:87], v[100:103]
    s_waitcnt lgkmcnt(2)
    v_mfma_f32_16x16x32_bf16 v[104:107], a[68:71], a[40:43], v[104:107]
    v_mfma_f32_16x16x32_bf16 v[108:111], a[72:75], a[40:43], v[108:111]
    v_mfma_f32_16x16x32_bf16 v[112:115], a[76:79], a[40:43], v[112:115]
    v_mfma_f32_16x16x32_bf16 v[116:119], a[80:83], a[40:43], v[116:119]
    s_barrier
    v_add_u32 v24, 61440, v16
    v_add_u32 v25, 61440, v17
    v_add_u32 v20, 140288, v12
    v_add_u32 v21, 140288, v13
    ds_read_b128 a[92:95], v24 offset:2048
    v_mfma_f32_16x16x32_bf16 v[120:123], a[84:87], a[40:43], v[120:123]
    ds_read_b128 a[96:99], v24 offset:4096
    ds_read_b128 a[100:103], v24 offset:6144
    s_waitcnt lgkmcnt(3)
    v_mfma_f32_16x16x32_bf16 v[124:127], a[68:71], a[44:47], v[124:127]
    ds_read_b128 a[104:107], v24 offset:8192
    ds_read_b128 a[88:91], v24 offset:0
    v_mfma_f32_16x16x32_bf16 v[128:131], a[72:75], a[44:47], v[128:131]
    ds_read_b64_tr_b16 a[0:1], v20 offset:14336
    ds_read_b64_tr_b16 a[2:3], v21 offset:14336
    v_mfma_f32_16x16x32_bf16 v[132:135], a[76:79], a[44:47], v[132:135]
    ds_read_b64_tr_b16 a[4:5], v20 offset:14368
    ds_read_b64_tr_b16 a[6:7], v21 offset:14368
    v_mfma_f32_16x16x32_bf16 v[136:139], a[80:83], a[44:47], v[136:139]
    ds_read_b64_tr_b16 a[8:9], v20 offset:0
    v_mfma_f32_16x16x32_bf16 v[140:143], a[84:87], a[44:47], v[140:143]
    ds_read_b64_tr_b16 a[10:11], v21 offset:0
    s_waitcnt lgkmcnt(4)
    v_mfma_f32_16x16x32_bf16 v[32:35], a[0:3], a[92:95], v[32:35]
    ds_read_b64_tr_b16 a[12:13], v20 offset:32
    v_mfma_f32_16x16x32_bf16 v[40:43], a[0:3], a[96:99], v[40:43]
    ds_read_b64_tr_b16 a[14:15], v21 offset:32
    v_mfma_f32_16x16x32_bf16 v[48:51], a[0:3], a[100:103], v[48:51]
    ds_read_b64_tr_b16 a[16:17], v20 offset:112
    v_mfma_f32_16x16x32_bf16 v[56:59], a[0:3], a[104:107], v[56:59]
    ds_read_b64_tr_b16 a[18:19], v21 offset:112
    s_waitcnt lgkmcnt(6)
    v_mfma_f32_16x16x32_bf16 v[36:39], a[4:7], a[92:95], v[36:39]
    ds_read_b64_tr_b16 a[20:21], v20 offset:144
    v_mfma_f32_16x16x32_bf16 v[44:47], a[4:7], a[96:99], v[44:47]
    ds_read_b64_tr_b16 a[22:23], v21 offset:144
    v_mfma_f32_16x16x32_bf16 v[52:55], a[4:7], a[100:103], v[52:55]
    v_mfma_f32_16x16x32_bf16 v[60:63], a[4:7], a[104:107], v[60:63]
    s_waitcnt lgkmcnt(6)
    v_mfma_f32_16x16x32_bf16 v[64:67], a[8:11], a[88:91], v[64:67]
    v_mfma_f32_16x16x32_bf16 v[72:75], a[8:11], a[92:95], v[72:75]
    ds_read_b128 a[52:55], v25 offset:2048
    v_mfma_f32_16x16x32_bf16 v[80:83], a[8:11], a[96:99], v[80:83]
    ds_read_b128 a[56:59], v25 offset:4096
    v_mfma_f32_16x16x32_bf16 v[88:91], a[8:11], a[100:103], v[88:91]
    ds_read_b128 a[60:63], v25 offset:6144
    v_mfma_f32_16x16x32_bf16 v[96:99], a[8:11], a[104:107], v[96:99]
    ds_read_b128 a[64:67], v25 offset:8192
    s_waitcnt lgkmcnt(8)
    v_mfma_f32_16x16x32_bf16 v[68:71], a[12:15], a[88:91], v[68:71]
    ds_read_b128 a[48:51], v25 offset:0
    v_mfma_f32_16x16x32_bf16 v[76:79], a[12:15], a[92:95], v[76:79]
    ds_read_b64_tr_b16 a[24:25], v20 offset:14448
    v_mfma_f32_16x16x32_bf16 v[84:87], a[12:15], a[96:99], v[84:87]
    ds_read_b64_tr_b16 a[26:27], v21 offset:14448
    v_mfma_f32_16x16x32_bf16 v[92:95], a[12:15], a[100:103], v[92:95]
    ds_read_b64_tr_b16 a[28:29], v20 offset:14480
    v_mfma_f32_16x16x32_bf16 v[100:103], a[12:15], a[104:107], v[100:103]
    ds_read_b64_tr_b16 a[30:31], v21 offset:14480
    s_waitcnt lgkmcnt(11)
    v_mfma_f32_16x16x32_bf16 v[104:107], a[88:91], a[16:19], v[104:107]
    ds_read_b64_tr_b16 a[32:33], v20 offset:7168
    v_mfma_f32_16x16x32_bf16 v[108:111], a[92:95], a[16:19], v[108:111]
    ds_read_b64_tr_b16 a[34:35], v21 offset:7168
    v_mfma_f32_16x16x32_bf16 v[112:115], a[96:99], a[16:19], v[112:115]
    v_mfma_f32_16x16x32_bf16 v[116:119], a[100:103], a[16:19], v[116:119]
    v_mfma_f32_16x16x32_bf16 v[120:123], a[104:107], a[16:19], v[120:123]
    ds_read_b64_tr_b16 a[36:37], v20 offset:7200
    s_waitcnt lgkmcnt(12)
    v_mfma_f32_16x16x32_bf16 v[124:127], a[88:91], a[20:23], v[124:127]
    ds_read_b64_tr_b16 a[38:39], v21 offset:7200
    v_mfma_f32_16x16x32_bf16 v[128:131], a[92:95], a[20:23], v[128:131]
    v_mfma_f32_16x16x32_bf16 v[132:135], a[96:99], a[20:23], v[132:135]
    v_mfma_f32_16x16x32_bf16 v[136:139], a[100:103], a[20:23], v[136:139]
    v_mfma_f32_16x16x32_bf16 v[140:143], a[104:107], a[20:23], v[140:143]
    ds_read_b64_tr_b16 a[40:41], v20 offset:7280
    s_waitcnt lgkmcnt(7)
    v_mfma_f32_16x16x32_bf16 v[32:35], a[24:27], a[52:55], v[32:35]
    ds_read_b64_tr_b16 a[42:43], v21 offset:7280
    v_mfma_f32_16x16x32_bf16 v[40:43], a[24:27], a[56:59], v[40:43]
    v_mfma_f32_16x16x32_bf16 v[48:51], a[24:27], a[60:63], v[48:51]
    v_mfma_f32_16x16x32_bf16 v[56:59], a[24:27], a[64:67], v[56:59]
    s_waitcnt lgkmcnt(6)
    v_mfma_f32_16x16x32_bf16 v[36:39], a[28:31], a[52:55], v[36:39]
    ds_read_b64_tr_b16 a[44:45], v20 offset:7312
    v_mfma_f32_16x16x32_bf16 v[44:47], a[28:31], a[56:59], v[44:47]
    ds_read_b64_tr_b16 a[46:47], v21 offset:7312
    v_mfma_f32_16x16x32_bf16 v[52:55], a[28:31], a[60:63], v[52:55]
    v_mfma_f32_16x16x32_bf16 v[60:63], a[28:31], a[64:67], v[60:63]
    s_waitcnt lgkmcnt(6)
    v_mfma_f32_16x16x32_bf16 v[64:67], a[32:35], a[48:51], v[64:67]
    v_mfma_f32_16x16x32_bf16 v[72:75], a[32:35], a[52:55], v[72:75]
    v_mfma_f32_16x16x32_bf16 v[80:83], a[32:35], a[56:59], v[80:83]
    v_mfma_f32_16x16x32_bf16 v[88:91], a[32:35], a[60:63], v[88:91]
    v_mfma_f32_16x16x32_bf16 v[96:99], a[32:35], a[64:67], v[96:99]
    s_waitcnt lgkmcnt(4)
    v_mfma_f32_16x16x32_bf16 v[68:71], a[36:39], a[48:51], v[68:71]
    v_mfma_f32_16x16x32_bf16 v[76:79], a[36:39], a[52:55], v[76:79]
    v_mfma_f32_16x16x32_bf16 v[84:87], a[36:39], a[56:59], v[84:87]
    v_mfma_f32_16x16x32_bf16 v[92:95], a[36:39], a[60:63], v[92:95]
    v_mfma_f32_16x16x32_bf16 v[100:103], a[36:39], a[64:67], v[100:103]
    s_waitcnt lgkmcnt(2)
    v_mfma_f32_16x16x32_bf16 v[104:107], a[48:51], a[40:43], v[104:107]
    v_mfma_f32_16x16x32_bf16 v[108:111], a[52:55], a[40:43], v[108:111]
    v_mfma_f32_16x16x32_bf16 v[112:115], a[56:59], a[40:43], v[112:115]
    v_mfma_f32_16x16x32_bf16 v[116:119], a[60:63], a[40:43], v[116:119]
    s_barrier
    v_add_u32 v24, 79872, v16
    v_add_u32 v25, 79872, v17
    v_add_u32 v22, 0, v12
    v_add_u32 v23, 0, v13
    ds_read_b128 a[72:75], v24 offset:2048
    v_mfma_f32_16x16x32_bf16 v[120:123], a[64:67], a[40:43], v[120:123]
    ds_read_b128 a[76:79], v24 offset:4096
    ds_read_b128 a[80:83], v24 offset:6144
    s_waitcnt lgkmcnt(3)
    v_mfma_f32_16x16x32_bf16 v[124:127], a[48:51], a[44:47], v[124:127]
    ds_read_b128 a[84:87], v24 offset:8192
    ds_read_b128 a[68:71], v24 offset:0
    v_mfma_f32_16x16x32_bf16 v[128:131], a[52:55], a[44:47], v[128:131]
    ds_read_b64_tr_b16 a[0:1], v22 offset:14336
    ds_read_b64_tr_b16 a[2:3], v23 offset:14336
    v_mfma_f32_16x16x32_bf16 v[132:135], a[56:59], a[44:47], v[132:135]
    ds_read_b64_tr_b16 a[4:5], v22 offset:14368
    ds_read_b64_tr_b16 a[6:7], v23 offset:14368
    v_mfma_f32_16x16x32_bf16 v[136:139], a[60:63], a[44:47], v[136:139]
    ds_read_b64_tr_b16 a[8:9], v22 offset:0
    v_mfma_f32_16x16x32_bf16 v[140:143], a[64:67], a[44:47], v[140:143]
    ds_read_b64_tr_b16 a[10:11], v23 offset:0
    s_waitcnt lgkmcnt(4)
    v_mfma_f32_16x16x32_bf16 v[32:35], a[0:3], a[72:75], v[32:35]
    ds_read_b64_tr_b16 a[12:13], v22 offset:32
    v_mfma_f32_16x16x32_bf16 v[40:43], a[0:3], a[76:79], v[40:43]
    ds_read_b64_tr_b16 a[14:15], v23 offset:32
    v_mfma_f32_16x16x32_bf16 v[48:51], a[0:3], a[80:83], v[48:51]
    ds_read_b64_tr_b16 a[16:17], v22 offset:112
    v_mfma_f32_16x16x32_bf16 v[56:59], a[0:3], a[84:87], v[56:59]
    ds_read_b64_tr_b16 a[18:19], v23 offset:112
    s_waitcnt lgkmcnt(6)
    v_mfma_f32_16x16x32_bf16 v[36:39], a[4:7], a[72:75], v[36:39]
    ds_read_b64_tr_b16 a[20:21], v22 offset:144
    v_mfma_f32_16x16x32_bf16 v[44:47], a[4:7], a[76:79], v[44:47]
    ds_read_b64_tr_b16 a[22:23], v23 offset:144
    v_mfma_f32_16x16x32_bf16 v[52:55], a[4:7], a[80:83], v[52:55]
    v_mfma_f32_16x16x32_bf16 v[60:63], a[4:7], a[84:87], v[60:63]
    s_waitcnt lgkmcnt(6)
    v_mfma_f32_16x16x32_bf16 v[64:67], a[8:11], a[68:71], v[64:67]
    v_mfma_f32_16x16x32_bf16 v[72:75], a[8:11], a[72:75], v[72:75]
    ds_read_b128 a[92:95], v25 offset:2048
    v_mfma_f32_16x16x32_bf16 v[80:83], a[8:11], a[76:79], v[80:83]
    ds_read_b128 a[96:99], v25 offset:4096
    v_mfma_f32_16x16x32_bf16 v[88:91], a[8:11], a[80:83], v[88:91]
    ds_read_b128 a[100:103], v25 offset:6144
    v_mfma_f32_16x16x32_bf16 v[96:99], a[8:11], a[84:87], v[96:99]
    ds_read_b128 a[104:107], v25 offset:8192
    s_waitcnt lgkmcnt(8)
    v_mfma_f32_16x16x32_bf16 v[68:71], a[12:15], a[68:71], v[68:71]
    ds_read_b128 a[88:91], v25 offset:0
    v_mfma_f32_16x16x32_bf16 v[76:79], a[12:15], a[72:75], v[76:79]
    ds_read_b64_tr_b16 a[24:25], v22 offset:14448
    v_mfma_f32_16x16x32_bf16 v[84:87], a[12:15], a[76:79], v[84:87]
    ds_read_b64_tr_b16 a[26:27], v23 offset:14448
    v_mfma_f32_16x16x32_bf16 v[92:95], a[12:15], a[80:83], v[92:95]
    ds_read_b64_tr_b16 a[28:29], v22 offset:14480
    v_mfma_f32_16x16x32_bf16 v[100:103], a[12:15], a[84:87], v[100:103]
    ds_read_b64_tr_b16 a[30:31], v23 offset:14480
    s_waitcnt lgkmcnt(11)
    v_mfma_f32_16x16x32_bf16 v[104:107], a[68:71], a[16:19], v[104:107]
    ds_read_b64_tr_b16 a[32:33], v22 offset:7168
    v_mfma_f32_16x16x32_bf16 v[108:111], a[72:75], a[16:19], v[108:111]
    ds_read_b64_tr_b16 a[34:35], v23 offset:7168
    v_mfma_f32_16x16x32_bf16 v[112:115], a[76:79], a[16:19], v[112:115]
    v_mfma_f32_16x16x32_bf16 v[116:119], a[80:83], a[16:19], v[116:119]
    v_mfma_f32_16x16x32_bf16 v[120:123], a[84:87], a[16:19], v[120:123]
    ds_read_b64_tr_b16 a[36:37], v22 offset:7200
    s_waitcnt lgkmcnt(12)
    v_mfma_f32_16x16x32_bf16 v[124:127], a[68:71], a[20:23], v[124:127]
    ds_read_b64_tr_b16 a[38:39], v23 offset:7200
    v_mfma_f32_16x16x32_bf16 v[128:131], a[72:75], a[20:23], v[128:131]
    v_mfma_f32_16x16x32_bf16 v[132:135], a[76:79], a[20:23], v[132:135]
    v_mfma_f32_16x16x32_bf16 v[136:139], a[80:83], a[20:23], v[136:139]
    v_mfma_f32_16x16x32_bf16 v[140:143], a[84:87], a[20:23], v[140:143]
    ds_read_b64_tr_b16 a[40:41], v22 offset:7280
    s_waitcnt lgkmcnt(7)
    v_mfma_f32_16x16x32_bf16 v[32:35], a[24:27], a[92:95], v[32:35]
    ds_read_b64_tr_b16 a[42:43], v23 offset:7280
    v_mfma_f32_16x16x32_bf16 v[40:43], a[24:27], a[96:99], v[40:43]
    v_mfma_f32_16x16x32_bf16 v[48:51], a[24:27], a[100:103], v[48:51]
    v_mfma_f32_16x16x32_bf16 v[56:59], a[24:27], a[104:107], v[56:59]
    s_waitcnt lgkmcnt(6)
    v_mfma_f32_16x16x32_bf16 v[36:39], a[28:31], a[92:95], v[36:39]
    ds_read_b64_tr_b16 a[44:45], v22 offset:7312
    v_mfma_f32_16x16x32_bf16 v[44:47], a[28:31], a[96:99], v[44:47]
    ds_read_b64_tr_b16 a[46:47], v23 offset:7312
    v_mfma_f32_16x16x32_bf16 v[52:55], a[28:31], a[100:103], v[52:55]
    v_mfma_f32_16x16x32_bf16 v[60:63], a[28:31], a[104:107], v[60:63]
    s_waitcnt lgkmcnt(6)
    v_mfma_f32_16x16x32_bf16 v[64:67], a[32:35], a[88:91], v[64:67]
    v_mfma_f32_16x16x32_bf16 v[72:75], a[32:35], a[92:95], v[72:75]
    v_mfma_f32_16x16x32_bf16 v[80:83], a[32:35], a[96:99], v[80:83]
    v_mfma_f32_16x16x32_bf16 v[88:91], a[32:35], a[100:103], v[88:91]
    v_mfma_f32_16x16x32_bf16 v[96:99], a[32:35], a[104:107], v[96:99]
    s_waitcnt lgkmcnt(4)
    v_mfma_f32_16x16x32_bf16 v[68:71], a[36:39], a[88:91], v[68:71]
    v_mfma_f32_16x16x32_bf16 v[76:79], a[36:39], a[92:95], v[76:79]
    v_mfma_f32_16x16x32_bf16 v[84:87], a[36:39], a[96:99], v[84:87]
    v_mfma_f32_16x16x32_bf16 v[92:95], a[36:39], a[100:103], v[92:95]
    v_mfma_f32_16x16x32_bf16 v[100:103], a[36:39], a[104:107], v[100:103]
    s_waitcnt lgkmcnt(2)
    v_mfma_f32_16x16x32_bf16 v[104:107], a[88:91], a[40:43], v[104:107]
    v_mfma_f32_16x16x32_bf16 v[108:111], a[92:95], a[40:43], v[108:111]
    v_mfma_f32_16x16x32_bf16 v[112:115], a[96:99], a[40:43], v[112:115]
    v_mfma_f32_16x16x32_bf16 v[116:119], a[100:103], a[40:43], v[116:119]
    v_mfma_f32_16x16x32_bf16 v[120:123], a[104:107], a[40:43], v[120:123]
    s_waitcnt lgkmcnt(0)
    v_mfma_f32_16x16x32_bf16 v[124:127], a[88:91], a[44:47], v[124:127]
    v_mfma_f32_16x16x32_bf16 v[128:131], a[92:95], a[44:47], v[128:131]
    s_waitcnt vmcnt(1)
    s_barrier
    v_add_u32 v24, 43008, v16
    v_add_u32 v25, 43008, v17
    v_add_u32 v20, 21504, v12
    v_add_u32 v21, 21504, v13
    ds_read_b128 a[52:55], v24 offset:2048
    v_mfma_f32_16x16x32_bf16 v[132:135], a[96:99], a[44:47], v[132:135]
    ds_read_b128 a[56:59], v24 offset:4096
    ds_read_b128 a[60:63], v24 offset:6144
    v_mfma_f32_16x16x32_bf16 v[136:139], a[100:103], a[44:47], v[136:139]
    ds_read_b128 a[64:67], v24 offset:8192
    ds_read_b128 a[48:51], v24 offset:0
    v_mfma_f32_16x16x32_bf16 v[140:143], a[104:107], a[44:47], v[140:143]
    ds_read_b64_tr_b16 a[0:1], v20 offset:14336
    ds_read_b64_tr_b16 a[2:3], v21 offset:14336
    ds_read_b64_tr_b16 a[4:5], v20 offset:14368
    ds_read_b64_tr_b16 a[6:7], v21 offset:14368
    s_waitcnt lgkmcnt(2)
    v_mfma_f32_16x16x32_bf16 v[32:35], a[0:3], a[52:55], v[32:35]
    ds_read_b64_tr_b16 a[8:9], v20 offset:0
    ds_read_b64_tr_b16 a[10:11], v21 offset:0
    v_mfma_f32_16x16x32_bf16 v[40:43], a[0:3], a[56:59], v[40:43]
    ds_read_b64_tr_b16 a[12:13], v20 offset:32
    v_mfma_f32_16x16x32_bf16 v[48:51], a[0:3], a[60:63], v[48:51]
    ds_read_b64_tr_b16 a[14:15], v21 offset:32
    v_mfma_f32_16x16x32_bf16 v[56:59], a[0:3], a[64:67], v[56:59]
    ds_read_b64_tr_b16 a[16:17], v20 offset:112
    s_waitcnt lgkmcnt(5)
    v_mfma_f32_16x16x32_bf16 v[36:39], a[4:7], a[52:55], v[36:39]
    ds_read_b64_tr_b16 a[18:19], v21 offset:112
    v_mfma_f32_16x16x32_bf16 v[44:47], a[4:7], a[56:59], v[44:47]
    ds_read_b64_tr_b16 a[20:21], v20 offset:144
    v_mfma_f32_16x16x32_bf16 v[52:55], a[4:7], a[60:63], v[52:55]
    ds_read_b64_tr_b16 a[22:23], v21 offset:144
    v_mfma_f32_16x16x32_bf16 v[60:63], a[4:7], a[64:67], v[60:63]
    s_waitcnt lgkmcnt(6)
    v_mfma_f32_16x16x32_bf16 v[64:67], a[8:11], a[48:51], v[64:67]
    v_mfma_f32_16x16x32_bf16 v[72:75], a[8:11], a[52:55], v[72:75]
    ds_read_b128 a[72:75], v25 offset:2048
    v_mfma_f32_16x16x32_bf16 v[80:83], a[8:11], a[56:59], v[80:83]
    ds_read_b128 a[76:79], v25 offset:4096
    v_mfma_f32_16x16x32_bf16 v[88:91], a[8:11], a[60:63], v[88:91]
    ds_read_b128 a[80:83], v25 offset:6144
    v_mfma_f32_16x16x32_bf16 v[96:99], a[8:11], a[64:67], v[96:99]
    ds_read_b128 a[84:87], v25 offset:8192
    s_waitcnt lgkmcnt(8)
    v_mfma_f32_16x16x32_bf16 v[68:71], a[12:15], a[48:51], v[68:71]
    ds_read_b128 a[68:71], v25 offset:0
    v_mfma_f32_16x16x32_bf16 v[76:79], a[12:15], a[52:55], v[76:79]
    ds_read_b64_tr_b16 a[24:25], v20 offset:14448
    v_mfma_f32_16x16x32_bf16 v[84:87], a[12:15], a[56:59], v[84:87]
    ds_read_b64_tr_b16 a[26:27], v21 offset:14448
    v_mfma_f32_16x16x32_bf16 v[92:95], a[12:15], a[60:63], v[92:95]
    ds_read_b64_tr_b16 a[28:29], v20 offset:14480
    v_mfma_f32_16x16x32_bf16 v[100:103], a[12:15], a[64:67], v[100:103]
    ds_read_b64_tr_b16 a[30:31], v21 offset:14480
    s_waitcnt lgkmcnt(11)
    v_mfma_f32_16x16x32_bf16 v[104:107], a[48:51], a[16:19], v[104:107]
    ds_read_b64_tr_b16 a[32:33], v20 offset:7168
    v_mfma_f32_16x16x32_bf16 v[108:111], a[52:55], a[16:19], v[108:111]
    ds_read_b64_tr_b16 a[34:35], v21 offset:7168
    v_mfma_f32_16x16x32_bf16 v[112:115], a[56:59], a[16:19], v[112:115]
    v_mfma_f32_16x16x32_bf16 v[116:119], a[60:63], a[16:19], v[116:119]
    v_mfma_f32_16x16x32_bf16 v[120:123], a[64:67], a[16:19], v[120:123]
    ds_read_b64_tr_b16 a[36:37], v20 offset:7200
    s_waitcnt lgkmcnt(12)
    v_mfma_f32_16x16x32_bf16 v[124:127], a[48:51], a[20:23], v[124:127]
    ds_read_b64_tr_b16 a[38:39], v21 offset:7200
    v_mfma_f32_16x16x32_bf16 v[128:131], a[52:55], a[20:23], v[128:131]
    v_mfma_f32_16x16x32_bf16 v[132:135], a[56:59], a[20:23], v[132:135]
    v_mfma_f32_16x16x32_bf16 v[136:139], a[60:63], a[20:23], v[136:139]
    v_mfma_f32_16x16x32_bf16 v[140:143], a[64:67], a[20:23], v[140:143]
    ds_read_b64_tr_b16 a[40:41], v20 offset:7280
    s_waitcnt lgkmcnt(7)
    v_mfma_f32_16x16x32_bf16 v[32:35], a[24:27], a[72:75], v[32:35]
    ds_read_b64_tr_b16 a[42:43], v21 offset:7280
    v_mfma_f32_16x16x32_bf16 v[40:43], a[24:27], a[76:79], v[40:43]
    v_mfma_f32_16x16x32_bf16 v[48:51], a[24:27], a[80:83], v[48:51]
    v_mfma_f32_16x16x32_bf16 v[56:59], a[24:27], a[84:87], v[56:59]
    s_waitcnt lgkmcnt(6)
    v_mfma_f32_16x16x32_bf16 v[36:39], a[28:31], a[72:75], v[36:39]
    ds_read_b64_tr_b16 a[44:45], v20 offset:7312
    v_mfma_f32_16x16x32_bf16 v[44:47], a[28:31], a[76:79], v[44:47]
    ds_read_b64_tr_b16 a[46:47], v21 offset:7312
    s_mov_b64 exec, 1
    ds_add_u32 v6, v7
    s_mov_b64 exec, -1
    v_mfma_f32_16x16x32_bf16 v[52:55], a[28:31], a[80:83], v[52:55]
    v_mfma_f32_16x16x32_bf16 v[60:63], a[28:31], a[84:87], v[60:63]
    s_waitcnt lgkmcnt(7)
    v_mfma_f32_16x16x32_bf16 v[64:67], a[32:35], a[68:71], v[64:67]
    v_mfma_f32_16x16x32_bf16 v[72:75], a[32:35], a[72:75], v[72:75]
    v_mfma_f32_16x16x32_bf16 v[80:83], a[32:35], a[76:79], v[80:83]
    v_mfma_f32_16x16x32_bf16 v[88:91], a[32:35], a[80:83], v[88:91]
    v_mfma_f32_16x16x32_bf16 v[96:99], a[32:35], a[84:87], v[96:99]
    s_waitcnt lgkmcnt(5)
    v_mfma_f32_16x16x32_bf16 v[68:71], a[36:39], a[68:71], v[68:71]
    v_mfma_f32_16x16x32_bf16 v[76:79], a[36:39], a[72:75], v[76:79]
    v_mfma_f32_16x16x32_bf16 v[84:87], a[36:39], a[76:79], v[84:87]
    v_mfma_f32_16x16x32_bf16 v[92:95], a[36:39], a[80:83], v[92:95]
    v_mfma_f32_16x16x32_bf16 v[100:103], a[36:39], a[84:87], v[100:103]
    s_waitcnt lgkmcnt(3)
    v_mfma_f32_16x16x32_bf16 v[104:107], a[68:71], a[40:43], v[104:107]
    v_mfma_f32_16x16x32_bf16 v[108:111], a[72:75], a[40:43], v[108:111]
    v_mfma_f32_16x16x32_bf16 v[112:115], a[76:79], a[40:43], v[112:115]
    v_mfma_f32_16x16x32_bf16 v[116:119], a[80:83], a[40:43], v[116:119]
    v_mfma_f32_16x16x32_bf16 v[120:123], a[84:87], a[40:43], v[120:123]
    s_waitcnt lgkmcnt(1)
    v_mfma_f32_16x16x32_bf16 v[124:127], a[68:71], a[44:47], v[124:127]
    v_mfma_f32_16x16x32_bf16 v[128:131], a[72:75], a[44:47], v[128:131]
    v_mfma_f32_16x16x32_bf16 v[132:135], a[76:79], a[44:47], v[132:135]
    v_mfma_f32_16x16x32_bf16 v[136:139], a[80:83], a[44:47], v[136:139]
    v_mfma_f32_16x16x32_bf16 v[140:143], a[84:87], a[44:47], v[140:143]
    v_and_b32 v5, 15, v2
    v_lshrrev_b32 v6, 4, v2
    v_cmp_gt_u32 s[64:65], 3, v6
    v_readfirstlane_b32 s93, v31
    s_nop 3
    s_add_u32 s93, s93, 16
    s_and_b32 s61, s93, 0x7ff0
    s_or_b32 s61, s61, s92
    s_or_b32 s61, s61, 0x8000
    s_lshl_b32 s61, s61, 16
    v_and_b32 v3, 1, v5
    v_cmp_eq_u32 s[4:5], 1, v3
    v_mov_b32 v10, 0xffff
    v_mov_b32 v11, 0xffff0000
    v_cndmask_b32 v12, v10, v11, s[4:5]
    v_lshl_add_u32 v11, v6, 2, v3
    v_sub_u32 v11, v11, v5
    v_cvt_pk_bf16_f32 v32, v32, v33
    v_cvt_pk_bf16_f32 v33, v34, v35
    v_cvt_pk_bf16_f32 v34, v36, v37
    v_cvt_pk_bf16_f32 v35, v38, v39
    v_cndmask_b32 v34, 0, v34, s[64:65]
    v_cndmask_b32 v35, 0, v35, s[64:65]
    v_cvt_pk_bf16_f32 v40, v40, v41
    v_cvt_pk_bf16_f32 v41, v42, v43
    v_cvt_pk_bf16_f32 v42, v44, v45
    v_cvt_pk_bf16_f32 v43, v46, v47
    v_cndmask_b32 v42, 0, v42, s[64:65]
    v_cndmask_b32 v43, 0, v43, s[64:65]
    v_cvt_pk_bf16_f32 v48, v48, v49
    v_cvt_pk_bf16_f32 v49, v50, v51
    v_cvt_pk_bf16_f32 v50, v52, v53
    v_cvt_pk_bf16_f32 v51, v54, v55
    v_cndmask_b32 v50, 0, v50, s[64:65]
    v_cndmask_b32 v51, 0, v51, s[64:65]
    v_cvt_pk_bf16_f32 v56, v56, v57
    v_cvt_pk_bf16_f32 v57, v58, v59
    v_cvt_pk_bf16_f32 v58, v60, v61
    v_cvt_pk_bf16_f32 v59, v62, v63
    v_cndmask_b32 v58, 0, v58, s[64:65]
    v_cndmask_b32 v59, 0, v59, s[64:65]
    v_cvt_pk_bf16_f32 v64, v64, v65
    v_cvt_pk_bf16_f32 v65, v66, v67
    v_cvt_pk_bf16_f32 v66, v68, v69
    v_cvt_pk_bf16_f32 v67, v70, v71
    v_cvt_pk_bf16_f32 v72, v72, v73
    v_cvt_pk_bf16_f32 v73, v74, v75
    v_cvt_pk_bf16_f32 v74, v76, v77
    v_cvt_pk_bf16_f32 v75, v78, v79
    v_cvt_pk_bf16_f32 v80, v80, v81
    v_cvt_pk_bf16_f32 v81, v82, v83
    v_cvt_pk_bf16_f32 v82, v84, v85
    v_cvt_pk_bf16_f32 v83, v86, v87
    v_cvt_pk_bf16_f32 v88, v88, v89
    v_cvt_pk_bf16_f32 v89, v90, v91
    v_cvt_pk_bf16_f32 v90, v92, v93
    v_cvt_pk_bf16_f32 v91, v94, v95
    v_cvt_pk_bf16_f32 v96, v96, v97
    v_cvt_pk_bf16_f32 v97, v98, v99
    v_cvt_pk_bf16_f32 v98, v100, v101
    v_cvt_pk_bf16_f32 v99, v102, v103
    s_nop 1
    v_mfma_f32_16x16x32_bf16 v[36:39], v[64:67], v[32:35], 0
    v_mfma_f32_16x16x32_bf16 v[68:71], v[72:75], v[32:35], 0
    v_mfma_f32_16x16x32_bf16 v[44:47], v[72:75], v[40:43], 0
    v_mfma_f32_16x16x32_bf16 v[76:79], v[80:83], v[40:43], 0
    v_mfma_f32_16x16x32_bf16 v[52:55], v[80:83], v[48:51], 0
    v_mfma_f32_16x16x32_bf16 v[84:87], v[88:91], v[48:51], 0
    v_mfma_f32_16x16x32_bf16 v[60:63], v[88:91], v[56:59], 0
    v_mfma_f32_16x16x32_bf16 v[92:95], v[96:99], v[56:59], 0
    v_cvt_pk_bf16_f32 v104, v104, v105
    v_cvt_pk_bf16_f32 v105, v106, v107
    v_cvt_pk_bf16_f32 v106, v108, v109
    v_cvt_pk_bf16_f32 v107, v110, v111
    v_cvt_pk_bf16_f32 v108, v112, v113
    v_cvt_pk_bf16_f32 v109, v114, v115
    v_cvt_pk_bf16_f32 v110, v116, v117
    v_cvt_pk_bf16_f32 v111, v118, v119
    v_cvt_pk_bf16_f32 v112, v120, v121
    v_cvt_pk_bf16_f32 v113, v122, v123
    v_cvt_pk_bf16_f32 v124, v124, v125
    v_cvt_pk_bf16_f32 v125, v126, v127
    v_cvt_pk_bf16_f32 v126, v128, v129
    v_cvt_pk_bf16_f32 v127, v130, v131
    v_cvt_pk_bf16_f32 v128, v132, v133
    v_cvt_pk_bf16_f32 v129, v134, v135
    v_cvt_pk_bf16_f32 v130, v136, v137
    v_cvt_pk_bf16_f32 v131, v138, v139
    v_cvt_pk_bf16_f32 v132, v140, v141
    v_cvt_pk_bf16_f32 v133, v142, v143
    v_add_u32 v13, 0, v11
    v_cmp_le_i32 s[6:7], 2, v13
    v_cmp_ge_i32 vcc, 16, v13
    s_and_b64 s[6:7], s[6:7], vcc
    v_add_u32 v13, 2, v11
    v_cmp_le_i32 s[8:9], 2, v13
    v_cmp_ge_i32 vcc, 16, v13
    s_and_b64 s[8:9], s[8:9], vcc
    v_add_u32 v13, 16, v11
    v_cmp_le_i32 s[10:11], 2, v13
    v_cmp_ge_i32 vcc, 16, v13
    s_and_b64 s[10:11], s[10:11], vcc
    v_add_u32 v13, 18, v11
    v_cmp_le_i32 s[12:13], 2, v13
    v_cmp_ge_i32 vcc, 16, v13
    s_and_b64 s[12:13], s[12:13], vcc
    s_or_b32 s3, s25, s50
    s_cmp_eq_u32 s3, 0
    s_cselect_b64 s[14:15], 0, -1
    s_and_b64 s[16:17], s[6:7], s[14:15]
    s_and_b64 s[18:19], s[8:9], s[14:15]
    v_mov_b32 v13, 0xce6e6b28
    s_mov_b32 s20, 0x3e8b97f6
    s_lshl_b32 s3, s50, 13
    s_lshl_b32 s27, s49, 10
    s_add_u32 s3, s3, s27
    v_lshlrev_b32 v14, 4, v2
    v_add_u32 v14, s3, v14
    v_add_u32 v15, 0x1000, v14
    s_lshl_b32 s27, s26, 14
    s_add_u32 s63, s59, s27
    v_cmp_eq_u32 s[68:69], 3, v6
    v_cndmask_b32 v36, v36, v37, s[4:5]
    v_cndmask_b32 v44, v44, v45, s[4:5]
    v_cndmask_b32 v52, v52, v53, s[4:5]
    v_cndmask_b32 v60, v60, v61, s[4:5]
    v_cndmask_b32 v38, v38, v39, s[4:5]
    v_cndmask_b32 v46, v46, v47, s[4:5]
    v_cndmask_b32 v54, v54, v55, s[4:5]
    v_cndmask_b32 v62, v62, v63, s[4:5]
    v_cndmask_b32 v68, v68, v69, s[4:5]
    v_cndmask_b32 v76, v76, v77, s[4:5]
    v_cndmask_b32 v84, v84, v85, s[4:5]
    v_cndmask_b32 v92, v92, v93, s[4:5]
    v_cndmask_b32 v70, v70, v71, s[4:5]
    v_cndmask_b32 v78, v78, v79, s[4:5]
    v_cndmask_b32 v86, v86, v87, s[4:5]
    v_cndmask_b32 v94, v94, v95, s[4:5]
    v_cndmask_b32 v36, v13, v36, s[16:17]
    v_cndmask_b32 v44, v13, v44, s[6:7]
    v_cndmask_b32 v52, v13, v52, s[6:7]
    v_cndmask_b32 v60, v13, v60, s[6:7]
    v_cndmask_b32 v38, v13, v38, s[18:19]
    v_cndmask_b32 v46, v13, v46, s[8:9]
    v_cndmask_b32 v54, v13, v54, s[8:9]
    v_cndmask_b32 v62, v13, v62, s[8:9]
    v_cndmask_b32 v68, v13, v68, s[10:11]
    v_cndmask_b32 v76, v13, v76, s[10:11]
    v_cndmask_b32 v84, v13, v84, s[10:11]
    v_cndmask_b32 v92, v13, v92, s[10:11]
    v_cndmask_b32 v70, v13, v70, s[12:13]
    v_cndmask_b32 v78, v13, v78, s[12:13]
    v_cndmask_b32 v86, v13, v86, s[12:13]
    v_cndmask_b32 v94, v13, v94, s[12:13]
    v_max3_f32 v69, v36, v38, v68
    v_max3_f32 v77, v44, v46, v76
    v_max3_f32 v85, v52, v54, v84
    v_max3_f32 v93, v60, v62, v92
    v_max_f32 v69, v69, v70
    v_max_f32 v77, v77, v78
    v_max_f32 v85, v85, v86
    v_max_f32 v93, v93, v94
    v_mov_b32 v71, v69
    v_mov_b32 v79, v77
    v_mov_b32 v87, v85
    v_mov_b32 v95, v93
    v_permlane16_swap_b32 v69, v71
    v_permlane16_swap_b32 v77, v79
    v_permlane16_swap_b32 v85, v87
    v_permlane16_swap_b32 v93, v95
    v_max_f32 v69, v69, v71
    v_max_f32 v77, v77, v79
    v_max_f32 v85, v85, v87
    v_max_f32 v93, v93, v95
    v_mov_b32 v71, v69
    v_mov_b32 v79, v77
    v_mov_b32 v87, v85
    v_mov_b32 v95, v93
    v_permlane32_swap_b32 v69, v71
    v_permlane32_swap_b32 v77, v79
    v_permlane32_swap_b32 v85, v87
    v_permlane32_swap_b32 v93, v95
    v_max_f32 v69, v69, v71
    v_max_f32 v77, v77, v79
    v_max_f32 v85, v85, v87
    v_max_f32 v93, v93, v95
    v_mul_f32 v69, 0xbe8b97f6, v69
    v_mul_f32 v77, 0xbe8b97f6, v77
    v_mul_f32 v85, 0xbe8b97f6, v85
    v_mul_f32 v93, 0xbe8b97f6, v93
    v_fma_f32 v36, v36, s20, v69
    v_fma_f32 v44, v44, s20, v77
    v_fma_f32 v52, v52, s20, v85
    v_fma_f32 v60, v60, s20, v93
    v_fma_f32 v38, v38, s20, v69
    v_fma_f32 v46, v46, s20, v77
    v_fma_f32 v54, v54, s20, v85
    v_fma_f32 v62, v62, s20, v93
    v_fma_f32 v68, v68, s20, v69
    v_fma_f32 v76, v76, s20, v77
    v_fma_f32 v84, v84, s20, v85
    v_fma_f32 v92, v92, s20, v93
    v_fma_f32 v70, v70, s20, v69
    v_fma_f32 v78, v78, s20, v77
    v_fma_f32 v86, v86, s20, v85
    v_fma_f32 v94, v94, s20, v93
    v_exp_f32 v36, v36
    v_exp_f32 v44, v44
    v_exp_f32 v52, v52
    v_exp_f32 v60, v60
    v_exp_f32 v38, v38
    v_exp_f32 v46, v46
    v_exp_f32 v54, v54
    v_exp_f32 v62, v62
    v_exp_f32 v68, v68
    v_exp_f32 v76, v76
    v_exp_f32 v84, v84
    v_exp_f32 v92, v92
    v_exp_f32 v70, v70
    v_exp_f32 v78, v78
    v_exp_f32 v86, v86
    v_exp_f32 v94, v94
    v_add_f32 v69, v36, v38
    v_add_f32 v77, v44, v46
    v_add_f32 v85, v52, v54
    v_add_f32 v93, v60, v62
    v_add_f32 v71, v68, v70
    v_add_f32 v79, v76, v78
    v_add_f32 v87, v84, v86
    v_add_f32 v95, v92, v94
    v_add_f32 v69, v69, v71
    v_add_f32 v77, v77, v79
    v_add_f32 v85, v85, v87
    v_add_f32 v93, v93, v95
    v_mov_b32 v71, v69
    v_mov_b32 v79, v77
    v_mov_b32 v87, v85
    v_mov_b32 v95, v93
    v_permlane16_swap_b32 v69, v71
    v_permlane16_swap_b32 v77, v79
    v_permlane16_swap_b32 v85, v87
    v_permlane16_swap_b32 v93, v95
    v_add_f32 v69, v69, v71
    v_add_f32 v77, v77, v79
    v_add_f32 v85, v85, v87
    v_add_f32 v93, v93, v95
    v_mov_b32 v71, v69
    v_mov_b32 v79, v77
    v_mov_b32 v87, v85
    v_mov_b32 v95, v93
    v_permlane32_swap_b32 v69, v71
    v_permlane32_swap_b32 v77, v79
    v_permlane32_swap_b32 v85, v87
    v_permlane32_swap_b32 v93, v95
    v_add_f32 v69, v69, v71
    v_add_f32 v77, v77, v79
    v_add_f32 v85, v85, v87
    v_add_f32 v93, v93, v95
    v_rcp_f32 v69, v69
    v_rcp_f32 v77, v77
    v_rcp_f32 v85, v85
    v_rcp_f32 v93, v93
    v_mul_f32 v36, v36, v69
    v_mul_f32 v44, v44, v77
    v_mul_f32 v52, v52, v85
    v_mul_f32 v60, v60, v93
    v_cvt_pk_bf16_f32 v36, v36, v36
    v_cvt_pk_bf16_f32 v44, v44, v44
    v_cvt_pk_bf16_f32 v52, v52, v52
    v_cvt_pk_bf16_f32 v60, v60, v60
    v_and_b32 v36, v36, v12
    v_and_b32 v44, v44, v12
    v_and_b32 v52, v52, v12
    v_and_b32 v60, v60, v12
    v_mul_f32 v38, v38, v69
    v_mul_f32 v46, v46, v77
    v_mul_f32 v54, v54, v85
    v_mul_f32 v62, v62, v93
    v_cvt_pk_bf16_f32 v37, v38, v38
    v_cvt_pk_bf16_f32 v45, v46, v46
    v_cvt_pk_bf16_f32 v53, v54, v54
    v_cvt_pk_bf16_f32 v61, v62, v62
    v_and_b32 v37, v37, v12
    v_and_b32 v45, v45, v12
    v_and_b32 v53, v53, v12
    v_and_b32 v61, v61, v12
    v_mul_f32 v68, v68, v69
    v_mul_f32 v76, v76, v77
    v_mul_f32 v84, v84, v85
    v_mul_f32 v92, v92, v93
    v_cvt_pk_bf16_f32 v38, v68, v68
    v_cvt_pk_bf16_f32 v46, v76, v76
    v_cvt_pk_bf16_f32 v54, v84, v84
    v_cvt_pk_bf16_f32 v62, v92, v92
    v_and_b32 v38, v38, v12
    v_and_b32 v46, v46, v12
    v_and_b32 v54, v54, v12
    v_and_b32 v62, v62, v12
    v_mul_f32 v70, v70, v69
    v_mul_f32 v78, v78, v77
    v_mul_f32 v86, v86, v85
    v_mul_f32 v94, v94, v93
    v_cvt_pk_bf16_f32 v39, v70, v70
    v_cvt_pk_bf16_f32 v47, v78, v78
    v_cvt_pk_bf16_f32 v55, v86, v86
    v_cvt_pk_bf16_f32 v63, v94, v94
    v_and_b32 v39, v39, v12
    v_and_b32 v47, v47, v12
    v_and_b32 v55, v55, v12
    v_and_b32 v63, v63, v12
    v_lshlrev_b32 v26, 4, v2
    buffer_load_dwordx4 v[116:119], v26, s[40:43], s80 offen offset:0 nt
    buffer_load_dwordx4 v[120:123], v26, s[40:43], s80 offen offset:1024 nt
    s_nop 1
    v_mfma_f32_16x16x32_bf16 v[68:71], v[124:127], v[36:39], 0
    v_mfma_f32_16x16x32_bf16 v[32:35], v[104:107], v[36:39], 0
    v_mfma_f32_16x16x32_bf16 v[76:79], v[126:129], v[44:47], 0
    v_mfma_f32_16x16x32_bf16 v[40:43], v[106:109], v[44:47], 0
    v_mfma_f32_16x16x32_bf16 v[84:87], v[128:131], v[52:55], 0
    v_mfma_f32_16x16x32_bf16 v[48:51], v[108:111], v[52:55], 0
    v_mfma_f32_16x16x32_bf16 v[92:95], v[130:133], v[60:63], 0
    v_mfma_f32_16x16x32_bf16 v[56:59], v[110:113], v[60:63], 0
    s_nop 7
    v_mov_b32 v36, v71
    v_mov_b32 v44, v79
    v_mov_b32 v52, v87
    v_mov_b32 v60, v95
    v_cvt_pk_bf16_f32 v16, v32, v33
    v_cvt_pk_bf16_f32 v20, v40, v41
    v_cvt_pk_bf16_f32 v24, v48, v49
    v_cvt_pk_bf16_f32 v28, v56, v57
    v_permlane32_swap_b32 v37, v36
    v_permlane32_swap_b32 v45, v44
    v_permlane32_swap_b32 v53, v52
    v_permlane32_swap_b32 v61, v60
    v_permlane16_swap_b32 v38, v71
    v_permlane16_swap_b32 v46, v79
    v_permlane16_swap_b32 v54, v87
    v_permlane16_swap_b32 v62, v95
    v_cvt_pk_bf16_f32 v17, v34, v35
    v_cvt_pk_bf16_f32 v21, v42, v43
    v_cvt_pk_bf16_f32 v25, v50, v51
    v_cvt_pk_bf16_f32 v29, v58, v59
    v_permlane16_swap_b32 v39, v37
    v_permlane16_swap_b32 v47, v45
    v_permlane16_swap_b32 v55, v53
    v_permlane16_swap_b32 v63, v61
    v_cndmask_b32 v70, v70, v38, s[68:69]
    v_cndmask_b32 v78, v78, v46, s[68:69]
    v_cndmask_b32 v86, v86, v54, s[68:69]
    v_cndmask_b32 v94, v94, v62, s[68:69]
    v_cndmask_b32 v69, v69, v37, s[68:69]
    v_cndmask_b32 v77, v77, v45, s[68:69]
    v_cndmask_b32 v85, v85, v53, s[68:69]
    v_cndmask_b32 v93, v93, v61, s[68:69]
    v_cndmask_b32 v68, v68, v39, s[68:69]
    v_cndmask_b32 v76, v76, v47, s[68:69]
    v_cndmask_b32 v84, v84, v55, s[68:69]
    v_cndmask_b32 v92, v92, v63, s[68:69]
    v_cvt_pk_bf16_f32 v19, v70, v70
    v_cvt_pk_bf16_f32 v23, v78, v78
    v_cvt_pk_bf16_f32 v27, v86, v86
    v_cvt_pk_bf16_f32 v31, v94, v94
    v_cvt_pk_bf16_f32 v18, v68, v69
    v_cvt_pk_bf16_f32 v22, v76, v77
    v_cvt_pk_bf16_f32 v26, v84, v85
    v_cvt_pk_bf16_f32 v30, v92, v93
    v_and_or_b32 v19, v19, v10, s61
    v_and_or_b32 v23, v23, v10, s61
    v_and_or_b32 v27, v27, v10, s61
    v_and_or_b32 v31, v31, v10, s61
    buffer_store_dwordx4 v[16:19], v14, s[40:43], s63 offen offset:0
    buffer_store_dwordx4 v[20:23], v14, s[40:43], s63 offen offset:2048
    buffer_store_dwordx4 v[24:27], v15, s[40:43], s63 offen offset:0
    buffer_store_dwordx4 v[28:31], v15, s[40:43], s63 offen offset:2048
P2_BC:
    v_lshlrev_b32 v6, 4, v2
    v_mov_b32 v3, 161792
    v_add_u32 v5, 62720, v8
    v_add_u32 v7, 62720, v9
SP_30:
    ds_read_b32 v13, v3 offset:4
    s_waitcnt lgkmcnt(0)
    v_readfirstlane_b32 s3, v13
    s_nop 3
    s_cmp_eq_u32 s3, 4
    s_cbranch_scc1 SD_31
    s_sleep 1
    s_branch SP_30
SD_31:
    ds_read_b64_tr_b16 a[0:1], v8 offset:0
    v_and_b32 v13, 15, v2
    ds_read_b64_tr_b16 a[2:3], v9 offset:0
    v_lshrrev_b32 v15, 4, v2
    ds_read_b64_tr_b16 a[4:5], v8 offset:32
    v_mul_u32_u24 v13, 1792, v13
    ds_read_b64_tr_b16 a[6:7], v9 offset:32
    v_and_b32 v10, 1, v15
    ds_read_b64_tr_b16 a[8:9], v8 offset:64
    v_lshl_add_u32 v14, v15, 3, v13
    ds_read_b64_tr_b16 a[10:11], v9 offset:64
    v_lshl_add_u32 v10, v10, 5, v13
    ds_read_b64_tr_b16 a[12:13], v8 offset:96
    v_lshrrev_b32 v15, 1, v15
    ds_read_b64_tr_b16 a[14:15], v9 offset:96
    s_and_b32 s3, s48, 3
    ds_read_b64_tr_b16 a[16:17], v8 offset:128
    v_lshl_add_u32 v10, v15, 4, v10
    ds_read_b64_tr_b16 a[18:19], v9 offset:128
    s_lshl_b32 s27, s3, 3
    ds_read_b64_tr_b16 a[20:21], v8 offset:160
    s_mul_i32 s3, s3, 7168
    ds_read_b64_tr_b16 a[22:23], v9 offset:160
    s_add_u32 s27, s27, 161808
    ds_read_b64_tr_b16 a[24:25], v8 offset:192
    s_add_u32 s3, s3, 0
    ds_read_b64_tr_b16 a[26:27], v9 offset:192
    v_mov_b32 v11, s27
    ds_read_b64_tr_b16 v[76:77], v8 offset:6272
    v_add_u32 v12, s3, v6
    ds_read_b64_tr_b16 v[78:79], v9 offset:6272
    v_mov_b32 v4, 1
    ds_read_b64_tr_b16 v[80:81], v8 offset:6304
    s_mov_b32 s78, 0
    ds_read_b64_tr_b16 v[82:83], v9 offset:6304
    s_mov_b32 s79, 15
    ds_read_b64_tr_b16 v[84:85], v8 offset:6336
    s_mov_b32 s68, 0x10000
    ds_read_b64_tr_b16 v[86:87], v9 offset:6336
    ds_read_b64_tr_b16 v[124:125], v8 offset:6368
    ds_read_b64_tr_b16 v[126:127], v9 offset:6368
    ds_read_b64_tr_b16 v[128:129], v8 offset:6400
    ds_read_b64_tr_b16 v[130:131], v9 offset:6400
    ds_read_b64_tr_b16 v[132:133], v8 offset:6432
    ds_read_b64_tr_b16 v[134:135], v9 offset:6432
    ds_read_b64_tr_b16 v[136:137], v8 offset:6464
    ds_read_b64_tr_b16 v[138:139], v9 offset:6464
    ds_read_b64_tr_b16 a[28:29], v8 offset:12544
    ds_read_b64_tr_b16 a[30:31], v9 offset:12544
    ds_read_b64_tr_b16 a[32:33], v8 offset:12576
    ds_read_b64_tr_b16 a[34:35], v9 offset:12576
    ds_read_b64_tr_b16 a[36:37], v8 offset:12608
    ds_read_b64_tr_b16 a[38:39], v9 offset:12608
    ds_read_b64_tr_b16 a[40:41], v8 offset:12640
    ds_read_b64_tr_b16 a[42:43], v9 offset:12640
    ds_read_b64_tr_b16 a[44:45], v8 offset:12672
    ds_read_b64_tr_b16 a[46:47], v9 offset:12672
    ds_read_b64_tr_b16 a[48:49], v8 offset:12704
    ds_read_b64_tr_b16 a[50:51], v9 offset:12704
    s_waitcnt vmcnt(4)
    v_xor_b32 v119, s61, v119
    v_xor_b32 v123, s61, v123
    v_or_b32 v13, v119, v123
    v_cmp_gt_u32 vcc, s68, v13
    s_cmp_eq_u64 vcc, -1
    s_cbranch_scc0 F0_29
    s_bitset0_b32 s79, 0
    s_waitcnt lgkmcnt(12)
    v_mfma_f32_16x16x32_bf16 v[16:19], a[0:3], v[116:119], 0
    ds_read_b64_tr_b16 a[52:53], v8 offset:12736
    ds_read_b64_tr_b16 a[54:55], v9 offset:12736
    ds_read_b64_tr_b16 a[56:57], v5 offset:0
    ds_read_b64_tr_b16 a[58:59], v7 offset:0
    v_mfma_f32_16x16x32_bf16 v[20:23], a[4:7], v[116:119], 0
    ds_read_b64_tr_b16 a[60:61], v5 offset:32
    ds_read_b64_tr_b16 a[62:63], v7 offset:32
    ds_read_b64_tr_b16 a[64:65], v5 offset:64
    ds_read_b64_tr_b16 a[66:67], v7 offset:64
    v_mfma_f32_16x16x32_bf16 v[24:27], a[8:11], v[116:119], 0
    ds_read_b64_tr_b16 a[68:69], v5 offset:96
    ds_read_b64_tr_b16 a[70:71], v7 offset:96
    ds_read_b64_tr_b16 a[72:73], v5 offset:128
    ds_read_b64_tr_b16 a[74:75], v7 offset:128
    v_mfma_f32_16x16x32_bf16 v[28:31], a[12:15], v[116:119], 0
    ds_read_b64_tr_b16 a[76:77], v5 offset:160
    ds_read_b64_tr_b16 a[78:79], v7 offset:160
    ds_read_b64_tr_b16 a[80:81], v5 offset:192
    ds_read_b64_tr_b16 a[82:83], v7 offset:192
    v_mfma_f32_16x16x32_bf16 v[32:35], a[16:19], v[116:119], 0
    ds_read_b64_tr_b16 a[84:85], v5 offset:12544
    ds_read_b64_tr_b16 a[86:87], v7 offset:12544
    ds_read_b64_tr_b16 a[88:89], v5 offset:12576
    ds_read_b64_tr_b16 a[90:91], v7 offset:12576
    v_mfma_f32_16x16x32_bf16 v[36:39], a[20:23], v[116:119], 0
    ds_read_b64_tr_b16 a[92:93], v5 offset:12608
    ds_read_b64_tr_b16 a[94:95], v7 offset:12608
    buffer_load_dwordx4 v[52:55], v6, s[40:43], s81 offen offset:0 nt
    buffer_load_dwordx4 v[56:59], v6, s[40:43], s81 offen offset:1024 nt
    buffer_load_dwordx4 v[60:63], v6, s[40:43], s82 offen offset:0 nt
    buffer_load_dwordx4 v[64:67], v6, s[40:43], s82 offen offset:1024 nt
    buffer_load_dwordx4 v[68:71], v6, s[40:43], s83 offen offset:0 nt
    buffer_load_dwordx4 v[72:75], v6, s[40:43], s83 offen offset:1024 nt
    ds_read_b64_tr_b16 a[96:97], v5 offset:12640
    ds_read_b64_tr_b16 a[98:99], v7 offset:12640
    v_mfma_f32_16x16x32_bf16 v[40:43], a[24:27], v[116:119], 0
    ds_read_b64_tr_b16 a[100:101], v5 offset:12672
    ds_read_b64_tr_b16 a[102:103], v7 offset:12672
    ds_read_b64_tr_b16 a[104:105], v5 offset:12704
    ds_read_b64_tr_b16 a[106:107], v7 offset:12704
    v_mfma_f32_16x16x32_bf16 v[16:19], v[76:79], v[120:123], v[16:19]
    ds_read_b64_tr_b16 a[108:109], v5 offset:12736
    ds_read_b64_tr_b16 a[110:111], v7 offset:12736
    ds_read_b64_tr_b16 v[88:89], v8 offset:18816
    ds_read_b64_tr_b16 v[90:91], v9 offset:18816
    v_mfma_f32_16x16x32_bf16 v[20:23], v[80:83], v[120:123], v[20:23]
    ds_read_b64_tr_b16 v[92:93], v8 offset:18848
    ds_read_b64_tr_b16 v[94:95], v9 offset:18848
    ds_read_b64_tr_b16 v[96:97], v8 offset:18880
    ds_read_b64_tr_b16 v[98:99], v9 offset:18880
    v_mfma_f32_16x16x32_bf16 v[24:27], v[84:87], v[120:123], v[24:27]
    ds_read_b64_tr_b16 v[100:101], v5 offset:6272
    ds_read_b64_tr_b16 v[102:103], v7 offset:6272
    ds_read_b64_tr_b16 v[104:105], v5 offset:6304
    ds_read_b64_tr_b16 v[106:107], v7 offset:6304
    v_mfma_f32_16x16x32_bf16 v[28:31], v[124:127], v[120:123], v[28:31]
    ds_read_b64_tr_b16 v[108:109], v5 offset:6336
    ds_read_b64_tr_b16 v[110:111], v7 offset:6336
    ds_read_b64_tr_b16 v[112:113], v5 offset:18816
    ds_read_b64_tr_b16 v[114:115], v7 offset:18816
    v_mfma_f32_16x16x32_bf16 v[32:35], v[128:131], v[120:123], v[32:35]
    v_mfma_f32_16x16x32_bf16 v[36:39], v[132:135], v[120:123], v[36:39]
    v_mfma_f32_16x16x32_bf16 v[40:43], v[136:139], v[120:123], v[40:43]
    ds_read_b64_tr_b16 v[116:117], v5 offset:18848
    ds_read_b64_tr_b16 v[118:119], v7 offset:18848
    ds_read_b64_tr_b16 v[120:121], v5 offset:18880
    ds_read_b64_tr_b16 v[122:123], v7 offset:18880
    buffer_load_dword v3, off, s[40:43], s80
    buffer_load_dword v3, off, s[40:43], s80
    s_branch CK_12
F0_29:
    ds_read_b64_tr_b16 a[52:53], v8 offset:12736
    v_mov_b32 v16, 0
    ds_read_b64_tr_b16 a[54:55], v9 offset:12736
    v_mov_b32 v17, 0
    ds_read_b64_tr_b16 a[56:57], v5 offset:0
    v_mov_b32 v18, 0
    ds_read_b64_tr_b16 a[58:59], v7 offset:0
    v_mov_b32 v19, 0
    ds_read_b64_tr_b16 a[60:61], v5 offset:32
    v_mov_b32 v20, 0
    ds_read_b64_tr_b16 a[62:63], v7 offset:32
    v_mov_b32 v21, 0
    ds_read_b64_tr_b16 a[64:65], v5 offset:64
    v_mov_b32 v22, 0
    ds_read_b64_tr_b16 a[66:67], v7 offset:64
    v_mov_b32 v23, 0
    ds_read_b64_tr_b16 a[68:69], v5 offset:96
    v_mov_b32 v24, 0
    ds_read_b64_tr_b16 a[70:71], v7 offset:96
    v_mov_b32 v25, 0
    ds_read_b64_tr_b16 a[72:73], v5 offset:128
    v_mov_b32 v26, 0
    ds_read_b64_tr_b16 a[74:75], v7 offset:128
    v_mov_b32 v27, 0
    ds_read_b64_tr_b16 a[76:77], v5 offset:160
    v_mov_b32 v28, 0
    ds_read_b64_tr_b16 a[78:79], v7 offset:160
    v_mov_b32 v29, 0
    ds_read_b64_tr_b16 a[80:81], v5 offset:192
    v_mov_b32 v30, 0
    ds_read_b64_tr_b16 a[82:83], v7 offset:192
    v_mov_b32 v31, 0
    ds_read_b64_tr_b16 a[84:85], v5 offset:12544
    v_mov_b32 v32, 0
    ds_read_b64_tr_b16 a[86:87], v7 offset:12544
    v_mov_b32 v33, 0
    ds_read_b64_tr_b16 a[88:89], v5 offset:12576
    v_mov_b32 v34, 0
    ds_read_b64_tr_b16 a[90:91], v7 offset:12576
    v_mov_b32 v35, 0
    ds_read_b64_tr_b16 a[92:93], v5 offset:12608
    v_mov_b32 v36, 0
    ds_read_b64_tr_b16 a[94:95], v7 offset:12608
    v_mov_b32 v37, 0
    buffer_load_dwordx4 v[44:47], v6, s[40:43], s80 offen offset:0 nt
    buffer_load_dwordx4 v[48:51], v6, s[40:43], s80 offen offset:1024 nt
    buffer_load_dwordx4 v[52:55], v6, s[40:43], s81 offen offset:0 nt
    buffer_load_dwordx4 v[56:59], v6, s[40:43], s81 offen offset:1024 nt
    buffer_load_dwordx4 v[60:63], v6, s[40:43], s82 offen offset:0 nt
    buffer_load_dwordx4 v[64:67], v6, s[40:43], s82 offen offset:1024 nt
    buffer_load_dwordx4 v[68:71], v6, s[40:43], s83 offen offset:0 nt
    buffer_load_dwordx4 v[72:75], v6, s[40:43], s83 offen offset:1024 nt
    ds_read_b64_tr_b16 a[96:97], v5 offset:12640
    v_mov_b32 v38, 0
    ds_read_b64_tr_b16 a[98:99], v7 offset:12640
    v_mov_b32 v39, 0
    ds_read_b64_tr_b16 a[100:101], v5 offset:12672
    v_mov_b32 v40, 0
    ds_read_b64_tr_b16 a[102:103], v7 offset:12672
    v_mov_b32 v41, 0
    ds_read_b64_tr_b16 a[104:105], v5 offset:12704
    v_mov_b32 v42, 0
    ds_read_b64_tr_b16 a[106:107], v7 offset:12704
    v_mov_b32 v43, 0
    ds_read_b64_tr_b16 a[108:109], v5 offset:12736
    ds_read_b64_tr_b16 a[110:111], v7 offset:12736
    ds_read_b64_tr_b16 v[88:89], v8 offset:18816
    ds_read_b64_tr_b16 v[90:91], v9 offset:18816
    ds_read_b64_tr_b16 v[92:93], v8 offset:18848
    ds_read_b64_tr_b16 v[94:95], v9 offset:18848
    ds_read_b64_tr_b16 v[96:97], v8 offset:18880
    ds_read_b64_tr_b16 v[98:99], v9 offset:18880
    ds_read_b64_tr_b16 v[100:101], v5 offset:6272
    ds_read_b64_tr_b16 v[102:103], v7 offset:6272
    ds_read_b64_tr_b16 v[104:105], v5 offset:6304
    ds_read_b64_tr_b16 v[106:107], v7 offset:6304
    ds_read_b64_tr_b16 v[108:109], v5 offset:6336
    ds_read_b64_tr_b16 v[110:111], v7 offset:6336
    ds_read_b64_tr_b16 v[112:113], v5 offset:18816
    ds_read_b64_tr_b16 v[114:115], v7 offset:18816
    ds_read_b64_tr_b16 v[116:117], v5 offset:18848
    ds_read_b64_tr_b16 v[118:119], v7 offset:18848
    ds_read_b64_tr_b16 v[120:121], v5 offset:18880
    ds_read_b64_tr_b16 v[122:123], v7 offset:18880
CK_7:
    s_waitcnt vmcnt(6)
    v_xor_b32 v47, s61, v47
    v_xor_b32 v51, s61, v51
    v_or_b32 v13, v47, v51
    v_cmp_gt_u32 vcc, s68, v13
    s_cmp_eq_u64 vcc, -1
    s_cselect_b32 s3, s79, 0
    s_bitcmp1_b32 s3, 0
    s_cbranch_scc0 SL_9
    s_waitcnt lgkmcnt(15)
RN_8:
    s_bitset0_b32 s79, 0
    s_cmp_eq_u32 s79, 0
    v_mfma_f32_16x16x32_bf16 v[16:19], a[0:3], v[44:47], v[16:19]
    ds_read_b64_tr_b16 v[124:125], v8 offset:6368
    ds_read_b64_tr_b16 v[126:127], v9 offset:6368
    v_mfma_f32_16x16x32_bf16 v[20:23], a[4:7], v[44:47], v[20:23]
    ds_read_b64_tr_b16 v[128:129], v8 offset:6400
    ds_read_b64_tr_b16 v[130:131], v9 offset:6400
    v_mfma_f32_16x16x32_bf16 v[24:27], a[8:11], v[44:47], v[24:27]
    ds_read_b64_tr_b16 v[132:133], v8 offset:6432
    ds_read_b64_tr_b16 v[134:135], v9 offset:6432
    v_mfma_f32_16x16x32_bf16 v[28:31], a[12:15], v[44:47], v[28:31]
    ds_read_b64_tr_b16 v[136:137], v8 offset:6464
    ds_read_b64_tr_b16 v[138:139], v9 offset:6464
    v_mfma_f32_16x16x32_bf16 v[32:35], a[16:19], v[44:47], v[32:35]
    buffer_load_dword v3, off, s[40:43], s80
    v_mfma_f32_16x16x32_bf16 v[36:39], a[20:23], v[44:47], v[36:39]
    buffer_load_dword v3, off, s[40:43], s80
    v_mfma_f32_16x16x32_bf16 v[40:43], a[24:27], v[44:47], v[40:43]
    s_waitcnt lgkmcnt(8)
    v_mfma_f32_16x16x32_bf16 v[16:19], v[76:79], v[48:51], v[16:19]
    v_mfma_f32_16x16x32_bf16 v[20:23], v[80:83], v[48:51], v[20:23]
    v_mfma_f32_16x16x32_bf16 v[24:27], v[84:87], v[48:51], v[24:27]
    s_cbranch_scc1 LS_11
    s_waitcnt vmcnt(6)
    v_xor_b32 v55, s61, v55
    s_waitcnt lgkmcnt(6)
    v_mfma_f32_16x16x32_bf16 v[28:31], v[124:127], v[48:51], v[28:31]
    v_xor_b32 v59, s61, v59
    v_or_b32 v13, v55, v59
    s_waitcnt lgkmcnt(4)
    v_mfma_f32_16x16x32_bf16 v[32:35], v[128:131], v[48:51], v[32:35]
    v_cmp_gt_u32 vcc, s68, v13
    s_cmp_eq_u64 vcc, -1
    s_waitcnt lgkmcnt(2)
    v_mfma_f32_16x16x32_bf16 v[36:39], v[132:135], v[48:51], v[36:39]
    s_cselect_b32 s3, s79, 0
    s_bitcmp1_b32 s3, 1
    s_waitcnt lgkmcnt(0)
    v_mfma_f32_16x16x32_bf16 v[40:43], v[136:139], v[48:51], v[40:43]
    s_cbranch_scc1 RN_13
    s_branch SL_14
LS_11:
    s_waitcnt lgkmcnt(0)
    s_mov_b64 exec, 1
    ds_add_rtn_u32 v15, v11, v4
    ds_read_b32 v13, v11 offset:4
    s_mov_b64 exec, -1
    v_mfma_f32_16x16x32_bf16 v[28:31], v[124:127], v[48:51], v[28:31]
    ds_read_b128 v[76:79], v12 offset:0
    ds_read_b128 v[80:83], v12 offset:1024
    v_mfma_f32_16x16x32_bf16 v[32:35], v[128:131], v[48:51], v[32:35]
    ds_read_b128 v[84:87], v12 offset:2048
    ds_read_b128 v[88:91], v12 offset:3072
    v_mfma_f32_16x16x32_bf16 v[36:39], v[132:135], v[48:51], v[36:39]
    ds_read_b128 v[92:95], v12 offset:4096
    ds_read_b128 v[96:99], v12 offset:5120
    v_mfma_f32_16x16x32_bf16 v[40:43], v[136:139], v[48:51], v[40:43]
    ds_read_b128 v[100:103], v12 offset:6144
    s_branch PDN_27
SL_9:
    s_bitcmp1_b32 s79, 0
    s_cbranch_scc0 DM_10
    s_sleep 2
    buffer_load_dwordx4 v[44:47], v6, s[40:43], s80 offen offset:0 nt
    buffer_load_dwordx4 v[48:51], v6, s[40:43], s80 offen offset:1024 nt
    s_branch NX_32
DM_10:
    buffer_load_dword v3, off, s[40:43], s80
    buffer_load_dword v3, off, s[40:43], s80
NX_32:
CK_12:
    s_waitcnt vmcnt(6)
    v_xor_b32 v55, s61, v55
    v_xor_b32 v59, s61, v59
    v_or_b32 v13, v55, v59
    v_cmp_gt_u32 vcc, s68, v13
    s_cmp_eq_u64 vcc, -1
    s_cselect_b32 s3, s79, 0
    s_bitcmp1_b32 s3, 1
    s_cbranch_scc0 SL_14
    s_waitcnt lgkmcnt(15)
RN_13:
    s_bitset0_b32 s79, 1
    s_cmp_eq_u32 s79, 0
    v_mfma_f32_16x16x32_bf16 v[16:19], a[28:31], v[52:55], v[16:19]
    ds_read_b64_tr_b16 v[124:125], v8 offset:18912
    ds_read_b64_tr_b16 v[126:127], v9 offset:18912
    v_mfma_f32_16x16x32_bf16 v[20:23], a[32:35], v[52:55], v[20:23]
    ds_read_b64_tr_b16 v[128:129], v8 offset:18944
    ds_read_b64_tr_b16 v[130:131], v9 offset:18944
    v_mfma_f32_16x16x32_bf16 v[24:27], a[36:39], v[52:55], v[24:27]
    ds_read_b64_tr_b16 v[132:133], v8 offset:18976
    ds_read_b64_tr_b16 v[134:135], v9 offset:18976
    v_mfma_f32_16x16x32_bf16 v[28:31], a[40:43], v[52:55], v[28:31]
    ds_read_b64_tr_b16 v[136:137], v8 offset:19008
    ds_read_b64_tr_b16 v[138:139], v9 offset:19008
    v_mfma_f32_16x16x32_bf16 v[32:35], a[44:47], v[52:55], v[32:35]
    buffer_load_dword v3, off, s[40:43], s81
    v_mfma_f32_16x16x32_bf16 v[36:39], a[48:51], v[52:55], v[36:39]
    buffer_load_dword v3, off, s[40:43], s81
    v_mfma_f32_16x16x32_bf16 v[40:43], a[52:55], v[52:55], v[40:43]
    s_waitcnt lgkmcnt(8)
    v_mfma_f32_16x16x32_bf16 v[16:19], v[88:91], v[56:59], v[16:19]
    v_mfma_f32_16x16x32_bf16 v[20:23], v[92:95], v[56:59], v[20:23]
    v_mfma_f32_16x16x32_bf16 v[24:27], v[96:99], v[56:59], v[24:27]
    s_cbranch_scc1 LS_16
    s_waitcnt vmcnt(6)
    v_xor_b32 v63, s61, v63
    s_waitcnt lgkmcnt(6)
    v_mfma_f32_16x16x32_bf16 v[28:31], v[124:127], v[56:59], v[28:31]
    v_xor_b32 v67, s61, v67
    v_or_b32 v13, v63, v67
    s_waitcnt lgkmcnt(4)
    v_mfma_f32_16x16x32_bf16 v[32:35], v[128:131], v[56:59], v[32:35]
    v_cmp_gt_u32 vcc, s68, v13
    s_cmp_eq_u64 vcc, -1
    s_waitcnt lgkmcnt(2)
    v_mfma_f32_16x16x32_bf16 v[36:39], v[132:135], v[56:59], v[36:39]
    s_cselect_b32 s3, s79, 0
    s_bitcmp1_b32 s3, 2
    s_waitcnt lgkmcnt(0)
    v_mfma_f32_16x16x32_bf16 v[40:43], v[136:139], v[56:59], v[40:43]
    s_cbranch_scc1 RN_18
    s_branch SL_19
LS_16:
    s_waitcnt lgkmcnt(0)
    s_mov_b64 exec, 1
    ds_add_rtn_u32 v15, v11, v4
    ds_read_b32 v13, v11 offset:4
    s_mov_b64 exec, -1
    v_mfma_f32_16x16x32_bf16 v[28:31], v[124:127], v[56:59], v[28:31]
    ds_read_b128 v[76:79], v12 offset:0
    ds_read_b128 v[80:83], v12 offset:1024
    v_mfma_f32_16x16x32_bf16 v[32:35], v[128:131], v[56:59], v[32:35]
    ds_read_b128 v[84:87], v12 offset:2048
    ds_read_b128 v[88:91], v12 offset:3072
    v_mfma_f32_16x16x32_bf16 v[36:39], v[132:135], v[56:59], v[36:39]
    ds_read_b128 v[92:95], v12 offset:4096
    ds_read_b128 v[96:99], v12 offset:5120
    v_mfma_f32_16x16x32_bf16 v[40:43], v[136:139], v[56:59], v[40:43]
    ds_read_b128 v[100:103], v12 offset:6144
    s_branch PDN_27
SL_14:
    s_bitcmp1_b32 s79, 1
    s_cbranch_scc0 DM_15
    s_sleep 2
    buffer_load_dwordx4 v[52:55], v6, s[40:43], s81 offen offset:0 nt
    buffer_load_dwordx4 v[56:59], v6, s[40:43], s81 offen offset:1024 nt
    s_branch NX_33
DM_15:
    buffer_load_dword v3, off, s[40:43], s81
    buffer_load_dword v3, off, s[40:43], s81
NX_33:
CK_17:
    s_waitcnt vmcnt(6)
    v_xor_b32 v63, s61, v63
    v_xor_b32 v67, s61, v67
    v_or_b32 v13, v63, v67
    v_cmp_gt_u32 vcc, s68, v13
    s_cmp_eq_u64 vcc, -1
    s_cselect_b32 s3, s79, 0
    s_bitcmp1_b32 s3, 2
    s_cbranch_scc0 SL_19
    s_waitcnt lgkmcnt(15)
RN_18:
    s_bitset0_b32 s79, 2
    s_cmp_eq_u32 s79, 0
    v_mfma_f32_16x16x32_bf16 v[16:19], a[56:59], v[60:63], v[16:19]
    ds_read_b64_tr_b16 v[124:125], v5 offset:6368
    ds_read_b64_tr_b16 v[126:127], v7 offset:6368
    v_mfma_f32_16x16x32_bf16 v[20:23], a[60:63], v[60:63], v[20:23]
    ds_read_b64_tr_b16 v[128:129], v5 offset:6400
    ds_read_b64_tr_b16 v[130:131], v7 offset:6400
    v_mfma_f32_16x16x32_bf16 v[24:27], a[64:67], v[60:63], v[24:27]
    ds_read_b64_tr_b16 v[132:133], v5 offset:6432
    ds_read_b64_tr_b16 v[134:135], v7 offset:6432
    v_mfma_f32_16x16x32_bf16 v[28:31], a[68:71], v[60:63], v[28:31]
    ds_read_b64_tr_b16 v[136:137], v5 offset:6464
    ds_read_b64_tr_b16 v[138:139], v7 offset:6464
    v_mfma_f32_16x16x32_bf16 v[32:35], a[72:75], v[60:63], v[32:35]
    buffer_load_dword v3, off, s[40:43], s82
    v_mfma_f32_16x16x32_bf16 v[36:39], a[76:79], v[60:63], v[36:39]
    buffer_load_dword v3, off, s[40:43], s82
    v_mfma_f32_16x16x32_bf16 v[40:43], a[80:83], v[60:63], v[40:43]
    s_waitcnt lgkmcnt(8)
    v_mfma_f32_16x16x32_bf16 v[16:19], v[100:103], v[64:67], v[16:19]
    v_mfma_f32_16x16x32_bf16 v[20:23], v[104:107], v[64:67], v[20:23]
    v_mfma_f32_16x16x32_bf16 v[24:27], v[108:111], v[64:67], v[24:27]
    s_cbranch_scc1 LS_21
    s_waitcnt vmcnt(6)
    v_xor_b32 v71, s61, v71
    s_waitcnt lgkmcnt(6)
    v_mfma_f32_16x16x32_bf16 v[28:31], v[124:127], v[64:67], v[28:31]
    v_xor_b32 v75, s61, v75
    v_or_b32 v13, v71, v75
    s_waitcnt lgkmcnt(4)
    v_mfma_f32_16x16x32_bf16 v[32:35], v[128:131], v[64:67], v[32:35]
    v_cmp_gt_u32 vcc, s68, v13
    s_cmp_eq_u64 vcc, -1
    s_waitcnt lgkmcnt(2)
    v_mfma_f32_16x16x32_bf16 v[36:39], v[132:135], v[64:67], v[36:39]
    s_cselect_b32 s3, s79, 0
    s_bitcmp1_b32 s3, 3
    s_waitcnt lgkmcnt(0)
    v_mfma_f32_16x16x32_bf16 v[40:43], v[136:139], v[64:67], v[40:43]
    s_cbranch_scc1 RN_23
    s_branch SL_24
LS_21:
    s_waitcnt lgkmcnt(0)
    s_mov_b64 exec, 1
    ds_add_rtn_u32 v15, v11, v4
    ds_read_b32 v13, v11 offset:4
    s_mov_b64 exec, -1
    v_mfma_f32_16x16x32_bf16 v[28:31], v[124:127], v[64:67], v[28:31]
    ds_read_b128 v[76:79], v12 offset:0
    ds_read_b128 v[80:83], v12 offset:1024
    v_mfma_f32_16x16x32_bf16 v[32:35], v[128:131], v[64:67], v[32:35]
    ds_read_b128 v[84:87], v12 offset:2048
    ds_read_b128 v[88:91], v12 offset:3072
    v_mfma_f32_16x16x32_bf16 v[36:39], v[132:135], v[64:67], v[36:39]
    ds_read_b128 v[92:95], v12 offset:4096
    ds_read_b128 v[96:99], v12 offset:5120
    v_mfma_f32_16x16x32_bf16 v[40:43], v[136:139], v[64:67], v[40:43]
    ds_read_b128 v[100:103], v12 offset:6144
    s_branch PDN_27
SL_19:
    s_bitcmp1_b32 s79, 2
    s_cbranch_scc0 DM_20
    s_sleep 2
    buffer_load_dwordx4 v[60:63], v6, s[40:43], s82 offen offset:0 nt
    buffer_load_dwordx4 v[64:67], v6, s[40:43], s82 offen offset:1024 nt
    s_branch NX_34
DM_20:
    buffer_load_dword v3, off, s[40:43], s82
    buffer_load_dword v3, off, s[40:43], s82
NX_34:
CK_22:
    s_waitcnt vmcnt(6)
    v_xor_b32 v71, s61, v71
    v_xor_b32 v75, s61, v75
    v_or_b32 v13, v71, v75
    v_cmp_gt_u32 vcc, s68, v13
    s_cmp_eq_u64 vcc, -1
    s_cselect_b32 s3, s79, 0
    s_bitcmp1_b32 s3, 3
    s_cbranch_scc0 SL_24
    s_waitcnt lgkmcnt(15)
RN_23:
    s_bitset0_b32 s79, 3
    s_cmp_eq_u32 s79, 0
    v_mfma_f32_16x16x32_bf16 v[16:19], a[84:87], v[68:71], v[16:19]
    ds_read_b64_tr_b16 v[124:125], v5 offset:18912
    ds_read_b64_tr_b16 v[126:127], v7 offset:18912
    v_mfma_f32_16x16x32_bf16 v[20:23], a[88:91], v[68:71], v[20:23]
    ds_read_b64_tr_b16 v[128:129], v5 offset:18944
    ds_read_b64_tr_b16 v[130:131], v7 offset:18944
    v_mfma_f32_16x16x32_bf16 v[24:27], a[92:95], v[68:71], v[24:27]
    ds_read_b64_tr_b16 v[132:133], v5 offset:18976
    ds_read_b64_tr_b16 v[134:135], v7 offset:18976
    v_mfma_f32_16x16x32_bf16 v[28:31], a[96:99], v[68:71], v[28:31]
    ds_read_b64_tr_b16 v[136:137], v5 offset:19008
    ds_read_b64_tr_b16 v[138:139], v7 offset:19008
    v_mfma_f32_16x16x32_bf16 v[32:35], a[100:103], v[68:71], v[32:35]
    buffer_load_dword v3, off, s[40:43], s83
    v_mfma_f32_16x16x32_bf16 v[36:39], a[104:107], v[68:71], v[36:39]
    buffer_load_dword v3, off, s[40:43], s83
    v_mfma_f32_16x16x32_bf16 v[40:43], a[108:111], v[68:71], v[40:43]
    s_waitcnt lgkmcnt(8)
    v_mfma_f32_16x16x32_bf16 v[16:19], v[112:115], v[72:75], v[16:19]
    v_mfma_f32_16x16x32_bf16 v[20:23], v[116:119], v[72:75], v[20:23]
    v_mfma_f32_16x16x32_bf16 v[24:27], v[120:123], v[72:75], v[24:27]
    s_cbranch_scc1 LS_26
    s_waitcnt vmcnt(6)
    v_xor_b32 v47, s61, v47
    s_waitcnt lgkmcnt(6)
    v_mfma_f32_16x16x32_bf16 v[28:31], v[124:127], v[72:75], v[28:31]
    v_xor_b32 v51, s61, v51
    v_or_b32 v13, v47, v51
    s_waitcnt lgkmcnt(4)
    v_mfma_f32_16x16x32_bf16 v[32:35], v[128:131], v[72:75], v[32:35]
    v_cmp_gt_u32 vcc, s68, v13
    s_cmp_eq_u64 vcc, -1
    s_waitcnt lgkmcnt(2)
    v_mfma_f32_16x16x32_bf16 v[36:39], v[132:135], v[72:75], v[36:39]
    s_cselect_b32 s3, s79, 0
    s_bitcmp1_b32 s3, 0
    s_waitcnt lgkmcnt(0)
    v_mfma_f32_16x16x32_bf16 v[40:43], v[136:139], v[72:75], v[40:43]
    s_cbranch_scc1 RN_8
    s_branch SL_9
LS_26:
    s_waitcnt lgkmcnt(0)
    s_mov_b64 exec, 1
    ds_add_rtn_u32 v15, v11, v4
    ds_read_b32 v13, v11 offset:4
    s_mov_b64 exec, -1
    v_mfma_f32_16x16x32_bf16 v[28:31], v[124:127], v[72:75], v[28:31]
    ds_read_b128 v[76:79], v12 offset:0
    ds_read_b128 v[80:83], v12 offset:1024
    v_mfma_f32_16x16x32_bf16 v[32:35], v[128:131], v[72:75], v[32:35]
    ds_read_b128 v[84:87], v12 offset:2048
    ds_read_b128 v[88:91], v12 offset:3072
    v_mfma_f32_16x16x32_bf16 v[36:39], v[132:135], v[72:75], v[36:39]
    ds_read_b128 v[92:95], v12 offset:4096
    ds_read_b128 v[96:99], v12 offset:5120
    v_mfma_f32_16x16x32_bf16 v[40:43], v[136:139], v[72:75], v[40:43]
    ds_read_b128 v[100:103], v12 offset:6144
    s_branch PDN_27
SL_24:
    s_bitcmp1_b32 s79, 3
    s_cbranch_scc0 DM_25
    s_sleep 2
    buffer_load_dwordx4 v[68:71], v6, s[40:43], s83 offen offset:0 nt
    buffer_load_dwordx4 v[72:75], v6, s[40:43], s83 offen offset:1024 nt
    s_branch NX_35
DM_25:
    buffer_load_dword v3, off, s[40:43], s83
    buffer_load_dword v3, off, s[40:43], s83
NX_35:
    s_add_u32 s78, s78, 1
    s_cmp_lt_u32 s78, 64
    s_cbranch_scc1 CK_7
    s_branch PFB_28
PDN_27:
    s_waitcnt lgkmcnt(7)
    v_readfirstlane_b32 s3, v13
    v_readfirstlane_b32 s27, v15
    s_nop 2
    s_cmp_eq_u32 s3, 1
    s_cbranch_scc1 FIN_36
    s_cmp_eq_u32 s27, 0
    s_cbranch_scc0 SEC_37
    s_nop 3
    ds_write_b128 v12, v[16:19] offset:0
    ds_write_b128 v12, v[20:23] offset:1024
    ds_write_b128 v12, v[24:27] offset:2048
    ds_write_b128 v12, v[28:31] offset:3072
    ds_write_b128 v12, v[32:35] offset:4096
    ds_write_b128 v12, v[36:39] offset:5120
    ds_write_b128 v12, v[40:43] offset:6144
    s_mov_b64 exec, 1
    s_waitcnt lgkmcnt(0)
    ds_write_b32 v11, v4 offset:4
    s_waitcnt lgkmcnt(0)
    s_mov_b64 exec, -1
    s_endpgm
SEC_37:
    s_mov_b32 s69, 0
SPN_38:
    ds_read_b32 v13, v11 offset:4
    ds_read_b128 v[76:79], v12 offset:0
    ds_read_b128 v[80:83], v12 offset:1024
    ds_read_b128 v[84:87], v12 offset:2048
    ds_read_b128 v[88:91], v12 offset:3072
    ds_read_b128 v[92:95], v12 offset:4096
    ds_read_b128 v[96:99], v12 offset:5120
    ds_read_b128 v[100:103], v12 offset:6144
    s_add_u32 s69, s69, 1
    s_cmp_gt_u32 s69, 0x400000
    s_cbranch_scc1 K_END
    s_waitcnt lgkmcnt(7)
    v_readfirstlane_b32 s3, v13
    s_nop 3
    s_cmp_eq_u32 s3, 1
    s_cbranch_scc0 SPN_38
FIN_36:
    s_and_b32 s3, s48, 3
    s_or_b32 s3, s26, s3
    s_cbranch_scc1 NS_40
    v_mov_b32 v13, s93
    buffer_store_dword v13, off, s[40:43], s60 sc0 sc1
NS_40:
    s_waitcnt lgkmcnt(6)
    v_pk_add_f32 v[16:17], v[16:17], v[76:77]
    v_pk_add_f32 v[18:19], v[18:19], v[78:79]
    v_cvt_pk_bf16_f32 v104, v16, v17
    v_cvt_pk_bf16_f32 v105, v18, v19
    s_waitcnt lgkmcnt(5)
    v_pk_add_f32 v[20:21], v[20:21], v[80:81]
    v_pk_add_f32 v[22:23], v[22:23], v[82:83]
    v_cvt_pk_bf16_f32 v106, v20, v21
    v_cvt_pk_bf16_f32 v107, v22, v23
    s_waitcnt lgkmcnt(4)
    v_pk_add_f32 v[24:25], v[24:25], v[84:85]
    v_pk_add_f32 v[26:27], v[26:27], v[86:87]
    v_cvt_pk_bf16_f32 v108, v24, v25
    v_cvt_pk_bf16_f32 v109, v26, v27
    v_permlane16_swap_b32 v104, v106
    v_permlane16_swap_b32 v105, v107
    s_waitcnt lgkmcnt(3)
    v_pk_add_f32 v[28:29], v[28:29], v[88:89]
    v_pk_add_f32 v[30:31], v[30:31], v[90:91]
    v_cvt_pk_bf16_f32 v110, v28, v29
    v_cvt_pk_bf16_f32 v111, v30, v31
    buffer_store_dwordx4 v[104:107], v10, s[88:91], s87 offen offset:0 nt
    s_waitcnt lgkmcnt(2)
    v_pk_add_f32 v[32:33], v[32:33], v[92:93]
    v_pk_add_f32 v[34:35], v[34:35], v[94:95]
    v_cvt_pk_bf16_f32 v112, v32, v33
    v_cvt_pk_bf16_f32 v113, v34, v35
    v_permlane16_swap_b32 v108, v110
    v_permlane16_swap_b32 v109, v111
    s_waitcnt lgkmcnt(1)
    v_pk_add_f32 v[36:37], v[36:37], v[96:97]
    v_pk_add_f32 v[38:39], v[38:39], v[98:99]
    v_cvt_pk_bf16_f32 v114, v36, v37
    v_cvt_pk_bf16_f32 v115, v38, v39
    buffer_store_dwordx4 v[108:111], v10, s[88:91], s87 offen offset:64 nt
    s_waitcnt lgkmcnt(0)
    v_pk_add_f32 v[40:41], v[40:41], v[100:101]
    v_pk_add_f32 v[42:43], v[42:43], v[102:103]
    v_cvt_pk_bf16_f32 v116, v40, v41
    v_cvt_pk_bf16_f32 v117, v42, v43
    v_permlane16_swap_b32 v112, v114
    v_permlane16_swap_b32 v113, v115
    buffer_store_dwordx2 v[116:117], v14, s[88:91], s87 offen offset:192 nt
    s_nop 0
    buffer_store_dwordx4 v[112:115], v10, s[88:91], s87 offen offset:128 nt
ENDC_39:
    s_endpgm
PFB_28:
    s_waitcnt vmcnt(0)
    s_lshl_b32 s57, s24, 4
    s_add_u32 s57, s57, s25
    s_lshl_b32 s57, s57, 7
    s_add_u32 s57, s57, 0x810000
    s_cmp_eq_u32 s78, 64
    s_cbranch_scc0 NC_41
    s_lshl_b32 s3, s26, 14
    s_add_u32 s62, s59, s3
    s_mov_b32 s69, 0
CP_42:
RL_43:
    v_mov_b32 v13, 0
    s_add_u32 s3, s62, 0
    buffer_load_dwordx4 v[44:47], v6, s[40:43], s3 offen sc0 sc1
    s_add_u32 s3, s62, 1024
    buffer_load_dwordx4 v[48:51], v6, s[40:43], s3 offen sc0 sc1
    s_add_u32 s3, s62, 2048
    buffer_load_dwordx4 v[52:55], v6, s[40:43], s3 offen sc0 sc1
    s_add_u32 s3, s62, 3072
    buffer_load_dwordx4 v[56:59], v6, s[40:43], s3 offen sc0 sc1
    s_add_u32 s3, s62, 4096
    buffer_load_dwordx4 v[60:63], v6, s[40:43], s3 offen sc0 sc1
    s_add_u32 s3, s62, 5120
    buffer_load_dwordx4 v[64:67], v6, s[40:43], s3 offen sc0 sc1
    s_add_u32 s3, s62, 6144
    buffer_load_dwordx4 v[68:71], v6, s[40:43], s3 offen sc0 sc1
    s_add_u32 s3, s62, 7168
    buffer_load_dwordx4 v[72:75], v6, s[40:43], s3 offen sc0 sc1
    s_waitcnt vmcnt(0)
    v_xor_b32 v15, s61, v47
    v_or_b32 v13, v13, v15
    v_xor_b32 v15, s61, v51
    v_or_b32 v13, v13, v15
    v_xor_b32 v15, s61, v55
    v_or_b32 v13, v13, v15
    v_xor_b32 v15, s61, v59
    v_or_b32 v13, v13, v15
    v_xor_b32 v15, s61, v63
    v_or_b32 v13, v13, v15
    v_xor_b32 v15, s61, v67
    v_or_b32 v13, v13, v15
    v_xor_b32 v15, s61, v71
    v_or_b32 v13, v13, v15
    v_xor_b32 v15, s61, v75
    v_or_b32 v13, v13, v15
    v_cmp_gt_u32 vcc, 0x10000, v13
    s_add_u32 s69, s69, 1
    s_cmp_gt_u32 s69, 0x40000
    s_cbranch_scc1 K_END
    s_cmp_eq_u64 vcc, -1
    s_cbranch_scc0 RL_43
    s_add_u32 s3, s62, 0x400000
    buffer_store_dwordx4 v[44:47], v6, s[40:43], s3 offen sc0 sc1
    s_add_u32 s3, s62, 0x400400
    buffer_store_dwordx4 v[48:51], v6, s[40:43], s3 offen sc0 sc1
    s_add_u32 s3, s62, 0x400800
    buffer_store_dwordx4 v[52:55], v6, s[40:43], s3 offen sc0 sc1
    s_add_u32 s3, s62, 0x400c00
    buffer_store_dwordx4 v[56:59], v6, s[40:43], s3 offen sc0 sc1
    s_add_u32 s3, s62, 0x401000
    buffer_store_dwordx4 v[60:63], v6, s[40:43], s3 offen sc0 sc1
    s_add_u32 s3, s62, 0x401400
    buffer_store_dwordx4 v[64:67], v6, s[40:43], s3 offen sc0 sc1
    s_add_u32 s3, s62, 0x401800
    buffer_store_dwordx4 v[68:71], v6, s[40:43], s3 offen sc0 sc1
    s_add_u32 s3, s62, 0x401c00
    buffer_store_dwordx4 v[72:75], v6, s[40:43], s3 offen sc0 sc1
    s_waitcnt vmcnt(0)
RL_44:
    v_mov_b32 v13, 0
    s_add_u32 s3, s62, 8192
    buffer_load_dwordx4 v[44:47], v6, s[40:43], s3 offen sc0 sc1
    s_add_u32 s3, s62, 9216
    buffer_load_dwordx4 v[48:51], v6, s[40:43], s3 offen sc0 sc1
    s_add_u32 s3, s62, 10240
    buffer_load_dwordx4 v[52:55], v6, s[40:43], s3 offen sc0 sc1
    s_add_u32 s3, s62, 11264
    buffer_load_dwordx4 v[56:59], v6, s[40:43], s3 offen sc0 sc1
    s_add_u32 s3, s62, 12288
    buffer_load_dwordx4 v[60:63], v6, s[40:43], s3 offen sc0 sc1
    s_add_u32 s3, s62, 13312
    buffer_load_dwordx4 v[64:67], v6, s[40:43], s3 offen sc0 sc1
    s_add_u32 s3, s62, 14336
    buffer_load_dwordx4 v[68:71], v6, s[40:43], s3 offen sc0 sc1
    s_add_u32 s3, s62, 15360
    buffer_load_dwordx4 v[72:75], v6, s[40:43], s3 offen sc0 sc1
    s_waitcnt vmcnt(0)
    v_xor_b32 v15, s61, v47
    v_or_b32 v13, v13, v15
    v_xor_b32 v15, s61, v51
    v_or_b32 v13, v13, v15
    v_xor_b32 v15, s61, v55
    v_or_b32 v13, v13, v15
    v_xor_b32 v15, s61, v59
    v_or_b32 v13, v13, v15
    v_xor_b32 v15, s61, v63
    v_or_b32 v13, v13, v15
    v_xor_b32 v15, s61, v67
    v_or_b32 v13, v13, v15
    v_xor_b32 v15, s61, v71
    v_or_b32 v13, v13, v15
    v_xor_b32 v15, s61, v75
    v_or_b32 v13, v13, v15
    v_cmp_gt_u32 vcc, 0x10000, v13
    s_add_u32 s69, s69, 1
    s_cmp_gt_u32 s69, 0x40000
    s_cbranch_scc1 K_END
    s_cmp_eq_u64 vcc, -1
    s_cbranch_scc0 RL_44
    s_add_u32 s3, s62, 0x402000
    buffer_store_dwordx4 v[44:47], v6, s[40:43], s3 offen sc0 sc1
    s_add_u32 s3, s62, 0x402400
    buffer_store_dwordx4 v[48:51], v6, s[40:43], s3 offen sc0 sc1
    s_add_u32 s3, s62, 0x402800
    buffer_store_dwordx4 v[52:55], v6, s[40:43], s3 offen sc0 sc1
    s_add_u32 s3, s62, 0x402c00
    buffer_store_dwordx4 v[56:59], v6, s[40:43], s3 offen sc0 sc1
    s_add_u32 s3, s62, 0x403000
    buffer_store_dwordx4 v[60:63], v6, s[40:43], s3 offen sc0 sc1
    s_add_u32 s3, s62, 0x403400
    buffer_store_dwordx4 v[64:67], v6, s[40:43], s3 offen sc0 sc1
    s_add_u32 s3, s62, 0x403800
    buffer_store_dwordx4 v[68:71], v6, s[40:43], s3 offen sc0 sc1
    s_add_u32 s3, s62, 0x403c00
    buffer_store_dwordx4 v[72:75], v6, s[40:43], s3 offen sc0 sc1
    s_waitcnt vmcnt(0)
    s_lshl_b32 s3, s26, 2
    s_add_u32 s3, s3, s57
    v_mov_b32 v15, s93
    buffer_store_dword v15, off, s[40:43], s3 sc0 sc1
    s_mov_b32 s68, 0x100000
NC_41:
    v_and_b32 v15, 3, v2
    v_lshlrev_b32 v15, 2, v15
    buffer_load_dword v13, v15, s[40:43], s57 offen offset:0 sc0 sc1
    s_waitcnt vmcnt(0)
    v_cmp_eq_u32 vcc, s93, v13
    s_or_b32 s3, s80, 0x400000
    s_bitcmp1_b32 vcc_lo, 0
    s_cselect_b32 s80, s3, s80
    s_or_b32 s3, s81, 0x400000
    s_bitcmp1_b32 vcc_lo, 1
    s_cselect_b32 s81, s3, s81
    s_or_b32 s3, s82, 0x400000
    s_bitcmp1_b32 vcc_lo, 2
    s_cselect_b32 s82, s3, s82
    s_or_b32 s3, s83, 0x400000
    s_bitcmp1_b32 vcc_lo, 3
    s_cselect_b32 s83, s3, s83
    buffer_load_dwordx4 v[44:47], v6, s[40:43], s80 offen offset:0 sc0 sc1
    buffer_load_dwordx4 v[48:51], v6, s[40:43], s80 offen offset:1024 sc0 sc1
    buffer_load_dwordx4 v[52:55], v6, s[40:43], s81 offen offset:0 sc0 sc1
    buffer_load_dwordx4 v[56:59], v6, s[40:43], s81 offen offset:1024 sc0 sc1
    buffer_load_dwordx4 v[60:63], v6, s[40:43], s82 offen offset:0 sc0 sc1
    buffer_load_dwordx4 v[64:67], v6, s[40:43], s82 offen offset:1024 sc0 sc1
    buffer_load_dwordx4 v[68:71], v6, s[40:43], s83 offen offset:0 sc0 sc1
    buffer_load_dwordx4 v[72:75], v6, s[40:43], s83 offen offset:1024 sc0 sc1
    s_cmp_lt_u32 s78, 0x40000
    s_cbranch_scc1 CK_7
    s_endpgm
P2_BL:
    s_waitcnt vmcnt(0)
    s_mov_b64 exec, 1
    ds_add_u32 v3, v4 offset:4
    s_mov_b64 exec, -1
    ds_read_b64_tr_b16 a[84:85], v5 offset:25088
    ds_read_b64_tr_b16 a[86:87], v7 offset:25088
    ds_read_b64_tr_b16 a[88:89], v5 offset:25120
    ds_read_b64_tr_b16 a[90:91], v7 offset:25120
    ds_read_b64_tr_b16 a[92:93], v5 offset:25152
    ds_read_b64_tr_b16 a[94:95], v7 offset:25152
    ds_read_b64_tr_b16 a[96:97], v5 offset:25184
    ds_read_b64_tr_b16 a[98:99], v7 offset:25184
    ds_read_b64_tr_b16 a[100:101], v5 offset:25216
    ds_read_b64_tr_b16 a[102:103], v7 offset:25216
    ds_read_b64_tr_b16 a[104:105], v5 offset:25248
    ds_read_b64_tr_b16 a[106:107], v7 offset:25248
    ds_read_b64_tr_b16 a[108:109], v5 offset:25280
    ds_read_b64_tr_b16 a[110:111], v7 offset:25280
    ds_read_b64_tr_b16 v[112:113], v5 offset:31360
    ds_read_b64_tr_b16 v[114:115], v7 offset:31360
    ds_read_b64_tr_b16 v[116:117], v5 offset:31392
    ds_read_b64_tr_b16 v[118:119], v7 offset:31392
    ds_read_b64_tr_b16 v[120:121], v5 offset:31424
    ds_read_b64_tr_b16 v[122:123], v7 offset:31424
    ds_read_b64_tr_b16 v[124:125], v5 offset:31456
    ds_read_b64_tr_b16 v[126:127], v7 offset:31456
    ds_read_b64_tr_b16 v[128:129], v5 offset:31488
    ds_read_b64_tr_b16 v[130:131], v7 offset:31488
    ds_read_b64_tr_b16 v[132:133], v5 offset:31520
    ds_read_b64_tr_b16 v[134:135], v7 offset:31520
    ds_read_b64_tr_b16 v[136:137], v5 offset:31552
    ds_read_b64_tr_b16 v[138:139], v7 offset:31552
    buffer_load_dwordx4 v[68:71], v6, s[40:43], s83 offen offset:0 nt
    buffer_load_dwordx4 v[72:75], v6, s[40:43], s83 offen offset:1024 nt
    ds_read_b64_tr_b16 a[56:57], v5 offset:12544
    ds_read_b64_tr_b16 a[58:59], v7 offset:12544
    ds_read_b64_tr_b16 a[60:61], v5 offset:12576
    ds_read_b64_tr_b16 a[62:63], v7 offset:12576
    ds_read_b64_tr_b16 a[64:65], v5 offset:12608
    ds_read_b64_tr_b16 a[66:67], v7 offset:12608
    ds_read_b64_tr_b16 a[68:69], v5 offset:12640
    ds_read_b64_tr_b16 a[70:71], v7 offset:12640
    ds_read_b64_tr_b16 a[72:73], v5 offset:12672
    ds_read_b64_tr_b16 a[74:75], v7 offset:12672
    ds_read_b64_tr_b16 a[76:77], v5 offset:12704
    ds_read_b64_tr_b16 a[78:79], v7 offset:12704
    s_waitcnt vmcnt(0)
    v_xor_b32 v71, s61, v71
    v_xor_b32 v75, s61, v75
    v_or_b32 v13, v71, v75
    v_cmp_gt_u32 vcc, s68, v13
    s_cmp_eq_u64 vcc, -1
    s_cbranch_scc0 F0_67
    s_bitset0_b32 s79, 3
    s_waitcnt lgkmcnt(12)
    v_mfma_f32_16x16x32_bf16 v[16:19], a[84:87], v[68:71], 0
    ds_read_b64_tr_b16 a[80:81], v5 offset:12736
    ds_read_b64_tr_b16 a[82:83], v7 offset:12736
    ds_read_b64_tr_b16 a[28:29], v5 offset:0
    ds_read_b64_tr_b16 a[30:31], v7 offset:0
    v_mfma_f32_16x16x32_bf16 v[20:23], a[88:91], v[68:71], 0
    ds_read_b64_tr_b16 a[32:33], v5 offset:32
    ds_read_b64_tr_b16 a[34:35], v7 offset:32
    ds_read_b64_tr_b16 a[36:37], v5 offset:64
    ds_read_b64_tr_b16 a[38:39], v7 offset:64
    v_mfma_f32_16x16x32_bf16 v[24:27], a[92:95], v[68:71], 0
    ds_read_b64_tr_b16 a[40:41], v5 offset:96
    ds_read_b64_tr_b16 a[42:43], v7 offset:96
    ds_read_b64_tr_b16 a[44:45], v5 offset:128
    ds_read_b64_tr_b16 a[46:47], v7 offset:128
    v_mfma_f32_16x16x32_bf16 v[28:31], a[96:99], v[68:71], 0
    ds_read_b64_tr_b16 a[48:49], v5 offset:160
    ds_read_b64_tr_b16 a[50:51], v7 offset:160
    ds_read_b64_tr_b16 a[52:53], v5 offset:192
    ds_read_b64_tr_b16 a[54:55], v7 offset:192
    v_mfma_f32_16x16x32_bf16 v[32:35], a[100:103], v[68:71], 0
    ds_read_b64_tr_b16 a[0:1], v8 offset:0
    ds_read_b64_tr_b16 a[2:3], v9 offset:0
    ds_read_b64_tr_b16 a[4:5], v8 offset:32
    ds_read_b64_tr_b16 a[6:7], v9 offset:32
    v_mfma_f32_16x16x32_bf16 v[36:39], a[104:107], v[68:71], 0
    ds_read_b64_tr_b16 a[8:9], v8 offset:64
    ds_read_b64_tr_b16 a[10:11], v9 offset:64
    ds_read_b64_tr_b16 a[12:13], v8 offset:96
    ds_read_b64_tr_b16 a[14:15], v9 offset:96
    v_mfma_f32_16x16x32_bf16 v[40:43], a[108:111], v[68:71], 0
    ds_read_b64_tr_b16 a[16:17], v8 offset:128
    ds_read_b64_tr_b16 a[18:19], v9 offset:128
    ds_read_b64_tr_b16 a[20:21], v8 offset:160
    ds_read_b64_tr_b16 a[22:23], v9 offset:160
    v_mfma_f32_16x16x32_bf16 v[16:19], v[112:115], v[72:75], v[16:19]
    ds_read_b64_tr_b16 a[24:25], v8 offset:192
    ds_read_b64_tr_b16 a[26:27], v9 offset:192
    ds_read_b64_tr_b16 v[100:101], v5 offset:18816
    ds_read_b64_tr_b16 v[102:103], v7 offset:18816
    v_mfma_f32_16x16x32_bf16 v[20:23], v[116:119], v[72:75], v[20:23]
    ds_read_b64_tr_b16 v[104:105], v5 offset:18848
    ds_read_b64_tr_b16 v[106:107], v7 offset:18848
    ds_read_b64_tr_b16 v[108:109], v5 offset:18880
    ds_read_b64_tr_b16 v[110:111], v7 offset:18880
    v_mfma_f32_16x16x32_bf16 v[24:27], v[120:123], v[72:75], v[24:27]
    ds_read_b64_tr_b16 v[88:89], v5 offset:6272
    ds_read_b64_tr_b16 v[90:91], v7 offset:6272
    ds_read_b64_tr_b16 v[92:93], v5 offset:6304
    ds_read_b64_tr_b16 v[94:95], v7 offset:6304
    v_mfma_f32_16x16x32_bf16 v[28:31], v[124:127], v[72:75], v[28:31]
    ds_read_b64_tr_b16 v[96:97], v5 offset:6336
    ds_read_b64_tr_b16 v[98:99], v7 offset:6336
    ds_read_b64_tr_b16 v[76:77], v8 offset:6272
    ds_read_b64_tr_b16 v[78:79], v9 offset:6272
    v_mfma_f32_16x16x32_bf16 v[32:35], v[128:131], v[72:75], v[32:35]
    ds_read_b64_tr_b16 v[80:81], v8 offset:6304
    ds_read_b64_tr_b16 v[82:83], v9 offset:6304
    ds_read_b64_tr_b16 v[84:85], v8 offset:6336
    ds_read_b64_tr_b16 v[86:87], v9 offset:6336
    v_mfma_f32_16x16x32_bf16 v[36:39], v[132:135], v[72:75], v[36:39]
    v_mfma_f32_16x16x32_bf16 v[40:43], v[136:139], v[72:75], v[40:43]
    s_sleep 4
    buffer_load_dwordx4 v[60:63], v6, s[40:43], s82 offen offset:0 nt
    buffer_load_dwordx4 v[64:67], v6, s[40:43], s82 offen offset:1024 nt
    buffer_load_dwordx4 v[52:55], v6, s[40:43], s81 offen offset:0 nt
    buffer_load_dwordx4 v[56:59], v6, s[40:43], s81 offen offset:1024 nt
    buffer_load_dwordx4 v[44:47], v6, s[40:43], s80 offen offset:0 nt
    buffer_load_dwordx4 v[48:51], v6, s[40:43], s80 offen offset:1024 nt
    buffer_load_dword v3, off, s[40:43], s83
    buffer_load_dword v3, off, s[40:43], s83
    s_branch CK_55
F0_67:
    ds_read_b64_tr_b16 a[80:81], v5 offset:12736
    v_mov_b32 v16, 0
    ds_read_b64_tr_b16 a[82:83], v7 offset:12736
    v_mov_b32 v17, 0
    ds_read_b64_tr_b16 a[28:29], v5 offset:0
    v_mov_b32 v18, 0
    ds_read_b64_tr_b16 a[30:31], v7 offset:0
    v_mov_b32 v19, 0
    ds_read_b64_tr_b16 a[32:33], v5 offset:32
    v_mov_b32 v20, 0
    ds_read_b64_tr_b16 a[34:35], v7 offset:32
    v_mov_b32 v21, 0
    ds_read_b64_tr_b16 a[36:37], v5 offset:64
    v_mov_b32 v22, 0
    ds_read_b64_tr_b16 a[38:39], v7 offset:64
    v_mov_b32 v23, 0
    ds_read_b64_tr_b16 a[40:41], v5 offset:96
    v_mov_b32 v24, 0
    ds_read_b64_tr_b16 a[42:43], v7 offset:96
    v_mov_b32 v25, 0
    ds_read_b64_tr_b16 a[44:45], v5 offset:128
    v_mov_b32 v26, 0
    ds_read_b64_tr_b16 a[46:47], v7 offset:128
    v_mov_b32 v27, 0
    ds_read_b64_tr_b16 a[48:49], v5 offset:160
    v_mov_b32 v28, 0
    ds_read_b64_tr_b16 a[50:51], v7 offset:160
    v_mov_b32 v29, 0
    ds_read_b64_tr_b16 a[52:53], v5 offset:192
    v_mov_b32 v30, 0
    ds_read_b64_tr_b16 a[54:55], v7 offset:192
    v_mov_b32 v31, 0
    ds_read_b64_tr_b16 a[0:1], v8 offset:0
    v_mov_b32 v32, 0
    ds_read_b64_tr_b16 a[2:3], v9 offset:0
    v_mov_b32 v33, 0
    ds_read_b64_tr_b16 a[4:5], v8 offset:32
    v_mov_b32 v34, 0
    ds_read_b64_tr_b16 a[6:7], v9 offset:32
    v_mov_b32 v35, 0
    ds_read_b64_tr_b16 a[8:9], v8 offset:64
    v_mov_b32 v36, 0
    ds_read_b64_tr_b16 a[10:11], v9 offset:64
    v_mov_b32 v37, 0
    ds_read_b64_tr_b16 a[12:13], v8 offset:96
    v_mov_b32 v38, 0
    ds_read_b64_tr_b16 a[14:15], v9 offset:96
    v_mov_b32 v39, 0
    ds_read_b64_tr_b16 a[16:17], v8 offset:128
    v_mov_b32 v40, 0
    ds_read_b64_tr_b16 a[18:19], v9 offset:128
    v_mov_b32 v41, 0
    ds_read_b64_tr_b16 a[20:21], v8 offset:160
    v_mov_b32 v42, 0
    ds_read_b64_tr_b16 a[22:23], v9 offset:160
    v_mov_b32 v43, 0
    ds_read_b64_tr_b16 a[24:25], v8 offset:192
    ds_read_b64_tr_b16 a[26:27], v9 offset:192
    ds_read_b64_tr_b16 v[100:101], v5 offset:18816
    ds_read_b64_tr_b16 v[102:103], v7 offset:18816
    ds_read_b64_tr_b16 v[104:105], v5 offset:18848
    ds_read_b64_tr_b16 v[106:107], v7 offset:18848
    ds_read_b64_tr_b16 v[108:109], v5 offset:18880
    ds_read_b64_tr_b16 v[110:111], v7 offset:18880
    ds_read_b64_tr_b16 v[88:89], v5 offset:6272
    ds_read_b64_tr_b16 v[90:91], v7 offset:6272
    ds_read_b64_tr_b16 v[92:93], v5 offset:6304
    ds_read_b64_tr_b16 v[94:95], v7 offset:6304
    ds_read_b64_tr_b16 v[96:97], v5 offset:6336
    ds_read_b64_tr_b16 v[98:99], v7 offset:6336
    ds_read_b64_tr_b16 v[76:77], v8 offset:6272
    ds_read_b64_tr_b16 v[78:79], v9 offset:6272
    ds_read_b64_tr_b16 v[80:81], v8 offset:6304
    ds_read_b64_tr_b16 v[82:83], v9 offset:6304
    ds_read_b64_tr_b16 v[84:85], v8 offset:6336
    ds_read_b64_tr_b16 v[86:87], v9 offset:6336
    s_sleep 4
    buffer_load_dwordx4 v[68:71], v6, s[40:43], s83 offen offset:0 nt
    buffer_load_dwordx4 v[72:75], v6, s[40:43], s83 offen offset:1024 nt
    buffer_load_dwordx4 v[60:63], v6, s[40:43], s82 offen offset:0 nt
    buffer_load_dwordx4 v[64:67], v6, s[40:43], s82 offen offset:1024 nt
    buffer_load_dwordx4 v[52:55], v6, s[40:43], s81 offen offset:0 nt
    buffer_load_dwordx4 v[56:59], v6, s[40:43], s81 offen offset:1024 nt
    buffer_load_dwordx4 v[44:47], v6, s[40:43], s80 offen offset:0 nt
    buffer_load_dwordx4 v[48:51], v6, s[40:43], s80 offen offset:1024 nt
CK_60:
    s_waitcnt vmcnt(6)
    v_xor_b32 v71, s61, v71
    v_xor_b32 v75, s61, v75
    v_or_b32 v13, v71, v75
    v_cmp_gt_u32 vcc, s68, v13
    s_cmp_eq_u64 vcc, -1
    s_cselect_b32 s3, s79, 0
    s_bitcmp1_b32 s3, 3
    s_cbranch_scc0 SL_62
    s_waitcnt lgkmcnt(15)
RN_61:
    s_bitset0_b32 s79, 3
    s_cmp_eq_u32 s79, 0
    v_mfma_f32_16x16x32_bf16 v[16:19], a[84:87], v[68:71], v[16:19]
    ds_read_b64_tr_b16 v[124:125], v5 offset:31456
    ds_read_b64_tr_b16 v[126:127], v7 offset:31456
    v_mfma_f32_16x16x32_bf16 v[20:23], a[88:91], v[68:71], v[20:23]
    ds_read_b64_tr_b16 v[128:129], v5 offset:31488
    ds_read_b64_tr_b16 v[130:131], v7 offset:31488
    v_mfma_f32_16x16x32_bf16 v[24:27], a[92:95], v[68:71], v[24:27]
    ds_read_b64_tr_b16 v[132:133], v5 offset:31520
    ds_read_b64_tr_b16 v[134:135], v7 offset:31520
    v_mfma_f32_16x16x32_bf16 v[28:31], a[96:99], v[68:71], v[28:31]
    ds_read_b64_tr_b16 v[136:137], v5 offset:31552
    ds_read_b64_tr_b16 v[138:139], v7 offset:31552
    v_mfma_f32_16x16x32_bf16 v[32:35], a[100:103], v[68:71], v[32:35]
    buffer_load_dword v3, off, s[40:43], s83
    v_mfma_f32_16x16x32_bf16 v[36:39], a[104:107], v[68:71], v[36:39]
    buffer_load_dword v3, off, s[40:43], s83
    v_mfma_f32_16x16x32_bf16 v[40:43], a[108:111], v[68:71], v[40:43]
    s_waitcnt lgkmcnt(8)
    v_mfma_f32_16x16x32_bf16 v[16:19], v[112:115], v[72:75], v[16:19]
    v_mfma_f32_16x16x32_bf16 v[20:23], v[116:119], v[72:75], v[20:23]
    v_mfma_f32_16x16x32_bf16 v[24:27], v[120:123], v[72:75], v[24:27]
    s_cbranch_scc1 LS_64
    s_waitcnt vmcnt(6)
    v_xor_b32 v63, s61, v63
    s_waitcnt lgkmcnt(6)
    v_mfma_f32_16x16x32_bf16 v[28:31], v[124:127], v[72:75], v[28:31]
    v_xor_b32 v67, s61, v67
    v_or_b32 v13, v63, v67
    s_waitcnt lgkmcnt(4)
    v_mfma_f32_16x16x32_bf16 v[32:35], v[128:131], v[72:75], v[32:35]
    v_cmp_gt_u32 vcc, s68, v13
    s_cmp_eq_u64 vcc, -1
    s_waitcnt lgkmcnt(2)
    v_mfma_f32_16x16x32_bf16 v[36:39], v[132:135], v[72:75], v[36:39]
    s_cselect_b32 s3, s79, 0
    s_bitcmp1_b32 s3, 2
    s_waitcnt lgkmcnt(0)
    v_mfma_f32_16x16x32_bf16 v[40:43], v[136:139], v[72:75], v[40:43]
    s_cbranch_scc1 RN_56
    s_branch SL_57
LS_64:
    s_waitcnt lgkmcnt(0)
    s_mov_b64 exec, 1
    ds_add_rtn_u32 v15, v11, v4
    ds_read_b32 v13, v11 offset:4
    s_mov_b64 exec, -1
    v_mfma_f32_16x16x32_bf16 v[28:31], v[124:127], v[72:75], v[28:31]
    ds_read_b128 v[76:79], v12 offset:0
    ds_read_b128 v[80:83], v12 offset:1024
    v_mfma_f32_16x16x32_bf16 v[32:35], v[128:131], v[72:75], v[32:35]
    ds_read_b128 v[84:87], v12 offset:2048
    ds_read_b128 v[88:91], v12 offset:3072
    v_mfma_f32_16x16x32_bf16 v[36:39], v[132:135], v[72:75], v[36:39]
    ds_read_b128 v[92:95], v12 offset:4096
    ds_read_b128 v[96:99], v12 offset:5120
    v_mfma_f32_16x16x32_bf16 v[40:43], v[136:139], v[72:75], v[40:43]
    ds_read_b128 v[100:103], v12 offset:6144
    s_branch PDN_65
SL_62:
    s_bitcmp1_b32 s79, 3
    s_cbranch_scc0 DM_63
    s_sleep 2
    buffer_load_dwordx4 v[68:71], v6, s[40:43], s83 offen offset:0 nt
    buffer_load_dwordx4 v[72:75], v6, s[40:43], s83 offen offset:1024 nt
    s_branch NX_68
DM_63:
    buffer_load_dword v3, off, s[40:43], s83
    buffer_load_dword v3, off, s[40:43], s83
NX_68:
CK_55:
    s_waitcnt vmcnt(6)
    v_xor_b32 v63, s61, v63
    v_xor_b32 v67, s61, v67
    v_or_b32 v13, v63, v67
    v_cmp_gt_u32 vcc, s68, v13
    s_cmp_eq_u64 vcc, -1
    s_cselect_b32 s3, s79, 0
    s_bitcmp1_b32 s3, 2
    s_cbranch_scc0 SL_57
    s_waitcnt lgkmcnt(15)
RN_56:
    s_bitset0_b32 s79, 2
    s_cmp_eq_u32 s79, 0
    v_mfma_f32_16x16x32_bf16 v[16:19], a[56:59], v[60:63], v[16:19]
    ds_read_b64_tr_b16 v[124:125], v5 offset:18912
    ds_read_b64_tr_b16 v[126:127], v7 offset:18912
    v_mfma_f32_16x16x32_bf16 v[20:23], a[60:63], v[60:63], v[20:23]
    ds_read_b64_tr_b16 v[128:129], v5 offset:18944
    ds_read_b64_tr_b16 v[130:131], v7 offset:18944
    v_mfma_f32_16x16x32_bf16 v[24:27], a[64:67], v[60:63], v[24:27]
    ds_read_b64_tr_b16 v[132:133], v5 offset:18976
    ds_read_b64_tr_b16 v[134:135], v7 offset:18976
    v_mfma_f32_16x16x32_bf16 v[28:31], a[68:71], v[60:63], v[28:31]
    ds_read_b64_tr_b16 v[136:137], v5 offset:19008
    ds_read_b64_tr_b16 v[138:139], v7 offset:19008
    v_mfma_f32_16x16x32_bf16 v[32:35], a[72:75], v[60:63], v[32:35]
    buffer_load_dword v3, off, s[40:43], s82
    v_mfma_f32_16x16x32_bf16 v[36:39], a[76:79], v[60:63], v[36:39]
    buffer_load_dword v3, off, s[40:43], s82
    v_mfma_f32_16x16x32_bf16 v[40:43], a[80:83], v[60:63], v[40:43]
    s_waitcnt lgkmcnt(8)
    v_mfma_f32_16x16x32_bf16 v[16:19], v[100:103], v[64:67], v[16:19]
    v_mfma_f32_16x16x32_bf16 v[20:23], v[104:107], v[64:67], v[20:23]
    v_mfma_f32_16x16x32_bf16 v[24:27], v[108:111], v[64:67], v[24:27]
    s_cbranch_scc1 LS_59
    s_waitcnt vmcnt(6)
    v_xor_b32 v55, s61, v55
    s_waitcnt lgkmcnt(6)
    v_mfma_f32_16x16x32_bf16 v[28:31], v[124:127], v[64:67], v[28:31]
    v_xor_b32 v59, s61, v59
    v_or_b32 v13, v55, v59
    s_waitcnt lgkmcnt(4)
    v_mfma_f32_16x16x32_bf16 v[32:35], v[128:131], v[64:67], v[32:35]
    v_cmp_gt_u32 vcc, s68, v13
    s_cmp_eq_u64 vcc, -1
    s_waitcnt lgkmcnt(2)
    v_mfma_f32_16x16x32_bf16 v[36:39], v[132:135], v[64:67], v[36:39]
    s_cselect_b32 s3, s79, 0
    s_bitcmp1_b32 s3, 1
    s_waitcnt lgkmcnt(0)
    v_mfma_f32_16x16x32_bf16 v[40:43], v[136:139], v[64:67], v[40:43]
    s_cbranch_scc1 RN_51
    s_branch SL_52
LS_59:
    s_waitcnt lgkmcnt(0)
    s_mov_b64 exec, 1
    ds_add_rtn_u32 v15, v11, v4
    ds_read_b32 v13, v11 offset:4
    s_mov_b64 exec, -1
    v_mfma_f32_16x16x32_bf16 v[28:31], v[124:127], v[64:67], v[28:31]
    ds_read_b128 v[76:79], v12 offset:0
    ds_read_b128 v[80:83], v12 offset:1024
    v_mfma_f32_16x16x32_bf16 v[32:35], v[128:131], v[64:67], v[32:35]
    ds_read_b128 v[84:87], v12 offset:2048
    ds_read_b128 v[88:91], v12 offset:3072
    v_mfma_f32_16x16x32_bf16 v[36:39], v[132:135], v[64:67], v[36:39]
    ds_read_b128 v[92:95], v12 offset:4096
    ds_read_b128 v[96:99], v12 offset:5120
    v_mfma_f32_16x16x32_bf16 v[40:43], v[136:139], v[64:67], v[40:43]
    ds_read_b128 v[100:103], v12 offset:6144
    s_branch PDN_65
SL_57:
    s_bitcmp1_b32 s79, 2
    s_cbranch_scc0 DM_58
    s_sleep 2
    buffer_load_dwordx4 v[60:63], v6, s[40:43], s82 offen offset:0 nt
    buffer_load_dwordx4 v[64:67], v6, s[40:43], s82 offen offset:1024 nt
    s_branch NX_69
DM_58:
    buffer_load_dword v3, off, s[40:43], s82
    buffer_load_dword v3, off, s[40:43], s82
NX_69:
CK_50:
    s_waitcnt vmcnt(6)
    v_xor_b32 v55, s61, v55
    v_xor_b32 v59, s61, v59
    v_or_b32 v13, v55, v59
    v_cmp_gt_u32 vcc, s68, v13
    s_cmp_eq_u64 vcc, -1
    s_cselect_b32 s3, s79, 0
    s_bitcmp1_b32 s3, 1
    s_cbranch_scc0 SL_52
    s_waitcnt lgkmcnt(15)
RN_51:
    s_bitset0_b32 s79, 1
    s_cmp_eq_u32 s79, 0
    v_mfma_f32_16x16x32_bf16 v[16:19], a[28:31], v[52:55], v[16:19]
    ds_read_b64_tr_b16 v[124:125], v5 offset:6368
    ds_read_b64_tr_b16 v[126:127], v7 offset:6368
    v_mfma_f32_16x16x32_bf16 v[20:23], a[32:35], v[52:55], v[20:23]
    ds_read_b64_tr_b16 v[128:129], v5 offset:6400
    ds_read_b64_tr_b16 v[130:131], v7 offset:6400
    v_mfma_f32_16x16x32_bf16 v[24:27], a[36:39], v[52:55], v[24:27]
    ds_read_b64_tr_b16 v[132:133], v5 offset:6432
    ds_read_b64_tr_b16 v[134:135], v7 offset:6432
    v_mfma_f32_16x16x32_bf16 v[28:31], a[40:43], v[52:55], v[28:31]
    ds_read_b64_tr_b16 v[136:137], v5 offset:6464
    ds_read_b64_tr_b16 v[138:139], v7 offset:6464
    v_mfma_f32_16x16x32_bf16 v[32:35], a[44:47], v[52:55], v[32:35]
    buffer_load_dword v3, off, s[40:43], s81
    v_mfma_f32_16x16x32_bf16 v[36:39], a[48:51], v[52:55], v[36:39]
    buffer_load_dword v3, off, s[40:43], s81
    v_mfma_f32_16x16x32_bf16 v[40:43], a[52:55], v[52:55], v[40:43]
    s_waitcnt lgkmcnt(8)
    v_mfma_f32_16x16x32_bf16 v[16:19], v[88:91], v[56:59], v[16:19]
    v_mfma_f32_16x16x32_bf16 v[20:23], v[92:95], v[56:59], v[20:23]
    v_mfma_f32_16x16x32_bf16 v[24:27], v[96:99], v[56:59], v[24:27]
    s_cbranch_scc1 LS_54
    s_waitcnt vmcnt(6)
    v_xor_b32 v47, s61, v47
    s_waitcnt lgkmcnt(6)
    v_mfma_f32_16x16x32_bf16 v[28:31], v[124:127], v[56:59], v[28:31]
    v_xor_b32 v51, s61, v51
    v_or_b32 v13, v47, v51
    s_waitcnt lgkmcnt(4)
    v_mfma_f32_16x16x32_bf16 v[32:35], v[128:131], v[56:59], v[32:35]
    v_cmp_gt_u32 vcc, s68, v13
    s_cmp_eq_u64 vcc, -1
    s_waitcnt lgkmcnt(2)
    v_mfma_f32_16x16x32_bf16 v[36:39], v[132:135], v[56:59], v[36:39]
    s_cselect_b32 s3, s79, 0
    s_bitcmp1_b32 s3, 0
    s_waitcnt lgkmcnt(0)
    v_mfma_f32_16x16x32_bf16 v[40:43], v[136:139], v[56:59], v[40:43]
    s_cbranch_scc1 RN_46
    s_branch SL_47
LS_54:
    s_waitcnt lgkmcnt(0)
    s_mov_b64 exec, 1
    ds_add_rtn_u32 v15, v11, v4
    ds_read_b32 v13, v11 offset:4
    s_mov_b64 exec, -1
    v_mfma_f32_16x16x32_bf16 v[28:31], v[124:127], v[56:59], v[28:31]
    ds_read_b128 v[76:79], v12 offset:0
    ds_read_b128 v[80:83], v12 offset:1024
    v_mfma_f32_16x16x32_bf16 v[32:35], v[128:131], v[56:59], v[32:35]
    ds_read_b128 v[84:87], v12 offset:2048
    ds_read_b128 v[88:91], v12 offset:3072
    v_mfma_f32_16x16x32_bf16 v[36:39], v[132:135], v[56:59], v[36:39]
    ds_read_b128 v[92:95], v12 offset:4096
    ds_read_b128 v[96:99], v12 offset:5120
    v_mfma_f32_16x16x32_bf16 v[40:43], v[136:139], v[56:59], v[40:43]
    ds_read_b128 v[100:103], v12 offset:6144
    s_branch PDN_65
SL_52:
    s_bitcmp1_b32 s79, 1
    s_cbranch_scc0 DM_53
    s_sleep 2
    buffer_load_dwordx4 v[52:55], v6, s[40:43], s81 offen offset:0 nt
    buffer_load_dwordx4 v[56:59], v6, s[40:43], s81 offen offset:1024 nt
    s_branch NX_70
DM_53:
    buffer_load_dword v3, off, s[40:43], s81
    buffer_load_dword v3, off, s[40:43], s81
NX_70:
CK_45:
    s_waitcnt vmcnt(6)
    v_xor_b32 v47, s61, v47
    v_xor_b32 v51, s61, v51
    v_or_b32 v13, v47, v51
    v_cmp_gt_u32 vcc, s68, v13
    s_cmp_eq_u64 vcc, -1
    s_cselect_b32 s3, s79, 0
    s_bitcmp1_b32 s3, 0
    s_cbranch_scc0 SL_47
    s_waitcnt lgkmcnt(15)
RN_46:
    s_bitset0_b32 s79, 0
    s_cmp_eq_u32 s79, 0
    v_mfma_f32_16x16x32_bf16 v[16:19], a[0:3], v[44:47], v[16:19]
    ds_read_b64_tr_b16 v[124:125], v8 offset:6368
    ds_read_b64_tr_b16 v[126:127], v9 offset:6368
    v_mfma_f32_16x16x32_bf16 v[20:23], a[4:7], v[44:47], v[20:23]
    ds_read_b64_tr_b16 v[128:129], v8 offset:6400
    ds_read_b64_tr_b16 v[130:131], v9 offset:6400
    v_mfma_f32_16x16x32_bf16 v[24:27], a[8:11], v[44:47], v[24:27]
    ds_read_b64_tr_b16 v[132:133], v8 offset:6432
    ds_read_b64_tr_b16 v[134:135], v9 offset:6432
    v_mfma_f32_16x16x32_bf16 v[28:31], a[12:15], v[44:47], v[28:31]
    ds_read_b64_tr_b16 v[136:137], v8 offset:6464
    ds_read_b64_tr_b16 v[138:139], v9 offset:6464
    v_mfma_f32_16x16x32_bf16 v[32:35], a[16:19], v[44:47], v[32:35]
    buffer_load_dword v3, off, s[40:43], s80
    v_mfma_f32_16x16x32_bf16 v[36:39], a[20:23], v[44:47], v[36:39]
    buffer_load_dword v3, off, s[40:43], s80
    v_mfma_f32_16x16x32_bf16 v[40:43], a[24:27], v[44:47], v[40:43]
    s_waitcnt lgkmcnt(8)
    v_mfma_f32_16x16x32_bf16 v[16:19], v[76:79], v[48:51], v[16:19]
    v_mfma_f32_16x16x32_bf16 v[20:23], v[80:83], v[48:51], v[20:23]
    v_mfma_f32_16x16x32_bf16 v[24:27], v[84:87], v[48:51], v[24:27]
    s_cbranch_scc1 LS_49
    s_waitcnt vmcnt(6)
    v_xor_b32 v71, s61, v71
    s_waitcnt lgkmcnt(6)
    v_mfma_f32_16x16x32_bf16 v[28:31], v[124:127], v[48:51], v[28:31]
    v_xor_b32 v75, s61, v75
    v_or_b32 v13, v71, v75
    s_waitcnt lgkmcnt(4)
    v_mfma_f32_16x16x32_bf16 v[32:35], v[128:131], v[48:51], v[32:35]
    v_cmp_gt_u32 vcc, s68, v13
    s_cmp_eq_u64 vcc, -1
    s_waitcnt lgkmcnt(2)
    v_mfma_f32_16x16x32_bf16 v[36:39], v[132:135], v[48:51], v[36:39]
    s_cselect_b32 s3, s79, 0
    s_bitcmp1_b32 s3, 3
    s_waitcnt lgkmcnt(0)
    v_mfma_f32_16x16x32_bf16 v[40:43], v[136:139], v[48:51], v[40:43]
    s_cbranch_scc1 RN_61
    s_branch SL_62
LS_49:
    s_waitcnt lgkmcnt(0)
    s_mov_b64 exec, 1
    ds_add_rtn_u32 v15, v11, v4
    ds_read_b32 v13, v11 offset:4
    s_mov_b64 exec, -1
    v_mfma_f32_16x16x32_bf16 v[28:31], v[124:127], v[48:51], v[28:31]
    ds_read_b128 v[76:79], v12 offset:0
    ds_read_b128 v[80:83], v12 offset:1024
    v_mfma_f32_16x16x32_bf16 v[32:35], v[128:131], v[48:51], v[32:35]
    ds_read_b128 v[84:87], v12 offset:2048
    ds_read_b128 v[88:91], v12 offset:3072
    v_mfma_f32_16x16x32_bf16 v[36:39], v[132:135], v[48:51], v[36:39]
    ds_read_b128 v[92:95], v12 offset:4096
    ds_read_b128 v[96:99], v12 offset:5120
    v_mfma_f32_16x16x32_bf16 v[40:43], v[136:139], v[48:51], v[40:43]
    ds_read_b128 v[100:103], v12 offset:6144
    s_branch PDN_65
SL_47:
    s_bitcmp1_b32 s79, 0
    s_cbranch_scc0 DM_48
    s_sleep 2
    buffer_load_dwordx4 v[44:47], v6, s[40:43], s80 offen offset:0 nt
    buffer_load_dwordx4 v[48:51], v6, s[40:43], s80 offen offset:1024 nt
    s_branch NX_71
DM_48:
    buffer_load_dword v3, off, s[40:43], s80
    buffer_load_dword v3, off, s[40:43], s80
NX_71:
    s_add_u32 s78, s78, 1
    s_cmp_lt_u32 s78, 64
    s_cbranch_scc1 CK_60
    s_branch PFB_66
PDN_65:
    s_waitcnt lgkmcnt(7)
    v_readfirstlane_b32 s3, v13
    v_readfirstlane_b32 s27, v15
    s_nop 2
    s_cmp_eq_u32 s3, 1
    s_cbranch_scc1 FIN_72
    s_cmp_eq_u32 s27, 0
    s_cbranch_scc0 SEC_73
    s_nop 3
    ds_write_b128 v12, v[16:19] offset:0
    ds_write_b128 v12, v[20:23] offset:1024
    ds_write_b128 v12, v[24:27] offset:2048
    ds_write_b128 v12, v[28:31] offset:3072
    ds_write_b128 v12, v[32:35] offset:4096
    ds_write_b128 v12, v[36:39] offset:5120
    ds_write_b128 v12, v[40:43] offset:6144
    s_mov_b64 exec, 1
    s_waitcnt lgkmcnt(0)
    ds_write_b32 v11, v4 offset:4
    s_waitcnt lgkmcnt(0)
    s_mov_b64 exec, -1
    s_endpgm
SEC_73:
    s_mov_b32 s69, 0
SPN_74:
    ds_read_b32 v13, v11 offset:4
    ds_read_b128 v[76:79], v12 offset:0
    ds_read_b128 v[80:83], v12 offset:1024
    ds_read_b128 v[84:87], v12 offset:2048
    ds_read_b128 v[88:91], v12 offset:3072
    ds_read_b128 v[92:95], v12 offset:4096
    ds_read_b128 v[96:99], v12 offset:5120
    ds_read_b128 v[100:103], v12 offset:6144
    s_add_u32 s69, s69, 1
    s_cmp_gt_u32 s69, 0x400000
    s_cbranch_scc1 K_END
    s_waitcnt lgkmcnt(7)
    v_readfirstlane_b32 s3, v13
    s_nop 3
    s_cmp_eq_u32 s3, 1
    s_cbranch_scc0 SPN_74
FIN_72:
    s_and_b32 s3, s48, 3
    s_or_b32 s3, s26, s3
    s_cbranch_scc1 NS_76
    v_mov_b32 v13, s93
    buffer_store_dword v13, off, s[40:43], s60 sc0 sc1
NS_76:
    s_waitcnt lgkmcnt(6)
    v_pk_add_f32 v[16:17], v[16:17], v[76:77]
    v_pk_add_f32 v[18:19], v[18:19], v[78:79]
    v_cvt_pk_bf16_f32 v104, v16, v17
    v_cvt_pk_bf16_f32 v105, v18, v19
    s_waitcnt lgkmcnt(5)
    v_pk_add_f32 v[20:21], v[20:21], v[80:81]
    v_pk_add_f32 v[22:23], v[22:23], v[82:83]
    v_cvt_pk_bf16_f32 v106, v20, v21
    v_cvt_pk_bf16_f32 v107, v22, v23
    s_waitcnt lgkmcnt(4)
    v_pk_add_f32 v[24:25], v[24:25], v[84:85]
    v_pk_add_f32 v[26:27], v[26:27], v[86:87]
    v_cvt_pk_bf16_f32 v108, v24, v25
    v_cvt_pk_bf16_f32 v109, v26, v27
    v_permlane16_swap_b32 v104, v106
    v_permlane16_swap_b32 v105, v107
    s_waitcnt lgkmcnt(3)
    v_pk_add_f32 v[28:29], v[28:29], v[88:89]
    v_pk_add_f32 v[30:31], v[30:31], v[90:91]
    v_cvt_pk_bf16_f32 v110, v28, v29
    v_cvt_pk_bf16_f32 v111, v30, v31
    buffer_store_dwordx4 v[104:107], v10, s[88:91], s87 offen offset:0 nt
    s_waitcnt lgkmcnt(2)
    v_pk_add_f32 v[32:33], v[32:33], v[92:93]
    v_pk_add_f32 v[34:35], v[34:35], v[94:95]
    v_cvt_pk_bf16_f32 v112, v32, v33
    v_cvt_pk_bf16_f32 v113, v34, v35
    v_permlane16_swap_b32 v108, v110
    v_permlane16_swap_b32 v109, v111
    s_waitcnt lgkmcnt(1)
    v_pk_add_f32 v[36:37], v[36:37], v[96:97]
    v_pk_add_f32 v[38:39], v[38:39], v[98:99]
    v_cvt_pk_bf16_f32 v114, v36, v37
    v_cvt_pk_bf16_f32 v115, v38, v39
    buffer_store_dwordx4 v[108:111], v10, s[88:91], s87 offen offset:64 nt
    s_waitcnt lgkmcnt(0)
    v_pk_add_f32 v[40:41], v[40:41], v[100:101]
    v_pk_add_f32 v[42:43], v[42:43], v[102:103]
    v_cvt_pk_bf16_f32 v116, v40, v41
    v_cvt_pk_bf16_f32 v117, v42, v43
    v_permlane16_swap_b32 v112, v114
    v_permlane16_swap_b32 v113, v115
    buffer_store_dwordx2 v[116:117], v14, s[88:91], s87 offen offset:192 nt
    s_nop 0
    buffer_store_dwordx4 v[112:115], v10, s[88:91], s87 offen offset:128 nt
ENDC_75:
    s_endpgm
PFB_66:
    s_waitcnt vmcnt(0)
    s_lshl_b32 s57, s24, 4
    s_add_u32 s57, s57, s25
    s_lshl_b32 s57, s57, 7
    s_add_u32 s57, s57, 0x810000
    s_cmp_eq_u32 s78, 64
    s_cbranch_scc0 NC_77
    s_lshl_b32 s3, s26, 14
    s_add_u32 s62, s59, s3
    s_mov_b32 s69, 0
CP_78:
RL_79:
    v_mov_b32 v13, 0
    s_add_u32 s3, s62, 0
    buffer_load_dwordx4 v[44:47], v6, s[40:43], s3 offen sc0 sc1
    s_add_u32 s3, s62, 1024
    buffer_load_dwordx4 v[48:51], v6, s[40:43], s3 offen sc0 sc1
    s_add_u32 s3, s62, 2048
    buffer_load_dwordx4 v[52:55], v6, s[40:43], s3 offen sc0 sc1
    s_add_u32 s3, s62, 3072
    buffer_load_dwordx4 v[56:59], v6, s[40:43], s3 offen sc0 sc1
    s_add_u32 s3, s62, 4096
    buffer_load_dwordx4 v[60:63], v6, s[40:43], s3 offen sc0 sc1
    s_add_u32 s3, s62, 5120
    buffer_load_dwordx4 v[64:67], v6, s[40:43], s3 offen sc0 sc1
    s_add_u32 s3, s62, 6144
    buffer_load_dwordx4 v[68:71], v6, s[40:43], s3 offen sc0 sc1
    s_add_u32 s3, s62, 7168
    buffer_load_dwordx4 v[72:75], v6, s[40:43], s3 offen sc0 sc1
    s_waitcnt vmcnt(0)
    v_xor_b32 v15, s61, v47
    v_or_b32 v13, v13, v15
    v_xor_b32 v15, s61, v51
    v_or_b32 v13, v13, v15
    v_xor_b32 v15, s61, v55
    v_or_b32 v13, v13, v15
    v_xor_b32 v15, s61, v59
    v_or_b32 v13, v13, v15
    v_xor_b32 v15, s61, v63
    v_or_b32 v13, v13, v15
    v_xor_b32 v15, s61, v67
    v_or_b32 v13, v13, v15
    v_xor_b32 v15, s61, v71
    v_or_b32 v13, v13, v15
    v_xor_b32 v15, s61, v75
    v_or_b32 v13, v13, v15
    v_cmp_gt_u32 vcc, 0x10000, v13
    s_add_u32 s69, s69, 1
    s_cmp_gt_u32 s69, 0x40000
    s_cbranch_scc1 K_END
    s_cmp_eq_u64 vcc, -1
    s_cbranch_scc0 RL_79
    s_add_u32 s3, s62, 0x400000
    buffer_store_dwordx4 v[44:47], v6, s[40:43], s3 offen sc0 sc1
    s_add_u32 s3, s62, 0x400400
    buffer_store_dwordx4 v[48:51], v6, s[40:43], s3 offen sc0 sc1
    s_add_u32 s3, s62, 0x400800
    buffer_store_dwordx4 v[52:55], v6, s[40:43], s3 offen sc0 sc1
    s_add_u32 s3, s62, 0x400c00
    buffer_store_dwordx4 v[56:59], v6, s[40:43], s3 offen sc0 sc1
    s_add_u32 s3, s62, 0x401000
    buffer_store_dwordx4 v[60:63], v6, s[40:43], s3 offen sc0 sc1
    s_add_u32 s3, s62, 0x401400
    buffer_store_dwordx4 v[64:67], v6, s[40:43], s3 offen sc0 sc1
    s_add_u32 s3, s62, 0x401800
    buffer_store_dwordx4 v[68:71], v6, s[40:43], s3 offen sc0 sc1
    s_add_u32 s3, s62, 0x401c00
    buffer_store_dwordx4 v[72:75], v6, s[40:43], s3 offen sc0 sc1
    s_waitcnt vmcnt(0)
RL_80:
    v_mov_b32 v13, 0
    s_add_u32 s3, s62, 8192
    buffer_load_dwordx4 v[44:47], v6, s[40:43], s3 offen sc0 sc1
    s_add_u32 s3, s62, 9216
    buffer_load_dwordx4 v[48:51], v6, s[40:43], s3 offen sc0 sc1
    s_add_u32 s3, s62, 10240
    buffer_load_dwordx4 v[52:55], v6, s[40:43], s3 offen sc0 sc1
    s_add_u32 s3, s62, 11264
    buffer_load_dwordx4 v[56:59], v6, s[40:43], s3 offen sc0 sc1
    s_add_u32 s3, s62, 12288
    buffer_load_dwordx4 v[60:63], v6, s[40:43], s3 offen sc0 sc1
    s_add_u32 s3, s62, 13312
    buffer_load_dwordx4 v[64:67], v6, s[40:43], s3 offen sc0 sc1
    s_add_u32 s3, s62, 14336
    buffer_load_dwordx4 v[68:71], v6, s[40:43], s3 offen sc0 sc1
    s_add_u32 s3, s62, 15360
    buffer_load_dwordx4 v[72:75], v6, s[40:43], s3 offen sc0 sc1
    s_waitcnt vmcnt(0)
    v_xor_b32 v15, s61, v47
    v_or_b32 v13, v13, v15
    v_xor_b32 v15, s61, v51
    v_or_b32 v13, v13, v15
    v_xor_b32 v15, s61, v55
    v_or_b32 v13, v13, v15
    v_xor_b32 v15, s61, v59
    v_or_b32 v13, v13, v15
    v_xor_b32 v15, s61, v63
    v_or_b32 v13, v13, v15
    v_xor_b32 v15, s61, v67
    v_or_b32 v13, v13, v15
    v_xor_b32 v15, s61, v71
    v_or_b32 v13, v13, v15
    v_xor_b32 v15, s61, v75
    v_or_b32 v13, v13, v15
    v_cmp_gt_u32 vcc, 0x10000, v13
    s_add_u32 s69, s69, 1
    s_cmp_gt_u32 s69, 0x40000
    s_cbranch_scc1 K_END
    s_cmp_eq_u64 vcc, -1
    s_cbranch_scc0 RL_80
    s_add_u32 s3, s62, 0x402000
    buffer_store_dwordx4 v[44:47], v6, s[40:43], s3 offen sc0 sc1
    s_add_u32 s3, s62, 0x402400
    buffer_store_dwordx4 v[48:51], v6, s[40:43], s3 offen sc0 sc1
    s_add_u32 s3, s62, 0x402800
    buffer_store_dwordx4 v[52:55], v6, s[40:43], s3 offen sc0 sc1
    s_add_u32 s3, s62, 0x402c00
    buffer_store_dwordx4 v[56:59], v6, s[40:43], s3 offen sc0 sc1
    s_add_u32 s3, s62, 0x403000
    buffer_store_dwordx4 v[60:63], v6, s[40:43], s3 offen sc0 sc1
    s_add_u32 s3, s62, 0x403400
    buffer_store_dwordx4 v[64:67], v6, s[40:43], s3 offen sc0 sc1
    s_add_u32 s3, s62, 0x403800
    buffer_store_dwordx4 v[68:71], v6, s[40:43], s3 offen sc0 sc1
    s_add_u32 s3, s62, 0x403c00
    buffer_store_dwordx4 v[72:75], v6, s[40:43], s3 offen sc0 sc1
    s_waitcnt vmcnt(0)
    s_lshl_b32 s3, s26, 2
    s_add_u32 s3, s3, s57
    v_mov_b32 v15, s93
    buffer_store_dword v15, off, s[40:43], s3 sc0 sc1
    s_mov_b32 s68, 0x100000
NC_77:
    v_and_b32 v15, 3, v2
    v_lshlrev_b32 v15, 2, v15
    buffer_load_dword v13, v15, s[40:43], s57 offen offset:16 sc0 sc1
    s_waitcnt vmcnt(0)
    v_cmp_eq_u32 vcc, s93, v13
    s_or_b32 s3, s80, 0x400000
    s_bitcmp1_b32 vcc_lo, 0
    s_cselect_b32 s80, s3, s80
    s_or_b32 s3, s81, 0x400000
    s_bitcmp1_b32 vcc_lo, 1
    s_cselect_b32 s81, s3, s81
    s_or_b32 s3, s82, 0x400000
    s_bitcmp1_b32 vcc_lo, 2
    s_cselect_b32 s82, s3, s82
    s_or_b32 s3, s83, 0x400000
    s_bitcmp1_b32 vcc_lo, 3
    s_cselect_b32 s83, s3, s83
    buffer_load_dwordx4 v[68:71], v6, s[40:43], s83 offen offset:0 sc0 sc1
    buffer_load_dwordx4 v[72:75], v6, s[40:43], s83 offen offset:1024 sc0 sc1
    buffer_load_dwordx4 v[60:63], v6, s[40:43], s82 offen offset:0 sc0 sc1
    buffer_load_dwordx4 v[64:67], v6, s[40:43], s82 offen offset:1024 sc0 sc1
    buffer_load_dwordx4 v[52:55], v6, s[40:43], s81 offen offset:0 sc0 sc1
    buffer_load_dwordx4 v[56:59], v6, s[40:43], s81 offen offset:1024 sc0 sc1
    buffer_load_dwordx4 v[44:47], v6, s[40:43], s80 offen offset:0 sc0 sc1
    buffer_load_dwordx4 v[48:51], v6, s[40:43], s80 offen offset:1024 sc0 sc1
    s_cmp_lt_u32 s78, 0x40000
    s_cbranch_scc1 CK_60
    s_endpgm
C_A:
    s_load_dwordx2 s[40:41], s[0:1], 64
    s_load_dwordx2 s[88:89], s[0:1], 48
    s_load_dwordx2 s[44:45], s[0:1], 56
    s_lshr_b32 s23, s2, 3
    s_and_b32 s27, s2, 3
    s_and_b32 s3, s23, 3
    s_lshl2_add_u32 s25, s27, s3
    s_lshr_b32 s26, s23, 2
    s_mul_i32 s56, s26, 112
    s_lshr_b32 s80, s23, 4
    s_lshl2_add_u32 s80, s80, s3
    s_lshl_b32 s82, s80, 2
    s_lshr_b32 s82, 0x10653210, s82
    s_and_b32 s82, s82, 7
    s_mul_i32 s81, s27, 2
    s_add_u32 s81, s81, s82
    s_mul_i32 s3, s81, 37
    s_lshr_b32 s3, s3, 8
    s_mul_i32 s3, s3, 7
    s_sub_u32 s81, s81, s3
    s_and_b32 s22, s2, 7
    s_lshr_b32 s55, s26, 1
    s_mul_i32 s55, s55, 224
    s_getreg_b32 s92, hwreg(HW_REG_XCC_ID)
    s_and_b32 s92, s92, 15
    s_mov_b32 s70, 0x3fb8aa3b
    s_mov_b32 s71, 0x3fb8aa3b
    s_lshl_b32 s60, s24, 4
    s_add_u32 s60, s60, s25
    s_lshl_b32 s59, s60, 17
    s_lshl_b32 s60, s60, 7
    s_add_u32 s60, s60, 0x800000
    s_and_b32 s3, s48, 3
    s_and_b32 s27, s26, 1
    s_lshl2_add_u32 s3, s27, s3
    s_lshl_b32 s27, s3, 11
    s_add_u32 s80, s59, s27
    s_add_u32 s81, s80, 16384
    s_add_u32 s82, s80, 32768
    s_add_u32 s83, s80, 49152
    s_lshl3_add_u32 s3, s25, s3
    s_mul_i32 s87, s3, 28672
    s_mul_i32 s3, s24, 896
    s_add_u32 s87, s87, s3
    s_add_u32 s87, s87, s55
    v_lshrrev_b32 v7, 4, v2
    v_lshrrev_b32 v3, 1, v7
    v_bfe_u32 v8, v2, 2, 2
    v_mul_u32_u24 v9, 14, v3
    v_and_b32 v4, 1, v7
    v_lshl_add_u32 v6, v4, 2, v9
    v_add_u32 v6, v6, v8
    v_mul_u32_u24 v5, 3, v4
    v_min_u32 v8, 2, v8
    v_add3_u32 v9, v9, v5, v8
    v_add_u32 v9, 8, v9
    v_and_b32 v5, 3, v2
    v_lshlrev_b32 v5, 3, v5
    v_add_u32 v5, 0, v5
    v_mul_u32_u24 v8, 224, v6
    v_add_u32 v8, v8, v5
    v_mul_u32_u24 v9, 224, v9
    v_add_u32 v9, v9, v5
    v_lshrrev_b32 v3, 4, v2
    v_bfe_u32 v4, v2, 2, 2
    v_lshl_add_u32 v4, v3, 3, v4
    v_and_b32 v5, 1, v3
    v_lshlrev_b32 v5, 2, v5
    v_add_u32 v6, v4, v5
    v_xor_b32 v7, 4, v6
    v_mul_u32_u24 v6, 224, v6
    v_mul_u32_u24 v7, 224, v7
    v_and_b32 v5, 3, v2
    v_lshl_add_u32 v14, v5, 3, v6
    v_lshl_add_u32 v15, v5, 3, v7
    s_and_b32 s49, s48, 1
    s_lshr_b32 s50, s48, 1
    s_mul_i32 s3, s49, 56
    v_add_u32 v12, s3, v14
    v_add_u32 v13, s3, v15
    v_and_b32 v4, 15, v2
    v_lshrrev_b32 v5, 1, v4
    v_xor_b32 v5, v5, v3
    v_lshlrev_b32 v5, 4, v5
    v_lshl_add_u32 v18, v4, 7, v5
    v_lshl_add_u32 v16, v1, 12, v18
    v_xor_b32 v17, 64, v16
    v_xor_b32 v18, 0x1000, v16
    v_xor_b32 v19, 0x1000, v17
    s_lshl_b32 s3, s23, 2
    s_add_u32 s3, s3, s48
    s_and_b32 s27, s3, 63
    s_lshl_b32 s3, s3, 6
    v_add_u32 v4, s3, v2
    v_min_u32 v4, 6271, v4
    v_lshlrev_b32 v11, 6, v4
    v_mul_u32_u24 v5, 9363, v4
    v_lshrrev_b32 v5, 17, v5
    v_mul_u32_u24 v5, 1792, v5
    v_add_u32 v4, v5, v11
    v_mov_b32 v6, 161792
    v_mov_b32 v7, 1
    s_mov_b32 s30, 0x1c0000
    s_mov_b32 s31, 0x20000
    s_mov_b32 s34, 0x126000
    s_mov_b32 s35, 0x20000
    s_mov_b32 s42, 0x1c00000
    s_mov_b32 s43, 0x20000
    s_mov_b32 s38, 0x62000
    s_mov_b32 s39, 0x20000
    s_mov_b32 s46, 0x100
    s_mov_b32 s47, 0x20000
    s_mov_b32 s90, 0x380000
    s_mov_b32 s91, 0x20000
    s_waitcnt lgkmcnt(0)
    s_and_b32 s41, s41, 0xffff
    s_and_b32 s37, s37, 0xffff
    s_and_b32 s45, s45, 0xffff
    s_and_b32 s89, s89, 0xffff
    s_waitcnt lgkmcnt(0)
    s_and_b32 s29, s29, 0xffff
    s_and_b32 s33, s33, 0xffff
    v_mov_b32 v3, 0
    buffer_load_dword v31, v3, s[40:43], s60 offen sc0 sc1
    s_mul_i32 s3, s25, 229376
    s_mul_i32 s27, s24, 896
    s_add_u32 s3, s3, s27
    buffer_load_dword v30, v3, s[88:91], s3 offen
    buffer_load_dword v30, v3, s[36:39], s55 offen
    buffer_load_dword v30, v3, s[40:43], s59 offen
    s_and_b32 s3, s23, 3
    s_lshl_b32 s3, s3, 2
    s_lshr_b32 s3, 0x546, s3
    s_and_b32 s3, s3, 7
    s_and_b32 s27, s2, 3
    s_lshl1_add_u32 s3, s27, s3
    s_cmp_ge_u32 s3, 7
    s_cselect_b32 s27, 7, 0
    s_sub_u32 s3, s3, s27
    s_lshl_b32 s3, s3, 7
    s_lshl_b32 s27, s25, 7
    s_mul_i32 s27, s27, 896
    s_add_u32 s3, s3, s27
    s_lshl2_add_u32 s27, s26, s48
    s_mul_i32 s27, s27, 8
    v_min_u32 v24, 7, v2
    v_add_u32 v24, s27, v24
    v_lshrrev_b32 v25, 1, v24
    v_and_b32 v24, 1, v24
    v_mul_u32_u24 v25, 896, v25
    v_lshl_add_u32 v24, v24, 6, v25
    s_mov_b32 s30, 0x1c0000
    s_mov_b32 s31, 0x20000
    buffer_load_dword v30, v24, s[28:31], s3 offen
    s_barrier
    v_add_u32 v24, 14336, v16
    v_add_u32 v25, 14336, v17
    v_add_u32 v26, 14336, v18
    v_add_u32 v27, 14336, v19
    v_add_u32 v20, 0, v12
    v_add_u32 v21, 0, v13
    ds_read_b128 a[0:3], v24 offset:0
    ds_read_b128 a[4:7], v24 offset:2048
    ds_read_b128 v[120:123], v26 offset:0
    ds_read_b128 v[124:127], v26 offset:2048
    ds_read_b64_tr_b16 v[96:97], v20 offset:0
    ds_read_b64_tr_b16 v[98:99], v21 offset:0
    ds_read_b64_tr_b16 v[100:101], v20 offset:24
    ds_read_b64_tr_b16 v[102:103], v21 offset:24
    s_waitcnt lgkmcnt(2)
    v_mfma_f32_16x16x32_bf16 v[32:35], a[0:3], v[96:99], 1.0
    ds_read_b64_tr_b16 v[104:105], v20 offset:112
    ds_read_b64_tr_b16 v[106:107], v21 offset:112
    v_mfma_f32_16x16x32_bf16 v[36:39], a[4:7], v[96:99], 1.0
    ds_read_b64_tr_b16 v[108:109], v20 offset:144
    v_mfma_f32_16x16x32_bf16 v[40:43], v[120:123], v[96:99], 1.0
    ds_read_b64_tr_b16 v[110:111], v21 offset:144
    v_mfma_f32_16x16x32_bf16 v[44:47], v[124:127], v[96:99], 1.0
    ds_read_b128 a[8:11], v25 offset:0
    s_waitcnt lgkmcnt(5)
    v_mfma_f32_16x16x32_bf16 v[48:51], a[0:3], v[100:103], 1.0
    ds_read_b128 a[12:15], v25 offset:2048
    v_mfma_f32_16x16x32_bf16 v[52:55], a[4:7], v[100:103], 1.0
    ds_read_b128 v[128:131], v27 offset:0
    v_mfma_f32_16x16x32_bf16 v[56:59], v[120:123], v[100:103], 1.0
    ds_read_b128 v[132:135], v27 offset:2048
    v_mfma_f32_16x16x32_bf16 v[60:63], v[124:127], v[100:103], 1.0
    ds_read_b64_tr_b16 v[112:113], v20 offset:7168
    s_waitcnt lgkmcnt(7)
    v_mfma_f32_16x16x32_bf16 v[64:67], a[0:3], v[104:107], 0
    ds_read_b64_tr_b16 v[114:115], v21 offset:7168
    v_mfma_f32_16x16x32_bf16 v[68:71], a[4:7], v[104:107], 0
    ds_read_b64_tr_b16 v[116:117], v20 offset:7192
    v_mfma_f32_16x16x32_bf16 v[72:75], v[120:123], v[104:107], 0
    ds_read_b64_tr_b16 v[118:119], v21 offset:7192
    v_mfma_f32_16x16x32_bf16 v[76:79], v[124:127], v[104:107], 0
    ds_read_b64_tr_b16 v[96:97], v20 offset:7280
    s_waitcnt lgkmcnt(9)
    v_mfma_f32_16x16x32_bf16 v[80:83], a[0:3], v[108:111], 0
    ds_read_b64_tr_b16 v[98:99], v21 offset:7280
    v_mfma_f32_16x16x32_bf16 v[84:87], a[4:7], v[108:111], 0
    ds_read_b64_tr_b16 v[100:101], v20 offset:7312
    v_mfma_f32_16x16x32_bf16 v[88:91], v[120:123], v[108:111], 0
    ds_read_b64_tr_b16 v[102:103], v21 offset:7312
    v_mfma_f32_16x16x32_bf16 v[92:95], v[124:127], v[108:111], 0
    s_waitcnt lgkmcnt(6)
    v_mfma_f32_16x16x32_bf16 v[32:35], a[8:11], v[112:115], v[32:35]
    v_mfma_f32_16x16x32_bf16 v[36:39], a[12:15], v[112:115], v[36:39]
    v_mfma_f32_16x16x32_bf16 v[40:43], v[128:131], v[112:115], v[40:43]
    v_mfma_f32_16x16x32_bf16 v[44:47], v[132:135], v[112:115], v[44:47]
    s_waitcnt lgkmcnt(4)
    v_mfma_f32_16x16x32_bf16 v[48:51], a[8:11], v[116:119], v[48:51]
    v_mfma_f32_16x16x32_bf16 v[52:55], a[12:15], v[116:119], v[52:55]
    v_mfma_f32_16x16x32_bf16 v[56:59], v[128:131], v[116:119], v[56:59]
    v_mfma_f32_16x16x32_bf16 v[60:63], v[132:135], v[116:119], v[60:63]
    s_waitcnt lgkmcnt(2)
    v_mfma_f32_16x16x32_bf16 v[64:67], a[8:11], v[96:99], v[64:67]
    v_mfma_f32_16x16x32_bf16 v[68:71], a[12:15], v[96:99], v[68:71]
    s_barrier
    v_add_u32 v24, 45056, v16
    v_add_u32 v25, 45056, v17
    v_add_u32 v26, 45056, v18
    v_add_u32 v27, 45056, v19
    v_add_u32 v22, 30720, v12
    v_add_u32 v23, 30720, v13
    ds_read_b128 a[16:19], v24 offset:0
    v_mfma_f32_16x16x32_bf16 v[72:75], v[128:131], v[96:99], v[72:75]
    ds_read_b128 a[20:23], v24 offset:2048
    ds_read_b128 v[136:139], v26 offset:0
    v_mfma_f32_16x16x32_bf16 v[76:79], v[132:135], v[96:99], v[76:79]
    ds_read_b128 v[140:143], v26 offset:2048
    ds_read_b64_tr_b16 v[104:105], v22 offset:0
    s_waitcnt lgkmcnt(5)
    v_mfma_f32_16x16x32_bf16 v[80:83], a[8:11], v[100:103], v[80:83]
    ds_read_b64_tr_b16 v[106:107], v23 offset:0
    ds_read_b64_tr_b16 v[108:109], v22 offset:24
    v_mfma_f32_16x16x32_bf16 v[84:87], a[12:15], v[100:103], v[84:87]
    ds_read_b64_tr_b16 v[110:111], v23 offset:24
    v_mfma_f32_16x16x32_bf16 v[88:91], v[128:131], v[100:103], v[88:91]
    ds_read_b64_tr_b16 v[112:113], v22 offset:112
    v_mfma_f32_16x16x32_bf16 v[92:95], v[132:135], v[100:103], v[92:95]
    ds_read_b64_tr_b16 v[114:115], v23 offset:112
    s_waitcnt lgkmcnt(4)
    v_mfma_f32_16x16x32_bf16 v[32:35], a[16:19], v[104:107], v[32:35]
    ds_read_b64_tr_b16 v[116:117], v22 offset:144
    v_mfma_f32_16x16x32_bf16 v[36:39], a[20:23], v[104:107], v[36:39]
    ds_read_b64_tr_b16 v[118:119], v23 offset:144
    v_mfma_f32_16x16x32_bf16 v[40:43], v[136:139], v[104:107], v[40:43]
    ds_read_b128 a[24:27], v25 offset:0
    v_mfma_f32_16x16x32_bf16 v[44:47], v[140:143], v[104:107], v[44:47]
    ds_read_b128 a[28:31], v25 offset:2048
    s_waitcnt lgkmcnt(6)
    v_mfma_f32_16x16x32_bf16 v[48:51], a[16:19], v[108:111], v[48:51]
    ds_read_b128 v[120:123], v27 offset:0
    v_mfma_f32_16x16x32_bf16 v[52:55], a[20:23], v[108:111], v[52:55]
    ds_read_b128 v[124:127], v27 offset:2048
    v_mfma_f32_16x16x32_bf16 v[56:59], v[136:139], v[108:111], v[56:59]
    ds_read_b64_tr_b16 v[96:97], v22 offset:7168
    v_mfma_f32_16x16x32_bf16 v[60:63], v[140:143], v[108:111], v[60:63]
    ds_read_b64_tr_b16 v[98:99], v23 offset:7168
    s_waitcnt lgkmcnt(8)
    v_mfma_f32_16x16x32_bf16 v[64:67], a[16:19], v[112:115], v[64:67]
    ds_read_b64_tr_b16 v[100:101], v22 offset:7192
    v_mfma_f32_16x16x32_bf16 v[68:71], a[20:23], v[112:115], v[68:71]
    ds_read_b64_tr_b16 v[102:103], v23 offset:7192
    v_mfma_f32_16x16x32_bf16 v[72:75], v[136:139], v[112:115], v[72:75]
    ds_read_b64_tr_b16 v[104:105], v22 offset:7280
    v_mfma_f32_16x16x32_bf16 v[76:79], v[140:143], v[112:115], v[76:79]
    ds_read_b64_tr_b16 v[106:107], v23 offset:7280
    s_waitcnt lgkmcnt(10)
    v_mfma_f32_16x16x32_bf16 v[80:83], a[16:19], v[116:119], v[80:83]
    ds_read_b64_tr_b16 v[108:109], v22 offset:7312
    v_mfma_f32_16x16x32_bf16 v[84:87], a[20:23], v[116:119], v[84:87]
    ds_read_b64_tr_b16 v[110:111], v23 offset:7312
    v_mfma_f32_16x16x32_bf16 v[88:91], v[136:139], v[116:119], v[88:91]
    v_mfma_f32_16x16x32_bf16 v[92:95], v[140:143], v[116:119], v[92:95]
    s_waitcnt lgkmcnt(6)
    v_mfma_f32_16x16x32_bf16 v[32:35], a[24:27], v[96:99], v[32:35]
    v_mfma_f32_16x16x32_bf16 v[36:39], a[28:31], v[96:99], v[36:39]
    v_mfma_f32_16x16x32_bf16 v[40:43], v[120:123], v[96:99], v[40:43]
    v_mfma_f32_16x16x32_bf16 v[44:47], v[124:127], v[96:99], v[44:47]
    s_waitcnt lgkmcnt(4)
    v_mfma_f32_16x16x32_bf16 v[48:51], a[24:27], v[100:103], v[48:51]
    v_mfma_f32_16x16x32_bf16 v[52:55], a[28:31], v[100:103], v[52:55]
    v_mfma_f32_16x16x32_bf16 v[56:59], v[120:123], v[100:103], v[56:59]
    v_mfma_f32_16x16x32_bf16 v[60:63], v[124:127], v[100:103], v[60:63]
    s_waitcnt lgkmcnt(2)
    v_mfma_f32_16x16x32_bf16 v[64:67], a[24:27], v[104:107], v[64:67]
    v_mfma_f32_16x16x32_bf16 v[68:71], a[28:31], v[104:107], v[68:71]
    s_barrier
    v_add_u32 v24, 75776, v16
    v_add_u32 v25, 75776, v17
    v_add_u32 v26, 75776, v18
    v_add_u32 v27, 75776, v19
    v_add_u32 v20, 61440, v12
    v_add_u32 v21, 61440, v13
    ds_read_b128 a[32:35], v24 offset:0
    v_mfma_f32_16x16x32_bf16 v[72:75], v[120:123], v[104:107], v[72:75]
    ds_read_b128 a[36:39], v24 offset:2048
    ds_read_b128 v[128:131], v26 offset:0
    v_mfma_f32_16x16x32_bf16 v[76:79], v[124:127], v[104:107], v[76:79]
    ds_read_b128 v[132:135], v26 offset:2048
    ds_read_b64_tr_b16 v[112:113], v20 offset:0
    s_waitcnt lgkmcnt(5)
    v_mfma_f32_16x16x32_bf16 v[80:83], a[24:27], v[108:111], v[80:83]
    ds_read_b64_tr_b16 v[114:115], v21 offset:0
    ds_read_b64_tr_b16 v[116:117], v20 offset:24
    v_mfma_f32_16x16x32_bf16 v[84:87], a[28:31], v[108:111], v[84:87]
    ds_read_b64_tr_b16 v[118:119], v21 offset:24
    v_mfma_f32_16x16x32_bf16 v[88:91], v[120:123], v[108:111], v[88:91]
    ds_read_b64_tr_b16 v[96:97], v20 offset:112
    v_mfma_f32_16x16x32_bf16 v[92:95], v[124:127], v[108:111], v[92:95]
    ds_read_b64_tr_b16 v[98:99], v21 offset:112
    s_waitcnt lgkmcnt(4)
    v_mfma_f32_16x16x32_bf16 v[32:35], a[32:35], v[112:115], v[32:35]
    ds_read_b64_tr_b16 v[100:101], v20 offset:144
    v_mfma_f32_16x16x32_bf16 v[36:39], a[36:39], v[112:115], v[36:39]
    ds_read_b64_tr_b16 v[102:103], v21 offset:144
    v_mfma_f32_16x16x32_bf16 v[40:43], v[128:131], v[112:115], v[40:43]
    ds_read_b128 a[40:43], v25 offset:0
    v_mfma_f32_16x16x32_bf16 v[44:47], v[132:135], v[112:115], v[44:47]
    ds_read_b128 a[44:47], v25 offset:2048
    s_waitcnt lgkmcnt(6)
    v_mfma_f32_16x16x32_bf16 v[48:51], a[32:35], v[116:119], v[48:51]
    ds_read_b128 v[136:139], v27 offset:0
    v_mfma_f32_16x16x32_bf16 v[52:55], a[36:39], v[116:119], v[52:55]
    ds_read_b128 v[140:143], v27 offset:2048
    v_mfma_f32_16x16x32_bf16 v[56:59], v[128:131], v[116:119], v[56:59]
    ds_read_b64_tr_b16 v[104:105], v20 offset:7168
    v_mfma_f32_16x16x32_bf16 v[60:63], v[132:135], v[116:119], v[60:63]
    ds_read_b64_tr_b16 v[106:107], v21 offset:7168
    s_waitcnt lgkmcnt(8)
    v_mfma_f32_16x16x32_bf16 v[64:67], a[32:35], v[96:99], v[64:67]
    ds_read_b64_tr_b16 v[108:109], v20 offset:7192
    v_mfma_f32_16x16x32_bf16 v[68:71], a[36:39], v[96:99], v[68:71]
    ds_read_b64_tr_b16 v[110:111], v21 offset:7192
    v_mfma_f32_16x16x32_bf16 v[72:75], v[128:131], v[96:99], v[72:75]
    ds_read_b64_tr_b16 v[112:113], v20 offset:7280
    v_mfma_f32_16x16x32_bf16 v[76:79], v[132:135], v[96:99], v[76:79]
    ds_read_b64_tr_b16 v[114:115], v21 offset:7280
    s_waitcnt lgkmcnt(10)
    v_mfma_f32_16x16x32_bf16 v[80:83], a[32:35], v[100:103], v[80:83]
    ds_read_b64_tr_b16 v[116:117], v20 offset:7312
    v_mfma_f32_16x16x32_bf16 v[84:87], a[36:39], v[100:103], v[84:87]
    ds_read_b64_tr_b16 v[118:119], v21 offset:7312
    v_mfma_f32_16x16x32_bf16 v[88:91], v[128:131], v[100:103], v[88:91]
    v_mfma_f32_16x16x32_bf16 v[92:95], v[132:135], v[100:103], v[92:95]
    s_waitcnt lgkmcnt(6)
    v_mfma_f32_16x16x32_bf16 v[32:35], a[40:43], v[104:107], v[32:35]
    v_mfma_f32_16x16x32_bf16 v[36:39], a[44:47], v[104:107], v[36:39]
    v_mfma_f32_16x16x32_bf16 v[40:43], v[136:139], v[104:107], v[40:43]
    v_mfma_f32_16x16x32_bf16 v[44:47], v[140:143], v[104:107], v[44:47]
    s_waitcnt lgkmcnt(4)
    v_mfma_f32_16x16x32_bf16 v[48:51], a[40:43], v[108:111], v[48:51]
    v_mfma_f32_16x16x32_bf16 v[52:55], a[44:47], v[108:111], v[52:55]
    v_mfma_f32_16x16x32_bf16 v[56:59], v[136:139], v[108:111], v[56:59]
    v_mfma_f32_16x16x32_bf16 v[60:63], v[140:143], v[108:111], v[60:63]
    s_waitcnt lgkmcnt(2)
    v_mfma_f32_16x16x32_bf16 v[64:67], a[40:43], v[112:115], v[64:67]
    v_mfma_f32_16x16x32_bf16 v[68:71], a[44:47], v[112:115], v[68:71]
    s_barrier
    v_add_u32 v24, 106496, v16
    v_add_u32 v25, 106496, v17
    v_add_u32 v26, 106496, v18
    v_add_u32 v27, 106496, v19
    v_add_u32 v22, 92160, v12
    v_add_u32 v23, 92160, v13
    ds_read_b128 a[48:51], v24 offset:0
    v_mfma_f32_16x16x32_bf16 v[72:75], v[136:139], v[112:115], v[72:75]
    ds_read_b128 a[52:55], v24 offset:2048
    ds_read_b128 v[120:123], v26 offset:0
    v_mfma_f32_16x16x32_bf16 v[76:79], v[140:143], v[112:115], v[76:79]
    ds_read_b128 v[124:127], v26 offset:2048
    ds_read_b64_tr_b16 v[96:97], v22 offset:0
    s_waitcnt lgkmcnt(5)
    v_mfma_f32_16x16x32_bf16 v[80:83], a[40:43], v[116:119], v[80:83]
    ds_read_b64_tr_b16 v[98:99], v23 offset:0
    ds_read_b64_tr_b16 v[100:101], v22 offset:24
    v_mfma_f32_16x16x32_bf16 v[84:87], a[44:47], v[116:119], v[84:87]
    ds_read_b64_tr_b16 v[102:103], v23 offset:24
    v_mfma_f32_16x16x32_bf16 v[88:91], v[136:139], v[116:119], v[88:91]
    ds_read_b64_tr_b16 v[104:105], v22 offset:112
    v_mfma_f32_16x16x32_bf16 v[92:95], v[140:143], v[116:119], v[92:95]
    ds_read_b64_tr_b16 v[106:107], v23 offset:112
    s_waitcnt lgkmcnt(4)
    v_mfma_f32_16x16x32_bf16 v[32:35], a[48:51], v[96:99], v[32:35]
    ds_read_b64_tr_b16 v[108:109], v22 offset:144
    v_mfma_f32_16x16x32_bf16 v[36:39], a[52:55], v[96:99], v[36:39]
    ds_read_b64_tr_b16 v[110:111], v23 offset:144
    v_mfma_f32_16x16x32_bf16 v[40:43], v[120:123], v[96:99], v[40:43]
    ds_read_b128 a[56:59], v25 offset:0
    v_mfma_f32_16x16x32_bf16 v[44:47], v[124:127], v[96:99], v[44:47]
    ds_read_b128 a[60:63], v25 offset:2048
    s_waitcnt lgkmcnt(6)
    v_mfma_f32_16x16x32_bf16 v[48:51], a[48:51], v[100:103], v[48:51]
    ds_read_b128 v[128:131], v27 offset:0
    v_mfma_f32_16x16x32_bf16 v[52:55], a[52:55], v[100:103], v[52:55]
    ds_read_b128 v[132:135], v27 offset:2048
    v_mfma_f32_16x16x32_bf16 v[56:59], v[120:123], v[100:103], v[56:59]
    ds_read_b64_tr_b16 v[112:113], v22 offset:7168
    v_mfma_f32_16x16x32_bf16 v[60:63], v[124:127], v[100:103], v[60:63]
    ds_read_b64_tr_b16 v[114:115], v23 offset:7168
    s_waitcnt lgkmcnt(8)
    v_mfma_f32_16x16x32_bf16 v[64:67], a[48:51], v[104:107], v[64:67]
    ds_read_b64_tr_b16 v[116:117], v22 offset:7192
    v_mfma_f32_16x16x32_bf16 v[68:71], a[52:55], v[104:107], v[68:71]
    ds_read_b64_tr_b16 v[118:119], v23 offset:7192
    v_mfma_f32_16x16x32_bf16 v[72:75], v[120:123], v[104:107], v[72:75]
    ds_read_b64_tr_b16 v[96:97], v22 offset:7280
    v_mfma_f32_16x16x32_bf16 v[76:79], v[124:127], v[104:107], v[76:79]
    ds_read_b64_tr_b16 v[98:99], v23 offset:7280
    s_waitcnt lgkmcnt(10)
    v_mfma_f32_16x16x32_bf16 v[80:83], a[48:51], v[108:111], v[80:83]
    ds_read_b64_tr_b16 v[100:101], v22 offset:7312
    v_mfma_f32_16x16x32_bf16 v[84:87], a[52:55], v[108:111], v[84:87]
    ds_read_b64_tr_b16 v[102:103], v23 offset:7312
    v_mfma_f32_16x16x32_bf16 v[88:91], v[120:123], v[108:111], v[88:91]
    v_mfma_f32_16x16x32_bf16 v[92:95], v[124:127], v[108:111], v[92:95]
    s_waitcnt lgkmcnt(6)
    v_mfma_f32_16x16x32_bf16 v[32:35], a[56:59], v[112:115], v[32:35]
    v_mfma_f32_16x16x32_bf16 v[36:39], a[60:63], v[112:115], v[36:39]
    v_mfma_f32_16x16x32_bf16 v[40:43], v[128:131], v[112:115], v[40:43]
    v_mfma_f32_16x16x32_bf16 v[44:47], v[132:135], v[112:115], v[44:47]
    s_waitcnt lgkmcnt(4)
    v_mfma_f32_16x16x32_bf16 v[48:51], a[56:59], v[116:119], v[48:51]
    v_mfma_f32_16x16x32_bf16 v[52:55], a[60:63], v[116:119], v[52:55]
    v_mfma_f32_16x16x32_bf16 v[56:59], v[128:131], v[116:119], v[56:59]
    v_mfma_f32_16x16x32_bf16 v[60:63], v[132:135], v[116:119], v[60:63]
    s_waitcnt lgkmcnt(2)
    v_mfma_f32_16x16x32_bf16 v[64:67], a[56:59], v[96:99], v[64:67]
    v_mfma_f32_16x16x32_bf16 v[68:71], a[60:63], v[96:99], v[68:71]
    s_barrier
    v_add_u32 v24, 137216, v16
    v_add_u32 v25, 137216, v17
    v_add_u32 v26, 137216, v18
    v_add_u32 v27, 137216, v19
    v_add_u32 v20, 122880, v12
    v_add_u32 v21, 122880, v13
    ds_read_b128 a[64:67], v24 offset:0
    v_mfma_f32_16x16x32_bf16 v[72:75], v[128:131], v[96:99], v[72:75]
    ds_read_b128 a[68:71], v24 offset:2048
    ds_read_b128 v[136:139], v26 offset:0
    v_mfma_f32_16x16x32_bf16 v[76:79], v[132:135], v[96:99], v[76:79]
    ds_read_b128 v[140:143], v26 offset:2048
    ds_read_b64_tr_b16 v[104:105], v20 offset:0
    s_waitcnt lgkmcnt(5)
    v_mfma_f32_16x16x32_bf16 v[80:83], a[56:59], v[100:103], v[80:83]
    ds_read_b64_tr_b16 v[106:107], v21 offset:0
    ds_read_b64_tr_b16 v[108:109], v20 offset:24
    v_mfma_f32_16x16x32_bf16 v[84:87], a[60:63], v[100:103], v[84:87]
    ds_read_b64_tr_b16 v[110:111], v21 offset:24
    v_mfma_f32_16x16x32_bf16 v[88:91], v[128:131], v[100:103], v[88:91]
    ds_read_b64_tr_b16 v[112:113], v20 offset:112
    v_mfma_f32_16x16x32_bf16 v[92:95], v[132:135], v[100:103], v[92:95]
    ds_read_b64_tr_b16 v[114:115], v21 offset:112
    s_waitcnt lgkmcnt(4)
    v_mfma_f32_16x16x32_bf16 v[32:35], a[64:67], v[104:107], v[32:35]
    ds_read_b64_tr_b16 v[116:117], v20 offset:144
    v_mfma_f32_16x16x32_bf16 v[36:39], a[68:71], v[104:107], v[36:39]
    ds_read_b64_tr_b16 v[118:119], v21 offset:144
    v_mfma_f32_16x16x32_bf16 v[40:43], v[136:139], v[104:107], v[40:43]
    ds_read_b128 a[72:75], v25 offset:0
    v_mfma_f32_16x16x32_bf16 v[44:47], v[140:143], v[104:107], v[44:47]
    ds_read_b128 a[76:79], v25 offset:2048
    s_waitcnt lgkmcnt(6)
    v_mfma_f32_16x16x32_bf16 v[48:51], a[64:67], v[108:111], v[48:51]
    ds_read_b128 v[120:123], v27 offset:0
    v_mfma_f32_16x16x32_bf16 v[52:55], a[68:71], v[108:111], v[52:55]
    ds_read_b128 v[124:127], v27 offset:2048
    v_mfma_f32_16x16x32_bf16 v[56:59], v[136:139], v[108:111], v[56:59]
    ds_read_b64_tr_b16 v[96:97], v20 offset:7168
    v_mfma_f32_16x16x32_bf16 v[60:63], v[140:143], v[108:111], v[60:63]
    ds_read_b64_tr_b16 v[98:99], v21 offset:7168
    s_waitcnt lgkmcnt(8)
    v_mfma_f32_16x16x32_bf16 v[64:67], a[64:67], v[112:115], v[64:67]
    ds_read_b64_tr_b16 v[100:101], v20 offset:7192
    v_mfma_f32_16x16x32_bf16 v[68:71], a[68:71], v[112:115], v[68:71]
    ds_read_b64_tr_b16 v[102:103], v21 offset:7192
    v_mfma_f32_16x16x32_bf16 v[72:75], v[136:139], v[112:115], v[72:75]
    ds_read_b64_tr_b16 v[104:105], v20 offset:7280
    v_mfma_f32_16x16x32_bf16 v[76:79], v[140:143], v[112:115], v[76:79]
    ds_read_b64_tr_b16 v[106:107], v21 offset:7280
    s_waitcnt lgkmcnt(10)
    v_mfma_f32_16x16x32_bf16 v[80:83], a[64:67], v[116:119], v[80:83]
    ds_read_b64_tr_b16 v[108:109], v20 offset:7312
    v_mfma_f32_16x16x32_bf16 v[84:87], a[68:71], v[116:119], v[84:87]
    ds_read_b64_tr_b16 v[110:111], v21 offset:7312
    v_mfma_f32_16x16x32_bf16 v[88:91], v[136:139], v[116:119], v[88:91]
    v_mfma_f32_16x16x32_bf16 v[92:95], v[140:143], v[116:119], v[92:95]
    s_waitcnt lgkmcnt(6)
    v_mfma_f32_16x16x32_bf16 v[32:35], a[72:75], v[96:99], v[32:35]
    v_mfma_f32_16x16x32_bf16 v[36:39], a[76:79], v[96:99], v[36:39]
    v_mfma_f32_16x16x32_bf16 v[40:43], v[120:123], v[96:99], v[40:43]
    v_mfma_f32_16x16x32_bf16 v[44:47], v[124:127], v[96:99], v[44:47]
    s_waitcnt lgkmcnt(4)
    v_mfma_f32_16x16x32_bf16 v[48:51], a[72:75], v[100:103], v[48:51]
    v_mfma_f32_16x16x32_bf16 v[52:55], a[76:79], v[100:103], v[52:55]
    v_mfma_f32_16x16x32_bf16 v[56:59], v[120:123], v[100:103], v[56:59]
    v_mfma_f32_16x16x32_bf16 v[60:63], v[124:127], v[100:103], v[60:63]
    s_waitcnt lgkmcnt(2)
    v_mfma_f32_16x16x32_bf16 v[64:67], a[72:75], v[104:107], v[64:67]
    v_mfma_f32_16x16x32_bf16 v[68:71], a[76:79], v[104:107], v[68:71]
    s_barrier
    buffer_load_dword v30, v11, s[36:39], 0 offen
    v_add_u32 v24, 14336, v16
    v_add_u32 v25, 14336, v17
    v_add_u32 v26, 14336, v18
    v_add_u32 v27, 14336, v19
    v_add_u32 v22, 0, v12
    v_add_u32 v23, 0, v13
    ds_read_b128 a[80:83], v24 offset:0
    v_mfma_f32_16x16x32_bf16 v[72:75], v[120:123], v[104:107], v[72:75]
    ds_read_b128 a[84:87], v24 offset:2048
    ds_read_b128 v[128:131], v26 offset:0
    v_mfma_f32_16x16x32_bf16 v[76:79], v[124:127], v[104:107], v[76:79]
    ds_read_b128 v[132:135], v26 offset:2048
    ds_read_b64_tr_b16 v[112:113], v22 offset:0
    s_waitcnt lgkmcnt(5)
    v_mfma_f32_16x16x32_bf16 v[80:83], a[72:75], v[108:111], v[80:83]
    ds_read_b64_tr_b16 v[114:115], v23 offset:0
    ds_read_b64_tr_b16 v[116:117], v22 offset:24
    v_mfma_f32_16x16x32_bf16 v[84:87], a[76:79], v[108:111], v[84:87]
    ds_read_b64_tr_b16 v[118:119], v23 offset:24
    v_mfma_f32_16x16x32_bf16 v[88:91], v[120:123], v[108:111], v[88:91]
    ds_read_b64_tr_b16 v[96:97], v22 offset:112
    v_mfma_f32_16x16x32_bf16 v[92:95], v[124:127], v[108:111], v[92:95]
    ds_read_b64_tr_b16 v[98:99], v23 offset:112
    s_waitcnt lgkmcnt(4)
    v_mfma_f32_16x16x32_bf16 v[32:35], a[80:83], v[112:115], v[32:35]
    ds_read_b64_tr_b16 v[100:101], v22 offset:144
    v_mfma_f32_16x16x32_bf16 v[36:39], a[84:87], v[112:115], v[36:39]
    ds_read_b64_tr_b16 v[102:103], v23 offset:144
    v_mfma_f32_16x16x32_bf16 v[40:43], v[128:131], v[112:115], v[40:43]
    ds_read_b128 a[88:91], v25 offset:0
    v_mfma_f32_16x16x32_bf16 v[44:47], v[132:135], v[112:115], v[44:47]
    ds_read_b128 a[92:95], v25 offset:2048
    s_waitcnt lgkmcnt(6)
    v_mfma_f32_16x16x32_bf16 v[48:51], a[80:83], v[116:119], v[48:51]
    ds_read_b128 v[136:139], v27 offset:0
    v_mfma_f32_16x16x32_bf16 v[52:55], a[84:87], v[116:119], v[52:55]
    ds_read_b128 v[140:143], v27 offset:2048
    v_mfma_f32_16x16x32_bf16 v[56:59], v[128:131], v[116:119], v[56:59]
    ds_read_b64_tr_b16 v[104:105], v22 offset:7168
    v_mfma_f32_16x16x32_bf16 v[60:63], v[132:135], v[116:119], v[60:63]
    ds_read_b64_tr_b16 v[106:107], v23 offset:7168
    s_waitcnt lgkmcnt(8)
    v_mfma_f32_16x16x32_bf16 v[64:67], a[80:83], v[96:99], v[64:67]
    ds_read_b64_tr_b16 v[108:109], v22 offset:7192
    v_mfma_f32_16x16x32_bf16 v[68:71], a[84:87], v[96:99], v[68:71]
    ds_read_b64_tr_b16 v[110:111], v23 offset:7192
    v_mfma_f32_16x16x32_bf16 v[72:75], v[128:131], v[96:99], v[72:75]
    ds_read_b64_tr_b16 v[112:113], v22 offset:7280
    v_mfma_f32_16x16x32_bf16 v[76:79], v[132:135], v[96:99], v[76:79]
    ds_read_b64_tr_b16 v[114:115], v23 offset:7280
    s_waitcnt lgkmcnt(10)
    v_mfma_f32_16x16x32_bf16 v[80:83], a[80:83], v[100:103], v[80:83]
    ds_read_b64_tr_b16 v[116:117], v22 offset:7312
    v_mfma_f32_16x16x32_bf16 v[84:87], a[84:87], v[100:103], v[84:87]
    ds_read_b64_tr_b16 v[118:119], v23 offset:7312
    v_mfma_f32_16x16x32_bf16 v[88:91], v[128:131], v[100:103], v[88:91]
    v_mfma_f32_16x16x32_bf16 v[92:95], v[132:135], v[100:103], v[92:95]
    s_waitcnt lgkmcnt(6)
    v_mfma_f32_16x16x32_bf16 v[32:35], a[88:91], v[104:107], v[32:35]
    v_mfma_f32_16x16x32_bf16 v[36:39], a[92:95], v[104:107], v[36:39]
    v_mfma_f32_16x16x32_bf16 v[40:43], v[136:139], v[104:107], v[40:43]
    v_mfma_f32_16x16x32_bf16 v[44:47], v[140:143], v[104:107], v[44:47]
    s_waitcnt lgkmcnt(4)
    v_mfma_f32_16x16x32_bf16 v[48:51], a[88:91], v[108:111], v[48:51]
    v_mfma_f32_16x16x32_bf16 v[52:55], a[92:95], v[108:111], v[52:55]
    v_mfma_f32_16x16x32_bf16 v[56:59], v[136:139], v[108:111], v[56:59]
    v_mfma_f32_16x16x32_bf16 v[60:63], v[140:143], v[108:111], v[60:63]
    s_waitcnt lgkmcnt(2)
    v_mfma_f32_16x16x32_bf16 v[64:67], a[88:91], v[112:115], v[64:67]
    v_mfma_f32_16x16x32_bf16 v[68:71], a[92:95], v[112:115], v[68:71]
    v_mfma_f32_16x16x32_bf16 v[72:75], v[136:139], v[112:115], v[72:75]
    v_mfma_f32_16x16x32_bf16 v[76:79], v[140:143], v[112:115], v[76:79]
    s_waitcnt lgkmcnt(0)
    v_mfma_f32_16x16x32_bf16 v[80:83], a[88:91], v[116:119], v[80:83]
    s_waitcnt vmcnt(1)
    s_barrier
    v_add_u32 v24, 45056, v16
    v_add_u32 v25, 45056, v17
    v_add_u32 v26, 45056, v18
    v_add_u32 v27, 45056, v19
    v_add_u32 v20, 30720, v12
    v_add_u32 v21, 30720, v13
    ds_read_b128 a[96:99], v24 offset:0
    v_mfma_f32_16x16x32_bf16 v[84:87], a[92:95], v[116:119], v[84:87]
    ds_read_b128 a[100:103], v24 offset:2048
    ds_read_b128 v[120:123], v26 offset:0
    v_mfma_f32_16x16x32_bf16 v[88:91], v[136:139], v[116:119], v[88:91]
    ds_read_b128 v[124:127], v26 offset:2048
    ds_read_b64_tr_b16 v[96:97], v20 offset:0
    v_mfma_f32_16x16x32_bf16 v[92:95], v[140:143], v[116:119], v[92:95]
    ds_read_b64_tr_b16 v[98:99], v21 offset:0
    ds_read_b128 a[104:107], v25 offset:0
    ds_read_b128 a[108:111], v25 offset:2048
    s_waitcnt lgkmcnt(2)
    v_mfma_f32_16x16x32_bf16 v[32:35], a[96:99], v[96:99], v[32:35]
    v_and_b32 v5, 15, v2
    v_mov_b32 v7, 0x3f803f80
    s_lshl_b32 s3, s49, 13
    s_lshl_b32 s27, s50, 11
    ds_read_b128 v[128:131], v27 offset:0
    ds_read_b128 v[132:135], v27 offset:2048
    v_mfma_f32_16x16x32_bf16 v[36:39], a[100:103], v[96:99], v[36:39]
    v_cmp_le_u32 s[64:65], 12, v5
    s_add_u32 s3, s3, s27
    v_lshlrev_b32 v3, 4, v2
    s_add_u32 s3, s3, 0
    ds_read_b64_tr_b16 v[100:101], v20 offset:7168
    ds_read_b64_tr_b16 v[102:103], v21 offset:7168
    v_mfma_f32_16x16x32_bf16 v[40:43], v[120:123], v[96:99], v[40:43]
    v_lshrrev_b32 v6, 4, v2
    v_add_u32 v4, s3, v3
    ds_read_b64_tr_b16 v[104:105], v20 offset:24
    ds_read_b64_tr_b16 v[106:107], v21 offset:24
    v_mfma_f32_16x16x32_bf16 v[44:47], v[124:127], v[96:99], v[44:47]
    ds_read_b64_tr_b16 v[108:109], v20 offset:7192
    s_waitcnt lgkmcnt(3)
    v_mfma_f32_16x16x32_bf16 v[32:35], a[104:107], v[100:103], v[32:35]
    ds_read_b64_tr_b16 v[110:111], v21 offset:7192
    v_mfma_f32_16x16x32_bf16 v[36:39], a[108:111], v[100:103], v[36:39]
    ds_read_b64_tr_b16 v[112:113], v20 offset:112
    v_mfma_f32_16x16x32_bf16 v[40:43], v[128:131], v[100:103], v[40:43]
    ds_read_b64_tr_b16 v[114:115], v21 offset:112
    v_mfma_f32_16x16x32_bf16 v[44:47], v[132:135], v[100:103], v[44:47]
    v_fma_f32 v12, v32, s70, -s70
    v_fma_f32 v16, v34, s70, -s70
    v_fma_f32 v13, v33, s70, -s70
    v_fma_f32 v17, v35, s70, -s70
    ds_read_b64_tr_b16 v[116:117], v20 offset:7280
    s_waitcnt lgkmcnt(5)
    v_mfma_f32_16x16x32_bf16 v[48:51], a[96:99], v[104:107], v[48:51]
    v_exp_f32 v12, v12 clamp
    v_exp_f32 v16, v16 clamp
    v_exp_f32 v13, v13 clamp
    v_exp_f32 v17, v17 clamp
    ds_read_b64_tr_b16 v[118:119], v21 offset:7280
    v_mfma_f32_16x16x32_bf16 v[52:55], a[100:103], v[104:107], v[52:55]
    v_max_f32 v12, v12, v32
    v_max_f32 v16, v16, v34
    v_max_f32 v13, v13, v33
    v_max_f32 v17, v17, v35
    ds_read_b64_tr_b16 v[96:97], v20 offset:144
    v_mfma_f32_16x16x32_bf16 v[56:59], v[120:123], v[104:107], v[56:59]
    v_cvt_pk_bf16_f32 v32, v12, v13
    v_cvt_pk_bf16_f32 v33, v16, v17
    v_fma_f32 v18, v36, s70, -s70
    v_fma_f32 v22, v38, s70, -s70
    ds_read_b64_tr_b16 v[98:99], v21 offset:144
    v_mfma_f32_16x16x32_bf16 v[60:63], v[124:127], v[104:107], v[60:63]
    v_fma_f32 v19, v37, s70, -s70
    v_fma_f32 v23, v39, s70, -s70
    v_exp_f32 v18, v18 clamp
    v_exp_f32 v22, v22 clamp
    ds_read_b64_tr_b16 v[100:101], v20 offset:7312
    s_waitcnt lgkmcnt(7)
    v_mfma_f32_16x16x32_bf16 v[48:51], a[104:107], v[108:111], v[48:51]
    v_exp_f32 v19, v19 clamp
    v_exp_f32 v23, v23 clamp
    v_max_f32 v18, v18, v36
    v_max_f32 v22, v22, v38
    ds_read_b64_tr_b16 v[102:103], v21 offset:7312
    v_mfma_f32_16x16x32_bf16 v[52:55], a[108:111], v[108:111], v[52:55]
    v_max_f32 v19, v19, v37
    v_max_f32 v23, v23, v39
    v_cvt_pk_bf16_f32 v34, v18, v19
    v_cvt_pk_bf16_f32 v35, v22, v23
    v_mfma_f32_16x16x32_bf16 v[56:59], v[128:131], v[108:111], v[56:59]
    v_fma_f32 v12, v40, s70, -s70
    v_fma_f32 v16, v42, s70, -s70
    v_fma_f32 v13, v41, s70, -s70
    v_fma_f32 v17, v43, s70, -s70
    v_mfma_f32_16x16x32_bf16 v[60:63], v[132:135], v[108:111], v[60:63]
    v_exp_f32 v12, v12 clamp
    v_exp_f32 v16, v16 clamp
    v_exp_f32 v13, v13 clamp
    v_exp_f32 v17, v17 clamp
    s_waitcnt lgkmcnt(6)
    v_mfma_f32_16x16x32_bf16 v[64:67], a[96:99], v[112:115], v[64:67]
    v_max_f32 v12, v12, v40
    v_max_f32 v16, v16, v42
    v_max_f32 v13, v13, v41
    v_max_f32 v17, v17, v43
    v_mfma_f32_16x16x32_bf16 v[68:71], a[100:103], v[112:115], v[68:71]
    v_cvt_pk_bf16_f32 v40, v12, v13
    v_cvt_pk_bf16_f32 v41, v16, v17
    v_fma_f32 v18, v44, s70, -s70
    v_fma_f32 v22, v46, s70, -s70
    v_mfma_f32_16x16x32_bf16 v[72:75], v[120:123], v[112:115], v[72:75]
    v_fma_f32 v19, v45, s70, -s70
    v_fma_f32 v23, v47, s70, -s70
    v_exp_f32 v18, v18 clamp
    v_exp_f32 v22, v22 clamp
    v_mfma_f32_16x16x32_bf16 v[76:79], v[124:127], v[112:115], v[76:79]
    v_exp_f32 v19, v19 clamp
    v_exp_f32 v23, v23 clamp
    v_max_f32 v18, v18, v44
    v_max_f32 v22, v22, v46
    s_waitcnt lgkmcnt(4)
    v_mfma_f32_16x16x32_bf16 v[64:67], a[104:107], v[116:119], v[64:67]
    v_max_f32 v19, v19, v45
    v_max_f32 v23, v23, v47
    v_cvt_pk_bf16_f32 v42, v18, v19
    v_cvt_pk_bf16_f32 v43, v22, v23
    v_mfma_f32_16x16x32_bf16 v[68:71], a[108:111], v[116:119], v[68:71]
    v_fma_f32 v12, v48, s70, -s70
    v_fma_f32 v16, v50, s70, -s70
    v_fma_f32 v13, v49, s70, -s70
    v_fma_f32 v17, v51, s70, -s70
    v_mfma_f32_16x16x32_bf16 v[72:75], v[128:131], v[116:119], v[72:75]
    v_exp_f32 v12, v12 clamp
    v_exp_f32 v16, v16 clamp
    v_exp_f32 v13, v13 clamp
    v_exp_f32 v17, v17 clamp
    v_mfma_f32_16x16x32_bf16 v[76:79], v[132:135], v[116:119], v[76:79]
    v_max_f32 v12, v12, v48
    v_max_f32 v16, v16, v50
    v_max_f32 v13, v13, v49
    v_max_f32 v17, v17, v51
    s_waitcnt lgkmcnt(2)
    v_mfma_f32_16x16x32_bf16 v[80:83], a[96:99], v[96:99], v[80:83]
    v_cvt_pk_bf16_f32 v48, v12, v13
    v_cvt_pk_bf16_f32 v49, v16, v17
    v_fma_f32 v18, v52, s70, -s70
    v_fma_f32 v22, v54, s70, -s70
    v_mfma_f32_16x16x32_bf16 v[84:87], a[100:103], v[96:99], v[84:87]
    v_fma_f32 v19, v53, s70, -s70
    v_fma_f32 v23, v55, s70, -s70
    v_exp_f32 v18, v18 clamp
    v_exp_f32 v22, v22 clamp
    v_mfma_f32_16x16x32_bf16 v[88:91], v[120:123], v[96:99], v[88:91]
    v_exp_f32 v19, v19 clamp
    v_exp_f32 v23, v23 clamp
    v_max_f32 v18, v18, v52
    v_max_f32 v22, v22, v54
    v_mfma_f32_16x16x32_bf16 v[92:95], v[124:127], v[96:99], v[92:95]
    v_max_f32 v19, v19, v53
    v_max_f32 v23, v23, v55
    v_cvt_pk_bf16_f32 v50, v18, v19
    v_cvt_pk_bf16_f32 v51, v22, v23
    s_waitcnt lgkmcnt(0)
    v_mfma_f32_16x16x32_bf16 v[80:83], a[104:107], v[100:103], v[80:83]
    v_fma_f32 v12, v56, s70, -s70
    v_fma_f32 v16, v58, s70, -s70
    v_fma_f32 v13, v57, s70, -s70
    v_fma_f32 v17, v59, s70, -s70
    v_mfma_f32_16x16x32_bf16 v[84:87], a[108:111], v[100:103], v[84:87]
    v_exp_f32 v12, v12 clamp
    v_exp_f32 v16, v16 clamp
    v_exp_f32 v13, v13 clamp
    v_exp_f32 v17, v17 clamp
    v_mfma_f32_16x16x32_bf16 v[88:91], v[128:131], v[100:103], v[88:91]
    v_max_f32 v12, v12, v56
    v_max_f32 v16, v16, v58
    v_max_f32 v13, v13, v57
    v_max_f32 v17, v17, v59
    v_mfma_f32_16x16x32_bf16 v[92:95], v[132:135], v[100:103], v[92:95]
    v_cvt_pk_bf16_f32 v56, v12, v13
    v_cvt_pk_bf16_f32 v57, v16, v17
    v_fma_f32 v18, v60, s70, -s70
    v_fma_f32 v22, v62, s70, -s70
    v_fma_f32 v19, v61, s70, -s70
    v_fma_f32 v23, v63, s70, -s70
    v_exp_f32 v18, v18 clamp
    v_exp_f32 v22, v22 clamp
    v_exp_f32 v19, v19 clamp
    v_exp_f32 v23, v23 clamp
    v_max_f32 v18, v18, v60
    v_max_f32 v22, v22, v62
    v_max_f32 v19, v19, v61
    v_max_f32 v23, v23, v63
    v_cvt_pk_bf16_f32 v58, v18, v19
    v_cvt_pk_bf16_f32 v59, v22, v23
    v_cvt_pk_bf16_f32 v64, v64, v65
    v_cvt_pk_bf16_f32 v65, v66, v67
    v_cvt_pk_bf16_f32 v66, v68, v69
    v_cvt_pk_bf16_f32 v67, v70, v71
    v_cvt_pk_bf16_f32 v72, v72, v73
    v_cvt_pk_bf16_f32 v73, v74, v75
    v_cvt_pk_bf16_f32 v74, v76, v77
    v_cvt_pk_bf16_f32 v75, v78, v79
    s_nop 1
    v_mfma_f32_16x16x32_bf16 v[120:123], v[64:67], v[32:35], 0
    v_cvt_pk_bf16_f32 v80, v80, v81
    v_cvt_pk_bf16_f32 v81, v82, v83
    v_cndmask_b32 v80, v80, v7, s[64:65]
    v_cndmask_b32 v81, v81, v7, s[64:65]
    v_mfma_f32_16x16x32_bf16 v[124:127], v[64:67], v[48:51], 0
    v_cvt_pk_bf16_f32 v82, v84, v85
    v_cvt_pk_bf16_f32 v83, v86, v87
    v_cndmask_b32 v82, v82, v7, s[64:65]
    v_cndmask_b32 v83, v83, v7, s[64:65]
    v_mfma_f32_16x16x32_bf16 v[120:123], v[72:75], v[40:43], v[120:123]
    v_cvt_pk_bf16_f32 v88, v88, v89
    v_cvt_pk_bf16_f32 v89, v90, v91
    v_cndmask_b32 v88, v88, v7, s[64:65]
    v_cndmask_b32 v89, v89, v7, s[64:65]
    v_mfma_f32_16x16x32_bf16 v[124:127], v[72:75], v[56:59], v[124:127]
    v_cvt_pk_bf16_f32 v90, v92, v93
    v_cvt_pk_bf16_f32 v91, v94, v95
    v_cndmask_b32 v90, v90, v7, s[64:65]
    v_cndmask_b32 v91, v91, v7, s[64:65]
    s_nop 1
    v_mfma_f32_16x16x32_bf16 v[128:131], v[80:83], v[32:35], 0
    v_mfma_f32_16x16x32_bf16 v[132:135], v[80:83], v[48:51], 0
    v_mfma_f32_16x16x32_bf16 v[128:131], v[88:91], v[40:43], v[128:131]
    v_mfma_f32_16x16x32_bf16 v[132:135], v[88:91], v[56:59], v[132:135]
    ds_write_b128 v4, v[120:123] offset:0
    ds_write_b128 v4, v[124:127] offset:1024
    s_nop 4
    ds_write_b128 v4, v[128:131] offset:4096
    ds_write_b128 v4, v[132:135] offset:5120
    s_waitcnt lgkmcnt(0)
    s_barrier
    v_add_u32 v20, 61440, v14
    v_add_u32 v21, 61440, v15
    ds_read_b64_tr_b16 v[96:97], v20 offset:0
    ds_read_b64_tr_b16 v[98:99], v21 offset:0
    ds_read_b64_tr_b16 v[100:101], v20 offset:112
    ds_read_b64_tr_b16 v[102:103], v21 offset:112
    ds_read_b64_tr_b16 v[104:105], v20 offset:7168
    ds_read_b64_tr_b16 v[106:107], v21 offset:7168
    ds_read_b64_tr_b16 v[108:109], v20 offset:7280
    ds_read_b64_tr_b16 v[110:111], v21 offset:7280
    ds_read_b64_tr_b16 v[112:113], v20 offset:14336
    ds_read_b64_tr_b16 v[114:115], v21 offset:14336
    ds_read_b64_tr_b16 v[116:117], v20 offset:14448
    ds_read_b64_tr_b16 v[118:119], v21 offset:14448
    ds_read_b64_tr_b16 v[120:121], v20 offset:21504
    s_waitcnt lgkmcnt(11)
    v_mfma_f32_16x16x32_bf16 v[32:35], v[96:99], a[0:3], 1.0
    ds_read_b64_tr_b16 v[122:123], v21 offset:21504
    v_readfirstlane_b32 s93, v31
    v_mfma_f32_16x16x32_bf16 v[48:51], v[96:99], a[4:7], 1.0
    s_nop 3
    s_add_u32 s93, s93, 16
    ds_read_b64_tr_b16 v[124:125], v20 offset:21616
    s_waitcnt lgkmcnt(11)
    v_mfma_f32_16x16x32_bf16 v[32:35], v[100:103], a[8:11], v[32:35]
    ds_read_b64_tr_b16 v[126:127], v21 offset:21616
    s_and_b32 s61, s93, 0x7ff0
    v_mfma_f32_16x16x32_bf16 v[48:51], v[100:103], a[12:15], v[48:51]
    s_or_b32 s61, s61, s92
    s_or_b32 s61, s61, 0x8000
    ds_read_b64_tr_b16 v[128:129], v20 offset:28672
    s_waitcnt lgkmcnt(11)
    v_mfma_f32_16x16x32_bf16 v[32:35], v[104:107], a[16:19], v[32:35]
    ds_read_b64_tr_b16 v[130:131], v21 offset:28672
    s_lshl_b32 s61, s61, 16
    v_mfma_f32_16x16x32_bf16 v[48:51], v[104:107], a[20:23], v[48:51]
    v_lshlrev_b32 v10, 6, v5
    v_lshl_add_u32 v10, v6, 4, v10
    ds_read_b64_tr_b16 v[132:133], v20 offset:28784
    s_waitcnt lgkmcnt(11)
    v_mfma_f32_16x16x32_bf16 v[32:35], v[108:111], a[24:27], v[32:35]
    ds_read_b64_tr_b16 v[134:135], v21 offset:28784
    v_add_u32 v10, 55808, v10
    v_mfma_f32_16x16x32_bf16 v[48:51], v[108:111], a[28:31], v[48:51]
    v_lshlrev_b32 v12, 12, v1
    v_lshl_add_u32 v12, v2, 4, v12
    ds_read_b64_tr_b16 v[136:137], v20 offset:35840
    s_waitcnt lgkmcnt(11)
    v_mfma_f32_16x16x32_bf16 v[32:35], v[112:115], a[32:35], v[32:35]
    ds_read_b64_tr_b16 v[138:139], v21 offset:35840
    s_lshl_b32 s27, s26, 14
    v_mfma_f32_16x16x32_bf16 v[48:51], v[112:115], a[36:39], v[48:51]
    s_add_u32 s63, s59, s27
    v_mov_b32 v11, 0xffff
    ds_read_b64_tr_b16 v[140:141], v20 offset:35952
    s_waitcnt lgkmcnt(11)
    v_mfma_f32_16x16x32_bf16 v[32:35], v[116:119], a[40:43], v[32:35]
    ds_read_b64_tr_b16 v[142:143], v21 offset:35952
    v_mov_b32 v72, 0
    v_mfma_f32_16x16x32_bf16 v[48:51], v[116:119], a[44:47], v[48:51]
    v_mov_b32 v73, 0
    v_mov_b32 v74, 0
    ds_read_b64_tr_b16 v[96:97], v20 offset:43008
    s_waitcnt lgkmcnt(11)
    v_mfma_f32_16x16x32_bf16 v[32:35], v[120:123], a[48:51], v[32:35]
    ds_read_b64_tr_b16 v[98:99], v21 offset:43008
    v_mov_b32 v75, 0x358637bd
    v_mfma_f32_16x16x32_bf16 v[48:51], v[120:123], a[52:55], v[48:51]
    ds_read_b64_tr_b16 v[100:101], v20 offset:43120
    s_waitcnt lgkmcnt(11)
    v_mfma_f32_16x16x32_bf16 v[32:35], v[124:127], a[56:59], v[32:35]
    ds_read_b64_tr_b16 v[102:103], v21 offset:43120
    v_mfma_f32_16x16x32_bf16 v[48:51], v[124:127], a[60:63], v[48:51]
    ds_read_b64_tr_b16 v[104:105], v20 offset:24
    s_waitcnt lgkmcnt(11)
    v_mfma_f32_16x16x32_bf16 v[32:35], v[128:131], a[64:67], v[32:35]
    ds_read_b64_tr_b16 v[106:107], v21 offset:24
    v_mfma_f32_16x16x32_bf16 v[48:51], v[128:131], a[68:71], v[48:51]
    ds_read_b64_tr_b16 v[108:109], v20 offset:136
    s_waitcnt lgkmcnt(11)
    v_mfma_f32_16x16x32_bf16 v[32:35], v[132:135], a[72:75], v[32:35]
    ds_read_b64_tr_b16 v[110:111], v21 offset:136
    v_mfma_f32_16x16x32_bf16 v[48:51], v[132:135], a[76:79], v[48:51]
    ds_read_b64_tr_b16 v[112:113], v20 offset:7192
    s_waitcnt lgkmcnt(11)
    v_mfma_f32_16x16x32_bf16 v[32:35], v[136:139], a[80:83], v[32:35]
    ds_read_b64_tr_b16 v[114:115], v21 offset:7192
    v_mfma_f32_16x16x32_bf16 v[48:51], v[136:139], a[84:87], v[48:51]
    ds_read_b64_tr_b16 v[116:117], v20 offset:7304
    s_waitcnt lgkmcnt(11)
    v_mfma_f32_16x16x32_bf16 v[32:35], v[140:143], a[88:91], v[32:35]
    ds_read_b64_tr_b16 v[118:119], v21 offset:7304
    v_mfma_f32_16x16x32_bf16 v[48:51], v[140:143], a[92:95], v[48:51]
    ds_read_b64_tr_b16 v[120:121], v20 offset:14360
    s_waitcnt lgkmcnt(11)
    v_mfma_f32_16x16x32_bf16 v[32:35], v[96:99], a[96:99], v[32:35]
    ds_read_b64_tr_b16 v[122:123], v21 offset:14360
    v_mfma_f32_16x16x32_bf16 v[48:51], v[96:99], a[100:103], v[48:51]
    ds_read_b64_tr_b16 v[124:125], v20 offset:14472
    s_waitcnt lgkmcnt(11)
    v_mfma_f32_16x16x32_bf16 v[32:35], v[100:103], a[104:107], v[32:35]
    ds_read_b64_tr_b16 v[126:127], v21 offset:14472
    v_mfma_f32_16x16x32_bf16 v[48:51], v[100:103], a[108:111], v[48:51]
    ds_read_b64_tr_b16 v[128:129], v20 offset:21528
    s_waitcnt lgkmcnt(11)
    v_mfma_f32_16x16x32_bf16 v[36:39], v[104:107], a[0:3], 1.0
    ds_read_b64_tr_b16 v[130:131], v21 offset:21528
    v_mfma_f32_16x16x32_bf16 v[52:55], v[104:107], a[4:7], 1.0
    ds_read_b64_tr_b16 v[132:133], v20 offset:21640
    s_waitcnt lgkmcnt(11)
    v_mfma_f32_16x16x32_bf16 v[36:39], v[108:111], a[8:11], v[36:39]
    ds_read_b64_tr_b16 v[134:135], v21 offset:21640
    v_fma_f32 v64, v32, s70, -s70
    v_mfma_f32_16x16x32_bf16 v[52:55], v[108:111], a[12:15], v[52:55]
    v_fma_f32 v66, v34, s70, -s70
    v_fma_f32 v68, v48, s70, -s70
    ds_read_b64_tr_b16 v[136:137], v20 offset:28696
    s_waitcnt lgkmcnt(11)
    v_mfma_f32_16x16x32_bf16 v[36:39], v[112:115], a[16:19], v[36:39]
    ds_read_b64_tr_b16 v[138:139], v21 offset:28696
    v_fma_f32 v70, v50, s70, -s70
    v_mfma_f32_16x16x32_bf16 v[52:55], v[112:115], a[20:23], v[52:55]
    v_fma_f32 v65, v33, s70, -s70
    v_fma_f32 v67, v35, s70, -s70
    ds_read_b64_tr_b16 v[140:141], v20 offset:28808
    s_waitcnt lgkmcnt(11)
    v_mfma_f32_16x16x32_bf16 v[36:39], v[116:119], a[24:27], v[36:39]
    ds_read_b64_tr_b16 v[142:143], v21 offset:28808
    v_fma_f32 v69, v49, s70, -s70
    v_mfma_f32_16x16x32_bf16 v[52:55], v[116:119], a[28:31], v[52:55]
    v_fma_f32 v71, v51, s70, -s70
    v_exp_f32 v64, v64 clamp
    ds_read_b64_tr_b16 v[96:97], v20 offset:35864
    s_waitcnt lgkmcnt(11)
    v_mfma_f32_16x16x32_bf16 v[36:39], v[120:123], a[32:35], v[36:39]
    ds_read_b64_tr_b16 v[98:99], v21 offset:35864
    v_exp_f32 v66, v66 clamp
    v_mfma_f32_16x16x32_bf16 v[52:55], v[120:123], a[36:39], v[52:55]
    v_exp_f32 v68, v68 clamp
    v_exp_f32 v70, v70 clamp
    ds_read_b64_tr_b16 v[100:101], v20 offset:35976
    s_waitcnt lgkmcnt(11)
    v_mfma_f32_16x16x32_bf16 v[36:39], v[124:127], a[40:43], v[36:39]
    ds_read_b64_tr_b16 v[102:103], v21 offset:35976
    v_exp_f32 v65, v65 clamp
    v_mfma_f32_16x16x32_bf16 v[52:55], v[124:127], a[44:47], v[52:55]
    v_exp_f32 v67, v67 clamp
    v_exp_f32 v69, v69 clamp
    ds_read_b64_tr_b16 v[104:105], v20 offset:43032
    s_waitcnt lgkmcnt(11)
    v_mfma_f32_16x16x32_bf16 v[36:39], v[128:131], a[48:51], v[36:39]
    ds_read_b64_tr_b16 v[106:107], v21 offset:43032
    v_exp_f32 v71, v71 clamp
    v_mfma_f32_16x16x32_bf16 v[52:55], v[128:131], a[52:55], v[52:55]
    v_max_f32 v32, v64, v32
    v_max_f32 v34, v66, v34
    ds_read_b64_tr_b16 v[108:109], v20 offset:43144
    s_waitcnt lgkmcnt(11)
    v_mfma_f32_16x16x32_bf16 v[36:39], v[132:135], a[56:59], v[36:39]
    ds_read_b64_tr_b16 v[110:111], v21 offset:43144
    v_max_f32 v48, v68, v48
    v_mfma_f32_16x16x32_bf16 v[52:55], v[132:135], a[60:63], v[52:55]
    v_max_f32 v50, v70, v50
    v_max_f32 v33, v65, v33
    ds_read_b64_tr_b16 v[112:113], v20 offset:56
    s_waitcnt lgkmcnt(11)
    v_mfma_f32_16x16x32_bf16 v[36:39], v[136:139], a[64:67], v[36:39]
    ds_read_b64_tr_b16 v[114:115], v21 offset:56
    v_max_f32 v35, v67, v35
    v_mfma_f32_16x16x32_bf16 v[52:55], v[136:139], a[68:71], v[52:55]
    v_max_f32 v49, v69, v49
    v_max_f32 v51, v71, v51
    ds_read_b64_tr_b16 v[116:117], v20 offset:168
    s_waitcnt lgkmcnt(11)
    v_mfma_f32_16x16x32_bf16 v[36:39], v[140:143], a[72:75], v[36:39]
    ds_read_b64_tr_b16 v[118:119], v21 offset:168
    v_mfma_f32_16x16x32_bf16 v[52:55], v[140:143], a[76:79], v[52:55]
    ds_read_b64_tr_b16 v[120:121], v20 offset:7224
    s_waitcnt lgkmcnt(11)
    v_mfma_f32_16x16x32_bf16 v[36:39], v[96:99], a[80:83], v[36:39]
    ds_read_b64_tr_b16 v[122:123], v21 offset:7224
    v_mfma_f32_16x16x32_bf16 v[52:55], v[96:99], a[84:87], v[52:55]
    ds_read_b64_tr_b16 v[124:125], v20 offset:7336
    s_waitcnt lgkmcnt(11)
    v_mfma_f32_16x16x32_bf16 v[36:39], v[100:103], a[88:91], v[36:39]
    ds_read_b64_tr_b16 v[126:127], v21 offset:7336
    v_mfma_f32_16x16x32_bf16 v[52:55], v[100:103], a[92:95], v[52:55]
    ds_read_b64_tr_b16 v[128:129], v20 offset:14392
    s_waitcnt lgkmcnt(11)
    v_mfma_f32_16x16x32_bf16 v[36:39], v[104:107], a[96:99], v[36:39]
    ds_read_b64_tr_b16 v[130:131], v21 offset:14392
    v_mfma_f32_16x16x32_bf16 v[52:55], v[104:107], a[100:103], v[52:55]
    ds_read_b64_tr_b16 v[132:133], v20 offset:14504
    s_waitcnt lgkmcnt(11)
    v_mfma_f32_16x16x32_bf16 v[36:39], v[108:111], a[104:107], v[36:39]
    ds_read_b64_tr_b16 v[134:135], v21 offset:14504
    v_mfma_f32_16x16x32_bf16 v[52:55], v[108:111], a[108:111], v[52:55]
    ds_read_b64_tr_b16 v[136:137], v20 offset:21560
    s_waitcnt lgkmcnt(11)
    v_mfma_f32_16x16x32_bf16 v[40:43], v[112:115], a[0:3], 1.0
    ds_read_b64_tr_b16 v[138:139], v21 offset:21560
    v_mfma_f32_16x16x32_bf16 v[56:59], v[112:115], a[4:7], 1.0
    ds_read_b64_tr_b16 v[140:141], v20 offset:21672
    s_waitcnt lgkmcnt(11)
    v_mfma_f32_16x16x32_bf16 v[40:43], v[116:119], a[8:11], v[40:43]
    ds_read_b64_tr_b16 v[142:143], v21 offset:21672
    v_fma_f32 v64, v36, s70, -s70
    v_mfma_f32_16x16x32_bf16 v[56:59], v[116:119], a[12:15], v[56:59]
    v_fma_f32 v66, v38, s70, -s70
    v_fma_f32 v68, v52, s70, -s70
    ds_read_b64_tr_b16 v[96:97], v20 offset:28728
    s_waitcnt lgkmcnt(11)
    v_mfma_f32_16x16x32_bf16 v[40:43], v[120:123], a[16:19], v[40:43]
    ds_read_b64_tr_b16 v[98:99], v21 offset:28728
    v_fma_f32 v70, v54, s70, -s70
    v_mfma_f32_16x16x32_bf16 v[56:59], v[120:123], a[20:23], v[56:59]
    v_fma_f32 v65, v37, s70, -s70
    v_fma_f32 v67, v39, s70, -s70
    ds_read_b64_tr_b16 v[100:101], v20 offset:28840
    s_waitcnt lgkmcnt(11)
    v_mfma_f32_16x16x32_bf16 v[40:43], v[124:127], a[24:27], v[40:43]
    ds_read_b64_tr_b16 v[102:103], v21 offset:28840
    v_fma_f32 v69, v53, s70, -s70
    v_mfma_f32_16x16x32_bf16 v[56:59], v[124:127], a[28:31], v[56:59]
    v_fma_f32 v71, v55, s70, -s70
    v_exp_f32 v64, v64 clamp
    ds_read_b64_tr_b16 v[104:105], v20 offset:35896
    s_waitcnt lgkmcnt(11)
    v_mfma_f32_16x16x32_bf16 v[40:43], v[128:131], a[32:35], v[40:43]
    ds_read_b64_tr_b16 v[106:107], v21 offset:35896
    v_exp_f32 v66, v66 clamp
    v_mfma_f32_16x16x32_bf16 v[56:59], v[128:131], a[36:39], v[56:59]
    v_exp_f32 v68, v68 clamp
    v_exp_f32 v70, v70 clamp
    ds_read_b64_tr_b16 v[108:109], v20 offset:36008
    s_waitcnt lgkmcnt(11)
    v_mfma_f32_16x16x32_bf16 v[40:43], v[132:135], a[40:43], v[40:43]
    ds_read_b64_tr_b16 v[110:111], v21 offset:36008
    v_exp_f32 v65, v65 clamp
    v_mfma_f32_16x16x32_bf16 v[56:59], v[132:135], a[44:47], v[56:59]
    v_exp_f32 v67, v67 clamp
    v_exp_f32 v69, v69 clamp
    ds_read_b64_tr_b16 v[112:113], v20 offset:43064
    s_waitcnt lgkmcnt(11)
    v_mfma_f32_16x16x32_bf16 v[40:43], v[136:139], a[48:51], v[40:43]
    ds_read_b64_tr_b16 v[114:115], v21 offset:43064
    v_exp_f32 v71, v71 clamp
    v_mfma_f32_16x16x32_bf16 v[56:59], v[136:139], a[52:55], v[56:59]
    v_max_f32 v36, v64, v36
    v_max_f32 v38, v66, v38
    ds_read_b64_tr_b16 v[116:117], v20 offset:43176
    s_waitcnt lgkmcnt(11)
    v_mfma_f32_16x16x32_bf16 v[40:43], v[140:143], a[56:59], v[40:43]
    ds_read_b64_tr_b16 v[118:119], v21 offset:43176
    v_max_f32 v52, v68, v52
    v_mfma_f32_16x16x32_bf16 v[56:59], v[140:143], a[60:63], v[56:59]
    v_max_f32 v54, v70, v54
    v_max_f32 v37, v65, v37
    ds_read_b64_tr_b16 v[120:121], v20 offset:80
    s_waitcnt lgkmcnt(11)
    v_mfma_f32_16x16x32_bf16 v[40:43], v[96:99], a[64:67], v[40:43]
    ds_read_b64_tr_b16 v[122:123], v21 offset:80
    v_max_f32 v39, v67, v39
    v_mfma_f32_16x16x32_bf16 v[56:59], v[96:99], a[68:71], v[56:59]
    v_max_f32 v53, v69, v53
    v_max_f32 v55, v71, v55
    ds_read_b64_tr_b16 v[124:125], v20 offset:192
    s_waitcnt lgkmcnt(11)
    v_mfma_f32_16x16x32_bf16 v[40:43], v[100:103], a[72:75], v[40:43]
    ds_read_b64_tr_b16 v[126:127], v21 offset:192
    v_cvt_pk_f16_f32 v32, v32, v36
    v_mfma_f32_16x16x32_bf16 v[56:59], v[100:103], a[76:79], v[56:59]
    v_cvt_pk_f16_f32 v33, v33, v37
    v_cvt_pk_f16_f32 v34, v34, v38
    ds_read_b64_tr_b16 v[128:129], v20 offset:7248
    s_waitcnt lgkmcnt(11)
    v_mfma_f32_16x16x32_bf16 v[40:43], v[104:107], a[80:83], v[40:43]
    ds_read_b64_tr_b16 v[130:131], v21 offset:7248
    v_cvt_pk_f16_f32 v35, v35, v39
    v_mfma_f32_16x16x32_bf16 v[56:59], v[104:107], a[84:87], v[56:59]
    v_cvt_pk_f16_f32 v48, v48, v52
    v_cvt_pk_f16_f32 v49, v49, v53
    ds_read_b64_tr_b16 v[132:133], v20 offset:7360
    s_waitcnt lgkmcnt(11)
    v_mfma_f32_16x16x32_bf16 v[40:43], v[108:111], a[88:91], v[40:43]
    ds_read_b64_tr_b16 v[134:135], v21 offset:7360
    v_cvt_pk_f16_f32 v50, v50, v54
    v_mfma_f32_16x16x32_bf16 v[56:59], v[108:111], a[92:95], v[56:59]
    v_cvt_pk_f16_f32 v51, v51, v55
    ds_read_b64_tr_b16 v[136:137], v20 offset:14416
    s_waitcnt lgkmcnt(11)
    v_mfma_f32_16x16x32_bf16 v[40:43], v[112:115], a[96:99], v[40:43]
    ds_read_b64_tr_b16 v[138:139], v21 offset:14416
    v_mfma_f32_16x16x32_bf16 v[56:59], v[112:115], a[100:103], v[56:59]
    ds_read_b64_tr_b16 v[140:141], v20 offset:14528
    s_waitcnt lgkmcnt(11)
    v_mfma_f32_16x16x32_bf16 v[40:43], v[116:119], a[104:107], v[40:43]
    ds_read_b64_tr_b16 v[142:143], v21 offset:14528
    v_mfma_f32_16x16x32_bf16 v[56:59], v[116:119], a[108:111], v[56:59]
    ds_read_b64_tr_b16 v[96:97], v20 offset:21584
    s_waitcnt lgkmcnt(11)
    v_mfma_f32_16x16x32_bf16 v[44:47], v[120:123], a[0:3], 1.0
    ds_read_b64_tr_b16 v[98:99], v21 offset:21584
    v_mfma_f32_16x16x32_bf16 v[60:63], v[120:123], a[4:7], 1.0
    ds_read_b64_tr_b16 v[100:101], v20 offset:21696
    s_waitcnt lgkmcnt(11)
    v_mfma_f32_16x16x32_bf16 v[44:47], v[124:127], a[8:11], v[44:47]
    ds_read_b64_tr_b16 v[102:103], v21 offset:21696
    v_fma_f32 v64, v40, s70, -s70
    v_mfma_f32_16x16x32_bf16 v[60:63], v[124:127], a[12:15], v[60:63]
    v_fma_f32 v66, v42, s70, -s70
    v_fma_f32 v68, v56, s70, -s70
    ds_read_b64_tr_b16 v[104:105], v20 offset:28752
    s_waitcnt lgkmcnt(11)
    v_mfma_f32_16x16x32_bf16 v[44:47], v[128:131], a[16:19], v[44:47]
    ds_read_b64_tr_b16 v[106:107], v21 offset:28752
    v_fma_f32 v70, v58, s70, -s70
    v_mfma_f32_16x16x32_bf16 v[60:63], v[128:131], a[20:23], v[60:63]
    v_fma_f32 v65, v41, s70, -s70
    v_fma_f32 v67, v43, s70, -s70
    ds_read_b64_tr_b16 v[108:109], v20 offset:28864
    s_waitcnt lgkmcnt(11)
    v_mfma_f32_16x16x32_bf16 v[44:47], v[132:135], a[24:27], v[44:47]
    ds_read_b64_tr_b16 v[110:111], v21 offset:28864
    v_fma_f32 v69, v57, s70, -s70
    v_mfma_f32_16x16x32_bf16 v[60:63], v[132:135], a[28:31], v[60:63]
    v_fma_f32 v71, v59, s70, -s70
    v_exp_f32 v64, v64 clamp
    ds_read_b64_tr_b16 v[112:113], v20 offset:35920
    s_waitcnt lgkmcnt(11)
    v_mfma_f32_16x16x32_bf16 v[44:47], v[136:139], a[32:35], v[44:47]
    ds_read_b64_tr_b16 v[114:115], v21 offset:35920
    v_exp_f32 v66, v66 clamp
    v_mfma_f32_16x16x32_bf16 v[60:63], v[136:139], a[36:39], v[60:63]
    v_exp_f32 v68, v68 clamp
    v_exp_f32 v70, v70 clamp
    ds_read_b64_tr_b16 v[116:117], v20 offset:36032
    s_waitcnt lgkmcnt(11)
    v_mfma_f32_16x16x32_bf16 v[44:47], v[140:143], a[40:43], v[44:47]
    ds_read_b64_tr_b16 v[118:119], v21 offset:36032
    v_exp_f32 v65, v65 clamp
    v_mfma_f32_16x16x32_bf16 v[60:63], v[140:143], a[44:47], v[60:63]
    v_exp_f32 v67, v67 clamp
    v_exp_f32 v69, v69 clamp
    ds_read_b64_tr_b16 v[120:121], v20 offset:43088
    s_waitcnt lgkmcnt(11)
    v_mfma_f32_16x16x32_bf16 v[44:47], v[96:99], a[48:51], v[44:47]
    ds_read_b64_tr_b16 v[122:123], v21 offset:43088
    v_exp_f32 v71, v71 clamp
    v_mfma_f32_16x16x32_bf16 v[60:63], v[96:99], a[52:55], v[60:63]
    v_max_f32 v40, v64, v40
    v_max_f32 v42, v66, v42
    ds_read_b64_tr_b16 v[124:125], v20 offset:43200
    s_waitcnt lgkmcnt(11)
    v_mfma_f32_16x16x32_bf16 v[44:47], v[100:103], a[56:59], v[44:47]
    ds_read_b64_tr_b16 v[126:127], v21 offset:43200
    v_max_f32 v56, v68, v56
    v_mfma_f32_16x16x32_bf16 v[60:63], v[100:103], a[60:63], v[60:63]
    v_max_f32 v58, v70, v58
    v_max_f32 v41, v65, v41
    s_waitcnt lgkmcnt(10)
    v_mfma_f32_16x16x32_bf16 v[44:47], v[104:107], a[64:67], v[44:47]
    v_max_f32 v43, v67, v43
    v_mfma_f32_16x16x32_bf16 v[60:63], v[104:107], a[68:71], v[60:63]
    v_max_f32 v57, v69, v57
    v_max_f32 v59, v71, v59
    s_waitcnt lgkmcnt(8)
    v_mfma_f32_16x16x32_bf16 v[44:47], v[108:111], a[72:75], v[44:47]
    v_mfma_f32_16x16x32_bf16 v[60:63], v[108:111], a[76:79], v[60:63]
    s_waitcnt lgkmcnt(6)
    v_mfma_f32_16x16x32_bf16 v[44:47], v[112:115], a[80:83], v[44:47]
    v_mfma_f32_16x16x32_bf16 v[60:63], v[112:115], a[84:87], v[60:63]
    s_waitcnt lgkmcnt(4)
    v_mfma_f32_16x16x32_bf16 v[44:47], v[116:119], a[88:91], v[44:47]
    v_mfma_f32_16x16x32_bf16 v[60:63], v[116:119], a[92:95], v[60:63]
    s_waitcnt lgkmcnt(2)
    v_mfma_f32_16x16x32_bf16 v[44:47], v[120:123], a[96:99], v[44:47]
    v_mfma_f32_16x16x32_bf16 v[60:63], v[120:123], a[100:103], v[60:63]
    s_waitcnt lgkmcnt(0)
    v_mfma_f32_16x16x32_bf16 v[44:47], v[124:127], a[104:107], v[44:47]
    v_mfma_f32_16x16x32_bf16 v[60:63], v[124:127], a[108:111], v[60:63]
    s_nop 7
    s_nop 1
    v_fma_f32 v64, v44, s70, -s70
    v_fma_f32 v66, v46, s70, -s70
    v_fma_f32 v68, v60, s70, -s70
    v_fma_f32 v70, v62, s70, -s70
    v_fma_f32 v65, v45, s70, -s70
    v_fma_f32 v67, v47, s70, -s70
    v_fma_f32 v69, v61, s70, -s70
    v_fma_f32 v71, v63, s70, -s70
    v_exp_f32 v64, v64 clamp
    v_exp_f32 v66, v66 clamp
    v_exp_f32 v68, v68 clamp
    v_exp_f32 v70, v70 clamp
    v_exp_f32 v65, v65 clamp
    v_exp_f32 v67, v67 clamp
    v_exp_f32 v69, v69 clamp
    v_exp_f32 v71, v71 clamp
    v_max_f32 v44, v64, v44
    v_max_f32 v46, v66, v46
    v_max_f32 v60, v68, v60
    v_max_f32 v62, v70, v62
    v_max_f32 v45, v65, v45
    v_max_f32 v47, v67, v47
    v_max_f32 v61, v69, v61
    v_max_f32 v63, v71, v63
    v_cvt_pk_f16_f32 v40, v40, v44
    v_cvt_pk_f16_f32 v41, v41, v45
    v_cvt_pk_f16_f32 v42, v42, v46
    v_cvt_pk_f16_f32 v43, v43, v47
    v_cvt_pk_f16_f32 v56, v56, v60
    v_cvt_pk_f16_f32 v57, v57, v61
    v_cvt_pk_f16_f32 v58, v58, v62
    v_cvt_pk_f16_f32 v59, v59, v63
    v_mov_b32 v14, v12
    s_barrier
    ds_read_b128 v[84:87], v10 offset:1024
    ds_read_b128 v[80:83], v10 offset:0
    ds_read_b128 v[92:95], v10 offset:3072
    ds_read_b128 v[88:91], v10 offset:2048
    s_waitcnt lgkmcnt(3)
    v_mfma_f32_16x16x32_f16 v[100:103], v[84:87], v[32:35], v[72:75]
    v_mfma_f32_16x16x32_f16 v[108:111], v[84:87], v[48:51], v[72:75]
    s_waitcnt lgkmcnt(2)
    v_mfma_f32_16x16x32_f16 v[96:99], v[80:83], v[32:35], 0
    v_mfma_f32_16x16x32_f16 v[104:107], v[80:83], v[48:51], 0
    s_waitcnt lgkmcnt(1)
    v_mfma_f32_16x16x32_f16 v[116:119], v[92:95], v[40:43], v[72:75]
    v_mfma_f32_16x16x32_f16 v[124:127], v[92:95], v[56:59], v[72:75]
    s_waitcnt lgkmcnt(0)
    v_mfma_f32_16x16x32_f16 v[112:115], v[88:91], v[40:43], 0
    v_mfma_f32_16x16x32_f16 v[120:123], v[88:91], v[56:59], 0
    v_rcp_f32 v128, v103
    v_rcp_f32 v130, v111
    v_pk_mul_f32 v[100:101], v[100:101], v[128:129] op_sel_hi:[1,0]
    v_pk_mul_f32 v[108:109], v[108:109], v[130:131] op_sel_hi:[1,0]
    v_mul_f32 v102, v102, v128
    v_mul_f32 v110, v110, v130
    v_cvt_pk_bf16_f32 v18, v100, v101
    v_cvt_pk_bf16_f32 v22, v108, v109
    v_cvt_pk_bf16_f32 v19, v102, v102
    v_cvt_pk_bf16_f32 v23, v110, v110
    v_and_or_b32 v19, v19, v11, s61
    v_and_or_b32 v23, v23, v11, s61
    v_pk_mul_f32 v[96:97], v[96:97], v[128:129] op_sel_hi:[1,0]
    v_pk_mul_f32 v[104:105], v[104:105], v[130:131] op_sel_hi:[1,0]
    v_pk_mul_f32 v[98:99], v[98:99], v[128:129] op_sel_hi:[1,0]
    v_pk_mul_f32 v[106:107], v[106:107], v[130:131] op_sel_hi:[1,0]
    v_cvt_pk_bf16_f32 v16, v96, v97
    v_cvt_pk_bf16_f32 v20, v104, v105
    v_cvt_pk_bf16_f32 v17, v98, v99
    v_cvt_pk_bf16_f32 v21, v106, v107
    buffer_store_dwordx4 v[16:19], v14, s[40:43], s63 offen offset:0
    buffer_store_dwordx4 v[20:23], v14, s[40:43], s63 offen offset:2048
    v_rcp_f32 v132, v119
    v_rcp_f32 v134, v127
    v_pk_mul_f32 v[116:117], v[116:117], v[132:133] op_sel_hi:[1,0]
    v_pk_mul_f32 v[124:125], v[124:125], v[134:135] op_sel_hi:[1,0]
    v_mul_f32 v118, v118, v132
    v_mul_f32 v126, v126, v134
    v_cvt_pk_bf16_f32 v26, v116, v117
    v_cvt_pk_bf16_f32 v30, v124, v125
    v_cvt_pk_bf16_f32 v27, v118, v118
    v_cvt_pk_bf16_f32 v31, v126, v126
    v_and_or_b32 v27, v27, v11, s61
    v_and_or_b32 v31, v31, v11, s61
    v_pk_mul_f32 v[112:113], v[112:113], v[132:133] op_sel_hi:[1,0]
    v_pk_mul_f32 v[120:121], v[120:121], v[134:135] op_sel_hi:[1,0]
    v_pk_mul_f32 v[114:115], v[114:115], v[132:133] op_sel_hi:[1,0]
    v_pk_mul_f32 v[122:123], v[122:123], v[134:135] op_sel_hi:[1,0]
    v_cvt_pk_bf16_f32 v24, v112, v113
    v_cvt_pk_bf16_f32 v28, v120, v121
    v_cvt_pk_bf16_f32 v25, v114, v115
    v_cvt_pk_bf16_f32 v29, v122, v123
    buffer_store_dwordx4 v[24:27], v14, s[40:43], s63 offen offset:1024
    buffer_store_dwordx4 v[28:31], v14, s[40:43], s63 offen offset:3072
P2_AC:
    v_lshlrev_b32 v6, 4, v2
    v_mov_b32 v3, 161792
SP_104:
    ds_read_b32 v13, v3 offset:4
    s_waitcnt lgkmcnt(0)
    v_readfirstlane_b32 s3, v13
    s_nop 3
    s_cmp_eq_u32 s3, 4
    s_cbranch_scc1 SD_105
    s_sleep 1
    s_branch SP_104
SD_105:
    ds_read_b64_tr_b16 a[0:1], v8 offset:16384
    v_and_b32 v13, 15, v2
    ds_read_b64_tr_b16 a[2:3], v9 offset:16384
    v_lshrrev_b32 v15, 4, v2
    ds_read_b64_tr_b16 a[4:5], v8 offset:16416
    v_mul_u32_u24 v13, 1792, v13
    ds_read_b64_tr_b16 a[6:7], v9 offset:16416
    v_and_b32 v10, 1, v15
    ds_read_b64_tr_b16 a[8:9], v8 offset:16448
    v_lshl_add_u32 v14, v15, 3, v13
    ds_read_b64_tr_b16 a[10:11], v9 offset:16448
    v_lshl_add_u32 v10, v10, 5, v13
    ds_read_b64_tr_b16 a[12:13], v8 offset:16480
    v_lshrrev_b32 v15, 1, v15
    ds_read_b64_tr_b16 a[14:15], v9 offset:16480
    s_and_b32 s3, s48, 3
    ds_read_b64_tr_b16 a[16:17], v8 offset:16512
    v_lshl_add_u32 v10, v15, 4, v10
    ds_read_b64_tr_b16 a[18:19], v9 offset:16512
    s_lshl_b32 s27, s3, 3
    ds_read_b64_tr_b16 a[20:21], v8 offset:16544
    s_mul_i32 s3, s3, 7168
    ds_read_b64_tr_b16 a[22:23], v9 offset:16544
    s_add_u32 s27, s27, 161808
    ds_read_b64_tr_b16 a[24:25], v8 offset:16576
    s_add_u32 s3, s3, 61440
    ds_read_b64_tr_b16 a[26:27], v9 offset:16576
    v_mov_b32 v11, s27
    ds_read_b64_tr_b16 v[76:77], v8 offset:22656
    v_add_u32 v12, s3, v6
    ds_read_b64_tr_b16 v[78:79], v9 offset:22656
    v_mov_b32 v4, 1
    ds_read_b64_tr_b16 v[80:81], v8 offset:22688
    s_mov_b32 s78, 0
    ds_read_b64_tr_b16 v[82:83], v9 offset:22688
    s_mov_b32 s79, 15
    ds_read_b64_tr_b16 v[84:85], v8 offset:22720
    s_mov_b32 s68, 0x10000
    ds_read_b64_tr_b16 v[86:87], v9 offset:22720
    ds_read_b64_tr_b16 a[28:29], v8 offset:30720
    ds_read_b64_tr_b16 a[30:31], v9 offset:30720
    ds_read_b64_tr_b16 a[32:33], v8 offset:30752
    ds_read_b64_tr_b16 a[34:35], v9 offset:30752
    ds_read_b64_tr_b16 a[36:37], v8 offset:30784
    ds_read_b64_tr_b16 a[38:39], v9 offset:30784
    ds_read_b64_tr_b16 a[40:41], v8 offset:30816
    ds_read_b64_tr_b16 a[42:43], v9 offset:30816
    ds_read_b64_tr_b16 a[44:45], v8 offset:30848
    ds_read_b64_tr_b16 a[46:47], v9 offset:30848
    ds_read_b64_tr_b16 a[48:49], v8 offset:30880
    ds_read_b64_tr_b16 a[50:51], v9 offset:30880
    ds_read_b64_tr_b16 a[52:53], v8 offset:30912
    v_mov_b32 v16, 0
    ds_read_b64_tr_b16 a[54:55], v9 offset:30912
    v_mov_b32 v17, 0
    ds_read_b64_tr_b16 a[56:57], v8 offset:43264
    v_mov_b32 v18, 0
    ds_read_b64_tr_b16 a[58:59], v9 offset:43264
    v_mov_b32 v19, 0
    ds_read_b64_tr_b16 a[60:61], v8 offset:43296
    v_mov_b32 v20, 0
    ds_read_b64_tr_b16 a[62:63], v9 offset:43296
    v_mov_b32 v21, 0
    ds_read_b64_tr_b16 a[64:65], v8 offset:43328
    v_mov_b32 v22, 0
    ds_read_b64_tr_b16 a[66:67], v9 offset:43328
    v_mov_b32 v23, 0
    ds_read_b64_tr_b16 a[68:69], v8 offset:43360
    v_mov_b32 v24, 0
    ds_read_b64_tr_b16 a[70:71], v9 offset:43360
    v_mov_b32 v25, 0
    ds_read_b64_tr_b16 a[72:73], v8 offset:43392
    v_mov_b32 v26, 0
    ds_read_b64_tr_b16 a[74:75], v9 offset:43392
    v_mov_b32 v27, 0
    ds_read_b64_tr_b16 a[76:77], v8 offset:43424
    v_mov_b32 v28, 0
    ds_read_b64_tr_b16 a[78:79], v9 offset:43424
    v_mov_b32 v29, 0
    ds_read_b64_tr_b16 a[80:81], v8 offset:43456
    v_mov_b32 v30, 0
    ds_read_b64_tr_b16 a[82:83], v9 offset:43456
    v_mov_b32 v31, 0
    ds_read_b64_tr_b16 a[84:85], v8 offset:0
    v_mov_b32 v32, 0
    ds_read_b64_tr_b16 a[86:87], v9 offset:0
    v_mov_b32 v33, 0
    ds_read_b64_tr_b16 a[88:89], v8 offset:32
    v_mov_b32 v34, 0
    ds_read_b64_tr_b16 a[90:91], v9 offset:32
    v_mov_b32 v35, 0
    ds_read_b64_tr_b16 a[92:93], v8 offset:64
    v_mov_b32 v36, 0
    ds_read_b64_tr_b16 a[94:95], v9 offset:64
    v_mov_b32 v37, 0
    ds_read_b64_tr_b16 a[96:97], v8 offset:96
    v_mov_b32 v38, 0
    ds_read_b64_tr_b16 a[98:99], v9 offset:96
    v_mov_b32 v39, 0
    buffer_load_dwordx4 v[44:47], v6, s[40:43], s80 offen offset:0 nt
    buffer_load_dwordx4 v[48:51], v6, s[40:43], s80 offen offset:1024 nt
    buffer_load_dwordx4 v[52:55], v6, s[40:43], s81 offen offset:0 nt
    buffer_load_dwordx4 v[56:59], v6, s[40:43], s81 offen offset:1024 nt
    buffer_load_dwordx4 v[60:63], v6, s[40:43], s82 offen offset:0 nt
    buffer_load_dwordx4 v[64:67], v6, s[40:43], s82 offen offset:1024 nt
    buffer_load_dwordx4 v[68:71], v6, s[40:43], s83 offen offset:0 nt
    buffer_load_dwordx4 v[72:75], v6, s[40:43], s83 offen offset:1024 nt
    ds_read_b64_tr_b16 a[100:101], v8 offset:128
    v_mov_b32 v40, 0
    ds_read_b64_tr_b16 a[102:103], v9 offset:128
    v_mov_b32 v41, 0
    ds_read_b64_tr_b16 a[104:105], v8 offset:160
    v_mov_b32 v42, 0
    ds_read_b64_tr_b16 a[106:107], v9 offset:160
    v_mov_b32 v43, 0
    ds_read_b64_tr_b16 a[108:109], v8 offset:192
    ds_read_b64_tr_b16 a[110:111], v9 offset:192
    ds_read_b64_tr_b16 v[88:89], v8 offset:36992
    ds_read_b64_tr_b16 v[90:91], v9 offset:36992
    ds_read_b64_tr_b16 v[92:93], v8 offset:37024
    ds_read_b64_tr_b16 v[94:95], v9 offset:37024
    ds_read_b64_tr_b16 v[96:97], v8 offset:37056
    ds_read_b64_tr_b16 v[98:99], v9 offset:37056
    ds_read_b64_tr_b16 v[100:101], v8 offset:49536
    ds_read_b64_tr_b16 v[102:103], v9 offset:49536
    ds_read_b64_tr_b16 v[104:105], v8 offset:49568
    ds_read_b64_tr_b16 v[106:107], v9 offset:49568
    ds_read_b64_tr_b16 v[108:109], v8 offset:49600
    ds_read_b64_tr_b16 v[110:111], v9 offset:49600
    ds_read_b64_tr_b16 v[112:113], v8 offset:8192
    ds_read_b64_tr_b16 v[114:115], v9 offset:8192
    ds_read_b64_tr_b16 v[116:117], v8 offset:8224
    ds_read_b64_tr_b16 v[118:119], v9 offset:8224
    ds_read_b64_tr_b16 v[120:121], v8 offset:8256
    ds_read_b64_tr_b16 v[122:123], v9 offset:8256
CK_81:
    s_waitcnt vmcnt(6)
    v_xor_b32 v47, s61, v47
    v_xor_b32 v51, s61, v51
    v_or_b32 v13, v47, v51
    v_cmp_gt_u32 vcc, s68, v13
    s_cmp_eq_u64 vcc, -1
    s_cselect_b32 s3, s79, 0
    s_bitcmp1_b32 s3, 0
    s_cbranch_scc0 SL_83
    s_waitcnt lgkmcnt(15)
RN_82:
    s_bitset0_b32 s79, 0
    s_cmp_eq_u32 s79, 0
    v_mfma_f32_16x16x32_bf16 v[16:19], a[0:3], v[44:47], v[16:19]
    ds_read_b64_tr_b16 v[124:125], v8 offset:22752
    ds_read_b64_tr_b16 v[126:127], v9 offset:22752
    v_mfma_f32_16x16x32_bf16 v[20:23], a[4:7], v[44:47], v[20:23]
    ds_read_b64_tr_b16 v[128:129], v8 offset:22784
    ds_read_b64_tr_b16 v[130:131], v9 offset:22784
    v_mfma_f32_16x16x32_bf16 v[24:27], a[8:11], v[44:47], v[24:27]
    ds_read_b64_tr_b16 v[132:133], v8 offset:22816
    ds_read_b64_tr_b16 v[134:135], v9 offset:22816
    v_mfma_f32_16x16x32_bf16 v[28:31], a[12:15], v[44:47], v[28:31]
    ds_read_b64_tr_b16 v[136:137], v8 offset:22848
    ds_read_b64_tr_b16 v[138:139], v9 offset:22848
    v_mfma_f32_16x16x32_bf16 v[32:35], a[16:19], v[44:47], v[32:35]
    buffer_load_dword v3, off, s[40:43], s80
    v_mfma_f32_16x16x32_bf16 v[36:39], a[20:23], v[44:47], v[36:39]
    buffer_load_dword v3, off, s[40:43], s80
    v_mfma_f32_16x16x32_bf16 v[40:43], a[24:27], v[44:47], v[40:43]
    s_waitcnt lgkmcnt(8)
    v_mfma_f32_16x16x32_bf16 v[16:19], v[76:79], v[48:51], v[16:19]
    v_mfma_f32_16x16x32_bf16 v[20:23], v[80:83], v[48:51], v[20:23]
    v_mfma_f32_16x16x32_bf16 v[24:27], v[84:87], v[48:51], v[24:27]
    s_cbranch_scc1 LS_85
    s_waitcnt vmcnt(6)
    v_xor_b32 v55, s61, v55
    s_waitcnt lgkmcnt(6)
    v_mfma_f32_16x16x32_bf16 v[28:31], v[124:127], v[48:51], v[28:31]
    v_xor_b32 v59, s61, v59
    v_or_b32 v13, v55, v59
    s_waitcnt lgkmcnt(4)
    v_mfma_f32_16x16x32_bf16 v[32:35], v[128:131], v[48:51], v[32:35]
    v_cmp_gt_u32 vcc, s68, v13
    s_cmp_eq_u64 vcc, -1
    s_waitcnt lgkmcnt(2)
    v_mfma_f32_16x16x32_bf16 v[36:39], v[132:135], v[48:51], v[36:39]
    s_cselect_b32 s3, s79, 0
    s_bitcmp1_b32 s3, 1
    s_waitcnt lgkmcnt(0)
    v_mfma_f32_16x16x32_bf16 v[40:43], v[136:139], v[48:51], v[40:43]
    s_cbranch_scc1 RN_87
    s_branch SL_88
LS_85:
    s_waitcnt lgkmcnt(0)
    s_mov_b64 exec, 1
    ds_add_rtn_u32 v15, v11, v4
    ds_read_b32 v13, v11 offset:4
    s_mov_b64 exec, -1
    v_mfma_f32_16x16x32_bf16 v[28:31], v[124:127], v[48:51], v[28:31]
    ds_read_b128 v[76:79], v12 offset:0
    ds_read_b128 v[80:83], v12 offset:1024
    v_mfma_f32_16x16x32_bf16 v[32:35], v[128:131], v[48:51], v[32:35]
    ds_read_b128 v[84:87], v12 offset:2048
    ds_read_b128 v[88:91], v12 offset:3072
    v_mfma_f32_16x16x32_bf16 v[36:39], v[132:135], v[48:51], v[36:39]
    ds_read_b128 v[92:95], v12 offset:4096
    ds_read_b128 v[96:99], v12 offset:5120
    v_mfma_f32_16x16x32_bf16 v[40:43], v[136:139], v[48:51], v[40:43]
    ds_read_b128 v[100:103], v12 offset:6144
    s_branch PDN_101
SL_83:
    s_bitcmp1_b32 s79, 0
    s_cbranch_scc0 DM_84
    s_sleep 2
    buffer_load_dwordx4 v[44:47], v6, s[40:43], s80 offen offset:0 nt
    buffer_load_dwordx4 v[48:51], v6, s[40:43], s80 offen offset:1024 nt
    s_branch NX_106
DM_84:
    buffer_load_dword v3, off, s[40:43], s80
    buffer_load_dword v3, off, s[40:43], s80
NX_106:
CK_86:
    s_waitcnt vmcnt(6)
    v_xor_b32 v55, s61, v55
    v_xor_b32 v59, s61, v59
    v_or_b32 v13, v55, v59
    v_cmp_gt_u32 vcc, s68, v13
    s_cmp_eq_u64 vcc, -1
    s_cselect_b32 s3, s79, 0
    s_bitcmp1_b32 s3, 1
    s_cbranch_scc0 SL_88
    s_waitcnt lgkmcnt(15)
RN_87:
    s_bitset0_b32 s79, 1
    s_cmp_eq_u32 s79, 0
    v_mfma_f32_16x16x32_bf16 v[16:19], a[28:31], v[52:55], v[16:19]
    ds_read_b64_tr_b16 v[124:125], v8 offset:37088
    ds_read_b64_tr_b16 v[126:127], v9 offset:37088
    v_mfma_f32_16x16x32_bf16 v[20:23], a[32:35], v[52:55], v[20:23]
    ds_read_b64_tr_b16 v[128:129], v8 offset:37120
    ds_read_b64_tr_b16 v[130:131], v9 offset:37120
    v_mfma_f32_16x16x32_bf16 v[24:27], a[36:39], v[52:55], v[24:27]
    ds_read_b64_tr_b16 v[132:133], v8 offset:37152
    ds_read_b64_tr_b16 v[134:135], v9 offset:37152
    v_mfma_f32_16x16x32_bf16 v[28:31], a[40:43], v[52:55], v[28:31]
    ds_read_b64_tr_b16 v[136:137], v8 offset:37184
    ds_read_b64_tr_b16 v[138:139], v9 offset:37184
    v_mfma_f32_16x16x32_bf16 v[32:35], a[44:47], v[52:55], v[32:35]
    buffer_load_dword v3, off, s[40:43], s81
    v_mfma_f32_16x16x32_bf16 v[36:39], a[48:51], v[52:55], v[36:39]
    buffer_load_dword v3, off, s[40:43], s81
    v_mfma_f32_16x16x32_bf16 v[40:43], a[52:55], v[52:55], v[40:43]
    s_waitcnt lgkmcnt(8)
    v_mfma_f32_16x16x32_bf16 v[16:19], v[88:91], v[56:59], v[16:19]
    v_mfma_f32_16x16x32_bf16 v[20:23], v[92:95], v[56:59], v[20:23]
    v_mfma_f32_16x16x32_bf16 v[24:27], v[96:99], v[56:59], v[24:27]
    s_cbranch_scc1 LS_90
    s_waitcnt vmcnt(6)
    v_xor_b32 v63, s61, v63
    s_waitcnt lgkmcnt(6)
    v_mfma_f32_16x16x32_bf16 v[28:31], v[124:127], v[56:59], v[28:31]
    v_xor_b32 v67, s61, v67
    v_or_b32 v13, v63, v67
    s_waitcnt lgkmcnt(4)
    v_mfma_f32_16x16x32_bf16 v[32:35], v[128:131], v[56:59], v[32:35]
    v_cmp_gt_u32 vcc, s68, v13
    s_cmp_eq_u64 vcc, -1
    s_waitcnt lgkmcnt(2)
    v_mfma_f32_16x16x32_bf16 v[36:39], v[132:135], v[56:59], v[36:39]
    s_cselect_b32 s3, s79, 0
    s_bitcmp1_b32 s3, 2
    s_waitcnt lgkmcnt(0)
    v_mfma_f32_16x16x32_bf16 v[40:43], v[136:139], v[56:59], v[40:43]
    s_cbranch_scc1 RN_92
    s_branch SL_93
LS_90:
    s_waitcnt lgkmcnt(0)
    s_mov_b64 exec, 1
    ds_add_rtn_u32 v15, v11, v4
    ds_read_b32 v13, v11 offset:4
    s_mov_b64 exec, -1
    v_mfma_f32_16x16x32_bf16 v[28:31], v[124:127], v[56:59], v[28:31]
    ds_read_b128 v[76:79], v12 offset:0
    ds_read_b128 v[80:83], v12 offset:1024
    v_mfma_f32_16x16x32_bf16 v[32:35], v[128:131], v[56:59], v[32:35]
    ds_read_b128 v[84:87], v12 offset:2048
    ds_read_b128 v[88:91], v12 offset:3072
    v_mfma_f32_16x16x32_bf16 v[36:39], v[132:135], v[56:59], v[36:39]
    ds_read_b128 v[92:95], v12 offset:4096
    ds_read_b128 v[96:99], v12 offset:5120
    v_mfma_f32_16x16x32_bf16 v[40:43], v[136:139], v[56:59], v[40:43]
    ds_read_b128 v[100:103], v12 offset:6144
    s_branch PDN_101
SL_88:
    s_bitcmp1_b32 s79, 1
    s_cbranch_scc0 DM_89
    s_sleep 2
    buffer_load_dwordx4 v[52:55], v6, s[40:43], s81 offen offset:0 nt
    buffer_load_dwordx4 v[56:59], v6, s[40:43], s81 offen offset:1024 nt
    s_branch NX_107
DM_89:
    buffer_load_dword v3, off, s[40:43], s81
    buffer_load_dword v3, off, s[40:43], s81
NX_107:
CK_91:
    s_waitcnt vmcnt(6)
    v_xor_b32 v63, s61, v63
    v_xor_b32 v67, s61, v67
    v_or_b32 v13, v63, v67
    v_cmp_gt_u32 vcc, s68, v13
    s_cmp_eq_u64 vcc, -1
    s_cselect_b32 s3, s79, 0
    s_bitcmp1_b32 s3, 2
    s_cbranch_scc0 SL_93
    s_waitcnt lgkmcnt(15)
RN_92:
    s_bitset0_b32 s79, 2
    s_cmp_eq_u32 s79, 0
    v_mfma_f32_16x16x32_bf16 v[16:19], a[56:59], v[60:63], v[16:19]
    ds_read_b64_tr_b16 v[124:125], v8 offset:49632
    ds_read_b64_tr_b16 v[126:127], v9 offset:49632
    v_mfma_f32_16x16x32_bf16 v[20:23], a[60:63], v[60:63], v[20:23]
    ds_read_b64_tr_b16 v[128:129], v8 offset:49664
    ds_read_b64_tr_b16 v[130:131], v9 offset:49664
    v_mfma_f32_16x16x32_bf16 v[24:27], a[64:67], v[60:63], v[24:27]
    ds_read_b64_tr_b16 v[132:133], v8 offset:49696
    ds_read_b64_tr_b16 v[134:135], v9 offset:49696
    v_mfma_f32_16x16x32_bf16 v[28:31], a[68:71], v[60:63], v[28:31]
    ds_read_b64_tr_b16 v[136:137], v8 offset:49728
    ds_read_b64_tr_b16 v[138:139], v9 offset:49728
    v_mfma_f32_16x16x32_bf16 v[32:35], a[72:75], v[60:63], v[32:35]
    buffer_load_dword v3, off, s[40:43], s82
    v_mfma_f32_16x16x32_bf16 v[36:39], a[76:79], v[60:63], v[36:39]
    buffer_load_dword v3, off, s[40:43], s82
    v_mfma_f32_16x16x32_bf16 v[40:43], a[80:83], v[60:63], v[40:43]
    s_waitcnt lgkmcnt(8)
    v_mfma_f32_16x16x32_bf16 v[16:19], v[100:103], v[64:67], v[16:19]
    v_mfma_f32_16x16x32_bf16 v[20:23], v[104:107], v[64:67], v[20:23]
    v_mfma_f32_16x16x32_bf16 v[24:27], v[108:111], v[64:67], v[24:27]
    s_cbranch_scc1 LS_95
    s_waitcnt vmcnt(6)
    v_xor_b32 v71, s61, v71
    s_waitcnt lgkmcnt(6)
    v_mfma_f32_16x16x32_bf16 v[28:31], v[124:127], v[64:67], v[28:31]
    v_xor_b32 v75, s61, v75
    v_or_b32 v13, v71, v75
    s_waitcnt lgkmcnt(4)
    v_mfma_f32_16x16x32_bf16 v[32:35], v[128:131], v[64:67], v[32:35]
    v_cmp_gt_u32 vcc, s68, v13
    s_cmp_eq_u64 vcc, -1
    s_waitcnt lgkmcnt(2)
    v_mfma_f32_16x16x32_bf16 v[36:39], v[132:135], v[64:67], v[36:39]
    s_cselect_b32 s3, s79, 0
    s_bitcmp1_b32 s3, 3
    s_waitcnt lgkmcnt(0)
    v_mfma_f32_16x16x32_bf16 v[40:43], v[136:139], v[64:67], v[40:43]
    s_cbranch_scc1 RN_97
    s_branch SL_98
LS_95:
    s_waitcnt lgkmcnt(0)
    s_mov_b64 exec, 1
    ds_add_rtn_u32 v15, v11, v4
    ds_read_b32 v13, v11 offset:4
    s_mov_b64 exec, -1
    v_mfma_f32_16x16x32_bf16 v[28:31], v[124:127], v[64:67], v[28:31]
    ds_read_b128 v[76:79], v12 offset:0
    ds_read_b128 v[80:83], v12 offset:1024
    v_mfma_f32_16x16x32_bf16 v[32:35], v[128:131], v[64:67], v[32:35]
    ds_read_b128 v[84:87], v12 offset:2048
    ds_read_b128 v[88:91], v12 offset:3072
    v_mfma_f32_16x16x32_bf16 v[36:39], v[132:135], v[64:67], v[36:39]
    ds_read_b128 v[92:95], v12 offset:4096
    ds_read_b128 v[96:99], v12 offset:5120
    v_mfma_f32_16x16x32_bf16 v[40:43], v[136:139], v[64:67], v[40:43]
    ds_read_b128 v[100:103], v12 offset:6144
    s_branch PDN_101
SL_93:
    s_bitcmp1_b32 s79, 2
    s_cbranch_scc0 DM_94
    s_sleep 2
    buffer_load_dwordx4 v[60:63], v6, s[40:43], s82 offen offset:0 nt
    buffer_load_dwordx4 v[64:67], v6, s[40:43], s82 offen offset:1024 nt
    s_branch NX_108
DM_94:
    buffer_load_dword v3, off, s[40:43], s82
    buffer_load_dword v3, off, s[40:43], s82
NX_108:
CK_96:
    s_waitcnt vmcnt(6)
    v_xor_b32 v71, s61, v71
    v_xor_b32 v75, s61, v75
    v_or_b32 v13, v71, v75
    v_cmp_gt_u32 vcc, s68, v13
    s_cmp_eq_u64 vcc, -1
    s_cselect_b32 s3, s79, 0
    s_bitcmp1_b32 s3, 3
    s_cbranch_scc0 SL_98
    s_waitcnt lgkmcnt(15)
RN_97:
    s_bitset0_b32 s79, 3
    s_cmp_eq_u32 s79, 0
    v_mfma_f32_16x16x32_bf16 v[16:19], a[84:87], v[68:71], v[16:19]
    ds_read_b64_tr_b16 v[124:125], v8 offset:8288
    ds_read_b64_tr_b16 v[126:127], v9 offset:8288
    v_mfma_f32_16x16x32_bf16 v[20:23], a[88:91], v[68:71], v[20:23]
    ds_read_b64_tr_b16 v[128:129], v8 offset:8320
    ds_read_b64_tr_b16 v[130:131], v9 offset:8320
    v_mfma_f32_16x16x32_bf16 v[24:27], a[92:95], v[68:71], v[24:27]
    ds_read_b64_tr_b16 v[132:133], v8 offset:8352
    ds_read_b64_tr_b16 v[134:135], v9 offset:8352
    v_mfma_f32_16x16x32_bf16 v[28:31], a[96:99], v[68:71], v[28:31]
    ds_read_b64_tr_b16 v[136:137], v8 offset:8384
    ds_read_b64_tr_b16 v[138:139], v9 offset:8384
    v_mfma_f32_16x16x32_bf16 v[32:35], a[100:103], v[68:71], v[32:35]
    buffer_load_dword v3, off, s[40:43], s83
    v_mfma_f32_16x16x32_bf16 v[36:39], a[104:107], v[68:71], v[36:39]
    buffer_load_dword v3, off, s[40:43], s83
    v_mfma_f32_16x16x32_bf16 v[40:43], a[108:111], v[68:71], v[40:43]
    s_waitcnt lgkmcnt(8)
    v_mfma_f32_16x16x32_bf16 v[16:19], v[112:115], v[72:75], v[16:19]
    v_mfma_f32_16x16x32_bf16 v[20:23], v[116:119], v[72:75], v[20:23]
    v_mfma_f32_16x16x32_bf16 v[24:27], v[120:123], v[72:75], v[24:27]
    s_cbranch_scc1 LS_100
    s_waitcnt vmcnt(6)
    v_xor_b32 v47, s61, v47
    s_waitcnt lgkmcnt(6)
    v_mfma_f32_16x16x32_bf16 v[28:31], v[124:127], v[72:75], v[28:31]
    v_xor_b32 v51, s61, v51
    v_or_b32 v13, v47, v51
    s_waitcnt lgkmcnt(4)
    v_mfma_f32_16x16x32_bf16 v[32:35], v[128:131], v[72:75], v[32:35]
    v_cmp_gt_u32 vcc, s68, v13
    s_cmp_eq_u64 vcc, -1
    s_waitcnt lgkmcnt(2)
    v_mfma_f32_16x16x32_bf16 v[36:39], v[132:135], v[72:75], v[36:39]
    s_cselect_b32 s3, s79, 0
    s_bitcmp1_b32 s3, 0
    s_waitcnt lgkmcnt(0)
    v_mfma_f32_16x16x32_bf16 v[40:43], v[136:139], v[72:75], v[40:43]
    s_cbranch_scc1 RN_82
    s_branch SL_83
LS_100:
    s_waitcnt lgkmcnt(0)
    s_mov_b64 exec, 1
    ds_add_rtn_u32 v15, v11, v4
    ds_read_b32 v13, v11 offset:4
    s_mov_b64 exec, -1
    v_mfma_f32_16x16x32_bf16 v[28:31], v[124:127], v[72:75], v[28:31]
    ds_read_b128 v[76:79], v12 offset:0
    ds_read_b128 v[80:83], v12 offset:1024
    v_mfma_f32_16x16x32_bf16 v[32:35], v[128:131], v[72:75], v[32:35]
    ds_read_b128 v[84:87], v12 offset:2048
    ds_read_b128 v[88:91], v12 offset:3072
    v_mfma_f32_16x16x32_bf16 v[36:39], v[132:135], v[72:75], v[36:39]
    ds_read_b128 v[92:95], v12 offset:4096
    ds_read_b128 v[96:99], v12 offset:5120
    v_mfma_f32_16x16x32_bf16 v[40:43], v[136:139], v[72:75], v[40:43]
    ds_read_b128 v[100:103], v12 offset:6144
    s_branch PDN_101
SL_98:
    s_bitcmp1_b32 s79, 3
    s_cbranch_scc0 DM_99
    s_sleep 2
    buffer_load_dwordx4 v[68:71], v6, s[40:43], s83 offen offset:0 nt
    buffer_load_dwordx4 v[72:75], v6, s[40:43], s83 offen offset:1024 nt
    s_branch NX_109
DM_99:
    buffer_load_dword v3, off, s[40:43], s83
    buffer_load_dword v3, off, s[40:43], s83
NX_109:
    s_add_u32 s78, s78, 1
    s_cmp_lt_u32 s78, 64
    s_cbranch_scc1 CK_81
    s_branch PFB_102
PDN_101:
    s_waitcnt lgkmcnt(7)
    v_readfirstlane_b32 s3, v13
    v_readfirstlane_b32 s27, v15
    s_nop 2
    s_cmp_eq_u32 s3, 1
    s_cbranch_scc1 FIN_110
    s_cmp_eq_u32 s27, 0
    s_cbranch_scc0 SEC_111
    s_nop 3
    ds_write_b128 v12, v[16:19] offset:0
    ds_write_b128 v12, v[20:23] offset:1024
    ds_write_b128 v12, v[24:27] offset:2048
    ds_write_b128 v12, v[28:31] offset:3072
    ds_write_b128 v12, v[32:35] offset:4096
    ds_write_b128 v12, v[36:39] offset:5120
    ds_write_b128 v12, v[40:43] offset:6144
    s_mov_b64 exec, 1
    s_waitcnt lgkmcnt(0)
    ds_write_b32 v11, v4 offset:4
    s_waitcnt lgkmcnt(0)
    s_mov_b64 exec, -1
    s_endpgm
SEC_111:
    s_mov_b32 s69, 0
SPN_112:
    ds_read_b32 v13, v11 offset:4
    ds_read_b128 v[76:79], v12 offset:0
    ds_read_b128 v[80:83], v12 offset:1024
    ds_read_b128 v[84:87], v12 offset:2048
    ds_read_b128 v[88:91], v12 offset:3072
    ds_read_b128 v[92:95], v12 offset:4096
    ds_read_b128 v[96:99], v12 offset:5120
    ds_read_b128 v[100:103], v12 offset:6144
    s_add_u32 s69, s69, 1
    s_cmp_gt_u32 s69, 0x400000
    s_cbranch_scc1 K_END
    s_waitcnt lgkmcnt(7)
    v_readfirstlane_b32 s3, v13
    s_nop 3
    s_cmp_eq_u32 s3, 1
    s_cbranch_scc0 SPN_112
FIN_110:
    s_and_b32 s3, s48, 3
    s_or_b32 s3, s26, s3
    s_cbranch_scc1 NS_114
    v_mov_b32 v13, s93
    buffer_store_dword v13, off, s[40:43], s60 sc0 sc1
NS_114:
    s_waitcnt lgkmcnt(6)
    v_pk_add_f32 v[16:17], v[16:17], v[76:77]
    v_pk_add_f32 v[18:19], v[18:19], v[78:79]
    v_cvt_pk_bf16_f32 v104, v16, v17
    v_cvt_pk_bf16_f32 v105, v18, v19
    s_waitcnt lgkmcnt(5)
    v_pk_add_f32 v[20:21], v[20:21], v[80:81]
    v_pk_add_f32 v[22:23], v[22:23], v[82:83]
    v_cvt_pk_bf16_f32 v106, v20, v21
    v_cvt_pk_bf16_f32 v107, v22, v23
    s_waitcnt lgkmcnt(4)
    v_pk_add_f32 v[24:25], v[24:25], v[84:85]
    v_pk_add_f32 v[26:27], v[26:27], v[86:87]
    v_cvt_pk_bf16_f32 v108, v24, v25
    v_cvt_pk_bf16_f32 v109, v26, v27
    v_permlane16_swap_b32 v104, v106
    v_permlane16_swap_b32 v105, v107
    s_waitcnt lgkmcnt(3)
    v_pk_add_f32 v[28:29], v[28:29], v[88:89]
    v_pk_add_f32 v[30:31], v[30:31], v[90:91]
    v_cvt_pk_bf16_f32 v110, v28, v29
    v_cvt_pk_bf16_f32 v111, v30, v31
    buffer_store_dwordx4 v[104:107], v10, s[88:91], s87 offen offset:0 nt
    s_waitcnt lgkmcnt(2)
    v_pk_add_f32 v[32:33], v[32:33], v[92:93]
    v_pk_add_f32 v[34:35], v[34:35], v[94:95]
    v_cvt_pk_bf16_f32 v112, v32, v33
    v_cvt_pk_bf16_f32 v113, v34, v35
    v_permlane16_swap_b32 v108, v110
    v_permlane16_swap_b32 v109, v111
    s_waitcnt lgkmcnt(1)
    v_pk_add_f32 v[36:37], v[36:37], v[96:97]
    v_pk_add_f32 v[38:39], v[38:39], v[98:99]
    v_cvt_pk_bf16_f32 v114, v36, v37
    v_cvt_pk_bf16_f32 v115, v38, v39
    buffer_store_dwordx4 v[108:111], v10, s[88:91], s87 offen offset:64 nt
    s_waitcnt lgkmcnt(0)
    v_pk_add_f32 v[40:41], v[40:41], v[100:101]
    v_pk_add_f32 v[42:43], v[42:43], v[102:103]
    v_cvt_pk_bf16_f32 v116, v40, v41
    v_cvt_pk_bf16_f32 v117, v42, v43
    v_permlane16_swap_b32 v112, v114
    v_permlane16_swap_b32 v113, v115
    buffer_store_dwordx2 v[116:117], v14, s[88:91], s87 offen offset:192 nt
    s_nop 0
    buffer_store_dwordx4 v[112:115], v10, s[88:91], s87 offen offset:128 nt
ENDC_113:
    s_endpgm
PFB_102:
    s_waitcnt vmcnt(0)
    s_lshl_b32 s57, s24, 4
    s_add_u32 s57, s57, s25
    s_lshl_b32 s57, s57, 7
    s_add_u32 s57, s57, 0x810000
    s_cmp_eq_u32 s78, 64
    s_cbranch_scc0 NC_115
    s_lshl_b32 s3, s26, 14
    s_add_u32 s62, s59, s3
    s_mov_b32 s69, 0
CP_116:
RL_117:
    v_mov_b32 v13, 0
    s_add_u32 s3, s62, 0
    buffer_load_dwordx4 v[44:47], v6, s[40:43], s3 offen sc0 sc1
    s_add_u32 s3, s62, 1024
    buffer_load_dwordx4 v[48:51], v6, s[40:43], s3 offen sc0 sc1
    s_add_u32 s3, s62, 2048
    buffer_load_dwordx4 v[52:55], v6, s[40:43], s3 offen sc0 sc1
    s_add_u32 s3, s62, 3072
    buffer_load_dwordx4 v[56:59], v6, s[40:43], s3 offen sc0 sc1
    s_add_u32 s3, s62, 4096
    buffer_load_dwordx4 v[60:63], v6, s[40:43], s3 offen sc0 sc1
    s_add_u32 s3, s62, 5120
    buffer_load_dwordx4 v[64:67], v6, s[40:43], s3 offen sc0 sc1
    s_add_u32 s3, s62, 6144
    buffer_load_dwordx4 v[68:71], v6, s[40:43], s3 offen sc0 sc1
    s_add_u32 s3, s62, 7168
    buffer_load_dwordx4 v[72:75], v6, s[40:43], s3 offen sc0 sc1
    s_waitcnt vmcnt(0)
    v_xor_b32 v15, s61, v47
    v_or_b32 v13, v13, v15
    v_xor_b32 v15, s61, v51
    v_or_b32 v13, v13, v15
    v_xor_b32 v15, s61, v55
    v_or_b32 v13, v13, v15
    v_xor_b32 v15, s61, v59
    v_or_b32 v13, v13, v15
    v_xor_b32 v15, s61, v63
    v_or_b32 v13, v13, v15
    v_xor_b32 v15, s61, v67
    v_or_b32 v13, v13, v15
    v_xor_b32 v15, s61, v71
    v_or_b32 v13, v13, v15
    v_xor_b32 v15, s61, v75
    v_or_b32 v13, v13, v15
    v_cmp_gt_u32 vcc, 0x10000, v13
    s_add_u32 s69, s69, 1
    s_cmp_gt_u32 s69, 0x40000
    s_cbranch_scc1 K_END
    s_cmp_eq_u64 vcc, -1
    s_cbranch_scc0 RL_117
    s_add_u32 s3, s62, 0x400000
    buffer_store_dwordx4 v[44:47], v6, s[40:43], s3 offen sc0 sc1
    s_add_u32 s3, s62, 0x400400
    buffer_store_dwordx4 v[48:51], v6, s[40:43], s3 offen sc0 sc1
    s_add_u32 s3, s62, 0x400800
    buffer_store_dwordx4 v[52:55], v6, s[40:43], s3 offen sc0 sc1
    s_add_u32 s3, s62, 0x400c00
    buffer_store_dwordx4 v[56:59], v6, s[40:43], s3 offen sc0 sc1
    s_add_u32 s3, s62, 0x401000
    buffer_store_dwordx4 v[60:63], v6, s[40:43], s3 offen sc0 sc1
    s_add_u32 s3, s62, 0x401400
    buffer_store_dwordx4 v[64:67], v6, s[40:43], s3 offen sc0 sc1
    s_add_u32 s3, s62, 0x401800
    buffer_store_dwordx4 v[68:71], v6, s[40:43], s3 offen sc0 sc1
    s_add_u32 s3, s62, 0x401c00
    buffer_store_dwordx4 v[72:75], v6, s[40:43], s3 offen sc0 sc1
    s_waitcnt vmcnt(0)
RL_118:
    v_mov_b32 v13, 0
    s_add_u32 s3, s62, 8192
    buffer_load_dwordx4 v[44:47], v6, s[40:43], s3 offen sc0 sc1
    s_add_u32 s3, s62, 9216
    buffer_load_dwordx4 v[48:51], v6, s[40:43], s3 offen sc0 sc1
    s_add_u32 s3, s62, 10240
    buffer_load_dwordx4 v[52:55], v6, s[40:43], s3 offen sc0 sc1
    s_add_u32 s3, s62, 11264
    buffer_load_dwordx4 v[56:59], v6, s[40:43], s3 offen sc0 sc1
    s_add_u32 s3, s62, 12288
    buffer_load_dwordx4 v[60:63], v6, s[40:43], s3 offen sc0 sc1
    s_add_u32 s3, s62, 13312
    buffer_load_dwordx4 v[64:67], v6, s[40:43], s3 offen sc0 sc1
    s_add_u32 s3, s62, 14336
    buffer_load_dwordx4 v[68:71], v6, s[40:43], s3 offen sc0 sc1
    s_add_u32 s3, s62, 15360
    buffer_load_dwordx4 v[72:75], v6, s[40:43], s3 offen sc0 sc1
    s_waitcnt vmcnt(0)
    v_xor_b32 v15, s61, v47
    v_or_b32 v13, v13, v15
    v_xor_b32 v15, s61, v51
    v_or_b32 v13, v13, v15
    v_xor_b32 v15, s61, v55
    v_or_b32 v13, v13, v15
    v_xor_b32 v15, s61, v59
    v_or_b32 v13, v13, v15
    v_xor_b32 v15, s61, v63
    v_or_b32 v13, v13, v15
    v_xor_b32 v15, s61, v67
    v_or_b32 v13, v13, v15
    v_xor_b32 v15, s61, v71
    v_or_b32 v13, v13, v15
    v_xor_b32 v15, s61, v75
    v_or_b32 v13, v13, v15
    v_cmp_gt_u32 vcc, 0x10000, v13
    s_add_u32 s69, s69, 1
    s_cmp_gt_u32 s69, 0x40000
    s_cbranch_scc1 K_END
    s_cmp_eq_u64 vcc, -1
    s_cbranch_scc0 RL_118
    s_add_u32 s3, s62, 0x402000
    buffer_store_dwordx4 v[44:47], v6, s[40:43], s3 offen sc0 sc1
    s_add_u32 s3, s62, 0x402400
    buffer_store_dwordx4 v[48:51], v6, s[40:43], s3 offen sc0 sc1
    s_add_u32 s3, s62, 0x402800
    buffer_store_dwordx4 v[52:55], v6, s[40:43], s3 offen sc0 sc1
    s_add_u32 s3, s62, 0x402c00
    buffer_store_dwordx4 v[56:59], v6, s[40:43], s3 offen sc0 sc1
    s_add_u32 s3, s62, 0x403000
    buffer_store_dwordx4 v[60:63], v6, s[40:43], s3 offen sc0 sc1
    s_add_u32 s3, s62, 0x403400
    buffer_store_dwordx4 v[64:67], v6, s[40:43], s3 offen sc0 sc1
    s_add_u32 s3, s62, 0x403800
    buffer_store_dwordx4 v[68:71], v6, s[40:43], s3 offen sc0 sc1
    s_add_u32 s3, s62, 0x403c00
    buffer_store_dwordx4 v[72:75], v6, s[40:43], s3 offen sc0 sc1
    s_waitcnt vmcnt(0)
    s_lshl_b32 s3, s26, 2
    s_add_u32 s3, s3, s57
    v_mov_b32 v15, s93
    buffer_store_dword v15, off, s[40:43], s3 sc0 sc1
    s_mov_b32 s68, 0x100000
NC_115:
    v_and_b32 v15, 3, v2
    v_lshlrev_b32 v15, 2, v15
    buffer_load_dword v13, v15, s[40:43], s57 offen offset:0 sc0 sc1
    s_waitcnt vmcnt(0)
    v_cmp_eq_u32 vcc, s93, v13
    s_or_b32 s3, s80, 0x400000
    s_bitcmp1_b32 vcc_lo, 0
    s_cselect_b32 s80, s3, s80
    s_or_b32 s3, s81, 0x400000
    s_bitcmp1_b32 vcc_lo, 1
    s_cselect_b32 s81, s3, s81
    s_or_b32 s3, s82, 0x400000
    s_bitcmp1_b32 vcc_lo, 2
    s_cselect_b32 s82, s3, s82
    s_or_b32 s3, s83, 0x400000
    s_bitcmp1_b32 vcc_lo, 3
    s_cselect_b32 s83, s3, s83
    buffer_load_dwordx4 v[44:47], v6, s[40:43], s80 offen offset:0 sc0 sc1
    buffer_load_dwordx4 v[48:51], v6, s[40:43], s80 offen offset:1024 sc0 sc1
    buffer_load_dwordx4 v[52:55], v6, s[40:43], s81 offen offset:0 sc0 sc1
    buffer_load_dwordx4 v[56:59], v6, s[40:43], s81 offen offset:1024 sc0 sc1
    buffer_load_dwordx4 v[60:63], v6, s[40:43], s82 offen offset:0 sc0 sc1
    buffer_load_dwordx4 v[64:67], v6, s[40:43], s82 offen offset:1024 sc0 sc1
    buffer_load_dwordx4 v[68:71], v6, s[40:43], s83 offen offset:0 sc0 sc1
    buffer_load_dwordx4 v[72:75], v6, s[40:43], s83 offen offset:1024 sc0 sc1
    s_cmp_lt_u32 s78, 0x40000
    s_cbranch_scc1 CK_81
    s_endpgm
P2_AL:
    s_waitcnt vmcnt(0)
    s_mov_b64 exec, 1
    ds_add_u32 v3, v4 offset:4
    s_mov_b64 exec, -1
    s_sleep 2
    ds_read_b64_tr_b16 a[84:85], v8 offset:37632
    ds_read_b64_tr_b16 a[86:87], v9 offset:37632
    ds_read_b64_tr_b16 a[88:89], v8 offset:37664
    ds_read_b64_tr_b16 a[90:91], v9 offset:37664
    ds_read_b64_tr_b16 a[92:93], v8 offset:37696
    ds_read_b64_tr_b16 a[94:95], v9 offset:37696
    ds_read_b64_tr_b16 a[96:97], v8 offset:37728
    ds_read_b64_tr_b16 a[98:99], v9 offset:37728
    ds_read_b64_tr_b16 a[100:101], v8 offset:37760
    ds_read_b64_tr_b16 a[102:103], v9 offset:37760
    ds_read_b64_tr_b16 a[104:105], v8 offset:37792
    ds_read_b64_tr_b16 a[106:107], v9 offset:37792
    ds_read_b64_tr_b16 a[108:109], v8 offset:37824
    ds_read_b64_tr_b16 a[110:111], v9 offset:37824
    ds_read_b64_tr_b16 v[112:113], v8 offset:43904
    ds_read_b64_tr_b16 v[114:115], v9 offset:43904
    ds_read_b64_tr_b16 v[116:117], v8 offset:43936
    ds_read_b64_tr_b16 v[118:119], v9 offset:43936
    ds_read_b64_tr_b16 v[120:121], v8 offset:43968
    ds_read_b64_tr_b16 v[122:123], v9 offset:43968
    ds_read_b64_tr_b16 v[124:125], v8 offset:44000
    ds_read_b64_tr_b16 v[126:127], v9 offset:44000
    ds_read_b64_tr_b16 v[128:129], v8 offset:44032
    ds_read_b64_tr_b16 v[130:131], v9 offset:44032
    ds_read_b64_tr_b16 v[132:133], v8 offset:44064
    ds_read_b64_tr_b16 v[134:135], v9 offset:44064
    ds_read_b64_tr_b16 v[136:137], v8 offset:44096
    ds_read_b64_tr_b16 v[138:139], v9 offset:44096
    buffer_load_dwordx4 v[68:71], v6, s[40:43], s83 offen offset:0 nt
    buffer_load_dwordx4 v[72:75], v6, s[40:43], s83 offen offset:1024 nt
    ds_read_b64_tr_b16 a[56:57], v8 offset:25088
    ds_read_b64_tr_b16 a[58:59], v9 offset:25088
    ds_read_b64_tr_b16 a[60:61], v8 offset:25120
    ds_read_b64_tr_b16 a[62:63], v9 offset:25120
    ds_read_b64_tr_b16 a[64:65], v8 offset:25152
    ds_read_b64_tr_b16 a[66:67], v9 offset:25152
    ds_read_b64_tr_b16 a[68:69], v8 offset:25184
    ds_read_b64_tr_b16 a[70:71], v9 offset:25184
    ds_read_b64_tr_b16 a[72:73], v8 offset:25216
    ds_read_b64_tr_b16 a[74:75], v9 offset:25216
    ds_read_b64_tr_b16 a[76:77], v8 offset:25248
    ds_read_b64_tr_b16 a[78:79], v9 offset:25248
    s_waitcnt vmcnt(0)
    v_xor_b32 v71, s61, v71
    v_xor_b32 v75, s61, v75
    v_or_b32 v13, v71, v75
    v_cmp_gt_u32 vcc, s68, v13
    s_cmp_eq_u64 vcc, -1
    s_cbranch_scc0 F0_141
    s_bitset0_b32 s79, 3
    s_waitcnt lgkmcnt(12)
    v_mfma_f32_16x16x32_bf16 v[16:19], a[84:87], v[68:71], 0
    ds_read_b64_tr_b16 a[80:81], v8 offset:25280
    ds_read_b64_tr_b16 a[82:83], v9 offset:25280
    ds_read_b64_tr_b16 a[28:29], v8 offset:12544
    ds_read_b64_tr_b16 a[30:31], v9 offset:12544
    v_mfma_f32_16x16x32_bf16 v[20:23], a[88:91], v[68:71], 0
    ds_read_b64_tr_b16 a[32:33], v8 offset:12576
    ds_read_b64_tr_b16 a[34:35], v9 offset:12576
    ds_read_b64_tr_b16 a[36:37], v8 offset:12608
    ds_read_b64_tr_b16 a[38:39], v9 offset:12608
    v_mfma_f32_16x16x32_bf16 v[24:27], a[92:95], v[68:71], 0
    ds_read_b64_tr_b16 a[40:41], v8 offset:12640
    ds_read_b64_tr_b16 a[42:43], v9 offset:12640
    ds_read_b64_tr_b16 a[44:45], v8 offset:12672
    ds_read_b64_tr_b16 a[46:47], v9 offset:12672
    v_mfma_f32_16x16x32_bf16 v[28:31], a[96:99], v[68:71], 0
    ds_read_b64_tr_b16 a[48:49], v8 offset:12704
    ds_read_b64_tr_b16 a[50:51], v9 offset:12704
    ds_read_b64_tr_b16 a[52:53], v8 offset:12736
    ds_read_b64_tr_b16 a[54:55], v9 offset:12736
    v_mfma_f32_16x16x32_bf16 v[32:35], a[100:103], v[68:71], 0
    ds_read_b64_tr_b16 a[0:1], v8 offset:0
    ds_read_b64_tr_b16 a[2:3], v9 offset:0
    ds_read_b64_tr_b16 a[4:5], v8 offset:32
    ds_read_b64_tr_b16 a[6:7], v9 offset:32
    v_mfma_f32_16x16x32_bf16 v[36:39], a[104:107], v[68:71], 0
    ds_read_b64_tr_b16 a[8:9], v8 offset:64
    ds_read_b64_tr_b16 a[10:11], v9 offset:64
    ds_read_b64_tr_b16 a[12:13], v8 offset:96
    ds_read_b64_tr_b16 a[14:15], v9 offset:96
    v_mfma_f32_16x16x32_bf16 v[40:43], a[108:111], v[68:71], 0
    ds_read_b64_tr_b16 a[16:17], v8 offset:128
    ds_read_b64_tr_b16 a[18:19], v9 offset:128
    ds_read_b64_tr_b16 a[20:21], v8 offset:160
    ds_read_b64_tr_b16 a[22:23], v9 offset:160
    v_mfma_f32_16x16x32_bf16 v[16:19], v[112:115], v[72:75], v[16:19]
    ds_read_b64_tr_b16 a[24:25], v8 offset:192
    ds_read_b64_tr_b16 a[26:27], v9 offset:192
    ds_read_b64_tr_b16 v[100:101], v8 offset:31360
    ds_read_b64_tr_b16 v[102:103], v9 offset:31360
    v_mfma_f32_16x16x32_bf16 v[20:23], v[116:119], v[72:75], v[20:23]
    ds_read_b64_tr_b16 v[104:105], v8 offset:31392
    ds_read_b64_tr_b16 v[106:107], v9 offset:31392
    ds_read_b64_tr_b16 v[108:109], v8 offset:31424
    ds_read_b64_tr_b16 v[110:111], v9 offset:31424
    v_mfma_f32_16x16x32_bf16 v[24:27], v[120:123], v[72:75], v[24:27]
    ds_read_b64_tr_b16 v[88:89], v8 offset:18816
    ds_read_b64_tr_b16 v[90:91], v9 offset:18816
    ds_read_b64_tr_b16 v[92:93], v8 offset:18848
    ds_read_b64_tr_b16 v[94:95], v9 offset:18848
    v_mfma_f32_16x16x32_bf16 v[28:31], v[124:127], v[72:75], v[28:31]
    ds_read_b64_tr_b16 v[96:97], v8 offset:18880
    ds_read_b64_tr_b16 v[98:99], v9 offset:18880
    ds_read_b64_tr_b16 v[76:77], v8 offset:6272
    ds_read_b64_tr_b16 v[78:79], v9 offset:6272
    v_mfma_f32_16x16x32_bf16 v[32:35], v[128:131], v[72:75], v[32:35]
    ds_read_b64_tr_b16 v[80:81], v8 offset:6304
    ds_read_b64_tr_b16 v[82:83], v9 offset:6304
    ds_read_b64_tr_b16 v[84:85], v8 offset:6336
    ds_read_b64_tr_b16 v[86:87], v9 offset:6336
    v_mfma_f32_16x16x32_bf16 v[36:39], v[132:135], v[72:75], v[36:39]
    v_mfma_f32_16x16x32_bf16 v[40:43], v[136:139], v[72:75], v[40:43]
    s_sleep 4
    buffer_load_dwordx4 v[60:63], v6, s[40:43], s82 offen offset:0 nt
    buffer_load_dwordx4 v[64:67], v6, s[40:43], s82 offen offset:1024 nt
    buffer_load_dwordx4 v[52:55], v6, s[40:43], s81 offen offset:0 nt
    buffer_load_dwordx4 v[56:59], v6, s[40:43], s81 offen offset:1024 nt
    buffer_load_dwordx4 v[44:47], v6, s[40:43], s80 offen offset:0 nt
    buffer_load_dwordx4 v[48:51], v6, s[40:43], s80 offen offset:1024 nt
    buffer_load_dword v3, off, s[40:43], s83
    buffer_load_dword v3, off, s[40:43], s83
    s_branch CK_129
F0_141:
    ds_read_b64_tr_b16 a[80:81], v8 offset:25280
    v_mov_b32 v16, 0
    ds_read_b64_tr_b16 a[82:83], v9 offset:25280
    v_mov_b32 v17, 0
    ds_read_b64_tr_b16 a[28:29], v8 offset:12544
    v_mov_b32 v18, 0
    ds_read_b64_tr_b16 a[30:31], v9 offset:12544
    v_mov_b32 v19, 0
    ds_read_b64_tr_b16 a[32:33], v8 offset:12576
    v_mov_b32 v20, 0
    ds_read_b64_tr_b16 a[34:35], v9 offset:12576
    v_mov_b32 v21, 0
    ds_read_b64_tr_b16 a[36:37], v8 offset:12608
    v_mov_b32 v22, 0
    ds_read_b64_tr_b16 a[38:39], v9 offset:12608
    v_mov_b32 v23, 0
    ds_read_b64_tr_b16 a[40:41], v8 offset:12640
    v_mov_b32 v24, 0
    ds_read_b64_tr_b16 a[42:43], v9 offset:12640
    v_mov_b32 v25, 0
    ds_read_b64_tr_b16 a[44:45], v8 offset:12672
    v_mov_b32 v26, 0
    ds_read_b64_tr_b16 a[46:47], v9 offset:12672
    v_mov_b32 v27, 0
    ds_read_b64_tr_b16 a[48:49], v8 offset:12704
    v_mov_b32 v28, 0
    ds_read_b64_tr_b16 a[50:51], v9 offset:12704
    v_mov_b32 v29, 0
    ds_read_b64_tr_b16 a[52:53], v8 offset:12736
    v_mov_b32 v30, 0
    ds_read_b64_tr_b16 a[54:55], v9 offset:12736
    v_mov_b32 v31, 0
    ds_read_b64_tr_b16 a[0:1], v8 offset:0
    v_mov_b32 v32, 0
    ds_read_b64_tr_b16 a[2:3], v9 offset:0
    v_mov_b32 v33, 0
    ds_read_b64_tr_b16 a[4:5], v8 offset:32
    v_mov_b32 v34, 0
    ds_read_b64_tr_b16 a[6:7], v9 offset:32
    v_mov_b32 v35, 0
    ds_read_b64_tr_b16 a[8:9], v8 offset:64
    v_mov_b32 v36, 0
    ds_read_b64_tr_b16 a[10:11], v9 offset:64
    v_mov_b32 v37, 0
    ds_read_b64_tr_b16 a[12:13], v8 offset:96
    v_mov_b32 v38, 0
    ds_read_b64_tr_b16 a[14:15], v9 offset:96
    v_mov_b32 v39, 0
    ds_read_b64_tr_b16 a[16:17], v8 offset:128
    v_mov_b32 v40, 0
    ds_read_b64_tr_b16 a[18:19], v9 offset:128
    v_mov_b32 v41, 0
    ds_read_b64_tr_b16 a[20:21], v8 offset:160
    v_mov_b32 v42, 0
    ds_read_b64_tr_b16 a[22:23], v9 offset:160
    v_mov_b32 v43, 0
    ds_read_b64_tr_b16 a[24:25], v8 offset:192
    ds_read_b64_tr_b16 a[26:27], v9 offset:192
    ds_read_b64_tr_b16 v[100:101], v8 offset:31360
    ds_read_b64_tr_b16 v[102:103], v9 offset:31360
    ds_read_b64_tr_b16 v[104:105], v8 offset:31392
    ds_read_b64_tr_b16 v[106:107], v9 offset:31392
    ds_read_b64_tr_b16 v[108:109], v8 offset:31424
    ds_read_b64_tr_b16 v[110:111], v9 offset:31424
    ds_read_b64_tr_b16 v[88:89], v8 offset:18816
    ds_read_b64_tr_b16 v[90:91], v9 offset:18816
    ds_read_b64_tr_b16 v[92:93], v8 offset:18848
    ds_read_b64_tr_b16 v[94:95], v9 offset:18848
    ds_read_b64_tr_b16 v[96:97], v8 offset:18880
    ds_read_b64_tr_b16 v[98:99], v9 offset:18880
    ds_read_b64_tr_b16 v[76:77], v8 offset:6272
    ds_read_b64_tr_b16 v[78:79], v9 offset:6272
    ds_read_b64_tr_b16 v[80:81], v8 offset:6304
    ds_read_b64_tr_b16 v[82:83], v9 offset:6304
    ds_read_b64_tr_b16 v[84:85], v8 offset:6336
    ds_read_b64_tr_b16 v[86:87], v9 offset:6336
    s_sleep 4
    buffer_load_dwordx4 v[68:71], v6, s[40:43], s83 offen offset:0 nt
    buffer_load_dwordx4 v[72:75], v6, s[40:43], s83 offen offset:1024 nt
    buffer_load_dwordx4 v[60:63], v6, s[40:43], s82 offen offset:0 nt
    buffer_load_dwordx4 v[64:67], v6, s[40:43], s82 offen offset:1024 nt
    buffer_load_dwordx4 v[52:55], v6, s[40:43], s81 offen offset:0 nt
    buffer_load_dwordx4 v[56:59], v6, s[40:43], s81 offen offset:1024 nt
    buffer_load_dwordx4 v[44:47], v6, s[40:43], s80 offen offset:0 nt
    buffer_load_dwordx4 v[48:51], v6, s[40:43], s80 offen offset:1024 nt
CK_134:
    s_waitcnt vmcnt(6)
    v_xor_b32 v71, s61, v71
    v_xor_b32 v75, s61, v75
    v_or_b32 v13, v71, v75
    v_cmp_gt_u32 vcc, s68, v13
    s_cmp_eq_u64 vcc, -1
    s_cselect_b32 s3, s79, 0
    s_bitcmp1_b32 s3, 3
    s_cbranch_scc0 SL_136
    s_waitcnt lgkmcnt(15)
RN_135:
    s_bitset0_b32 s79, 3
    s_cmp_eq_u32 s79, 0
    v_mfma_f32_16x16x32_bf16 v[16:19], a[84:87], v[68:71], v[16:19]
    ds_read_b64_tr_b16 v[124:125], v8 offset:44000
    ds_read_b64_tr_b16 v[126:127], v9 offset:44000
    v_mfma_f32_16x16x32_bf16 v[20:23], a[88:91], v[68:71], v[20:23]
    ds_read_b64_tr_b16 v[128:129], v8 offset:44032
    ds_read_b64_tr_b16 v[130:131], v9 offset:44032
    v_mfma_f32_16x16x32_bf16 v[24:27], a[92:95], v[68:71], v[24:27]
    ds_read_b64_tr_b16 v[132:133], v8 offset:44064
    ds_read_b64_tr_b16 v[134:135], v9 offset:44064
    v_mfma_f32_16x16x32_bf16 v[28:31], a[96:99], v[68:71], v[28:31]
    ds_read_b64_tr_b16 v[136:137], v8 offset:44096
    ds_read_b64_tr_b16 v[138:139], v9 offset:44096
    v_mfma_f32_16x16x32_bf16 v[32:35], a[100:103], v[68:71], v[32:35]
    buffer_load_dword v3, off, s[40:43], s83
    v_mfma_f32_16x16x32_bf16 v[36:39], a[104:107], v[68:71], v[36:39]
    buffer_load_dword v3, off, s[40:43], s83
    v_mfma_f32_16x16x32_bf16 v[40:43], a[108:111], v[68:71], v[40:43]
    s_waitcnt lgkmcnt(8)
    v_mfma_f32_16x16x32_bf16 v[16:19], v[112:115], v[72:75], v[16:19]
    v_mfma_f32_16x16x32_bf16 v[20:23], v[116:119], v[72:75], v[20:23]
    v_mfma_f32_16x16x32_bf16 v[24:27], v[120:123], v[72:75], v[24:27]
    s_cbranch_scc1 LS_138
    s_waitcnt vmcnt(6)
    v_xor_b32 v63, s61, v63
    s_waitcnt lgkmcnt(6)
    v_mfma_f32_16x16x32_bf16 v[28:31], v[124:127], v[72:75], v[28:31]
    v_xor_b32 v67, s61, v67
    v_or_b32 v13, v63, v67
    s_waitcnt lgkmcnt(4)
    v_mfma_f32_16x16x32_bf16 v[32:35], v[128:131], v[72:75], v[32:35]
    v_cmp_gt_u32 vcc, s68, v13
    s_cmp_eq_u64 vcc, -1
    s_waitcnt lgkmcnt(2)
    v_mfma_f32_16x16x32_bf16 v[36:39], v[132:135], v[72:75], v[36:39]
    s_cselect_b32 s3, s79, 0
    s_bitcmp1_b32 s3, 2
    s_waitcnt lgkmcnt(0)
    v_mfma_f32_16x16x32_bf16 v[40:43], v[136:139], v[72:75], v[40:43]
    s_cbranch_scc1 RN_130
    s_branch SL_131
LS_138:
    s_waitcnt lgkmcnt(0)
    s_mov_b64 exec, 1
    ds_add_rtn_u32 v15, v11, v4
    ds_read_b32 v13, v11 offset:4
    s_mov_b64 exec, -1
    v_mfma_f32_16x16x32_bf16 v[28:31], v[124:127], v[72:75], v[28:31]
    ds_read_b128 v[76:79], v12 offset:0
    ds_read_b128 v[80:83], v12 offset:1024
    v_mfma_f32_16x16x32_bf16 v[32:35], v[128:131], v[72:75], v[32:35]
    ds_read_b128 v[84:87], v12 offset:2048
    ds_read_b128 v[88:91], v12 offset:3072
    v_mfma_f32_16x16x32_bf16 v[36:39], v[132:135], v[72:75], v[36:39]
    ds_read_b128 v[92:95], v12 offset:4096
    ds_read_b128 v[96:99], v12 offset:5120
    v_mfma_f32_16x16x32_bf16 v[40:43], v[136:139], v[72:75], v[40:43]
    ds_read_b128 v[100:103], v12 offset:6144
    s_branch PDN_139
SL_136:
    s_bitcmp1_b32 s79, 3
    s_cbranch_scc0 DM_137
    s_sleep 2
    buffer_load_dwordx4 v[68:71], v6, s[40:43], s83 offen offset:0 nt
    buffer_load_dwordx4 v[72:75], v6, s[40:43], s83 offen offset:1024 nt
    s_branch NX_142
DM_137:
    buffer_load_dword v3, off, s[40:43], s83
    buffer_load_dword v3, off, s[40:43], s83
NX_142:
CK_129:
    s_waitcnt vmcnt(6)
    v_xor_b32 v63, s61, v63
    v_xor_b32 v67, s61, v67
    v_or_b32 v13, v63, v67
    v_cmp_gt_u32 vcc, s68, v13
    s_cmp_eq_u64 vcc, -1
    s_cselect_b32 s3, s79, 0
    s_bitcmp1_b32 s3, 2
    s_cbranch_scc0 SL_131
    s_waitcnt lgkmcnt(15)
RN_130:
    s_bitset0_b32 s79, 2
    s_cmp_eq_u32 s79, 0
    v_mfma_f32_16x16x32_bf16 v[16:19], a[56:59], v[60:63], v[16:19]
    ds_read_b64_tr_b16 v[124:125], v8 offset:31456
    ds_read_b64_tr_b16 v[126:127], v9 offset:31456
    v_mfma_f32_16x16x32_bf16 v[20:23], a[60:63], v[60:63], v[20:23]
    ds_read_b64_tr_b16 v[128:129], v8 offset:31488
    ds_read_b64_tr_b16 v[130:131], v9 offset:31488
    v_mfma_f32_16x16x32_bf16 v[24:27], a[64:67], v[60:63], v[24:27]
    ds_read_b64_tr_b16 v[132:133], v8 offset:31520
    ds_read_b64_tr_b16 v[134:135], v9 offset:31520
    v_mfma_f32_16x16x32_bf16 v[28:31], a[68:71], v[60:63], v[28:31]
    ds_read_b64_tr_b16 v[136:137], v8 offset:31552
    ds_read_b64_tr_b16 v[138:139], v9 offset:31552
    v_mfma_f32_16x16x32_bf16 v[32:35], a[72:75], v[60:63], v[32:35]
    buffer_load_dword v3, off, s[40:43], s82
    v_mfma_f32_16x16x32_bf16 v[36:39], a[76:79], v[60:63], v[36:39]
    buffer_load_dword v3, off, s[40:43], s82
    v_mfma_f32_16x16x32_bf16 v[40:43], a[80:83], v[60:63], v[40:43]
    s_waitcnt lgkmcnt(8)
    v_mfma_f32_16x16x32_bf16 v[16:19], v[100:103], v[64:67], v[16:19]
    v_mfma_f32_16x16x32_bf16 v[20:23], v[104:107], v[64:67], v[20:23]
    v_mfma_f32_16x16x32_bf16 v[24:27], v[108:111], v[64:67], v[24:27]
    s_cbranch_scc1 LS_133
    s_waitcnt vmcnt(6)
    v_xor_b32 v55, s61, v55
    s_waitcnt lgkmcnt(6)
    v_mfma_f32_16x16x32_bf16 v[28:31], v[124:127], v[64:67], v[28:31]
    v_xor_b32 v59, s61, v59
    v_or_b32 v13, v55, v59
    s_waitcnt lgkmcnt(4)
    v_mfma_f32_16x16x32_bf16 v[32:35], v[128:131], v[64:67], v[32:35]
    v_cmp_gt_u32 vcc, s68, v13
    s_cmp_eq_u64 vcc, -1
    s_waitcnt lgkmcnt(2)
    v_mfma_f32_16x16x32_bf16 v[36:39], v[132:135], v[64:67], v[36:39]
    s_cselect_b32 s3, s79, 0
    s_bitcmp1_b32 s3, 1
    s_waitcnt lgkmcnt(0)
    v_mfma_f32_16x16x32_bf16 v[40:43], v[136:139], v[64:67], v[40:43]
    s_cbranch_scc1 RN_125
    s_branch SL_126
LS_133:
    s_waitcnt lgkmcnt(0)
    s_mov_b64 exec, 1
    ds_add_rtn_u32 v15, v11, v4
    ds_read_b32 v13, v11 offset:4
    s_mov_b64 exec, -1
    v_mfma_f32_16x16x32_bf16 v[28:31], v[124:127], v[64:67], v[28:31]
    ds_read_b128 v[76:79], v12 offset:0
    ds_read_b128 v[80:83], v12 offset:1024
    v_mfma_f32_16x16x32_bf16 v[32:35], v[128:131], v[64:67], v[32:35]
    ds_read_b128 v[84:87], v12 offset:2048
    ds_read_b128 v[88:91], v12 offset:3072
    v_mfma_f32_16x16x32_bf16 v[36:39], v[132:135], v[64:67], v[36:39]
    ds_read_b128 v[92:95], v12 offset:4096
    ds_read_b128 v[96:99], v12 offset:5120
    v_mfma_f32_16x16x32_bf16 v[40:43], v[136:139], v[64:67], v[40:43]
    ds_read_b128 v[100:103], v12 offset:6144
    s_branch PDN_139
SL_131:
    s_bitcmp1_b32 s79, 2
    s_cbranch_scc0 DM_132
    s_sleep 2
    buffer_load_dwordx4 v[60:63], v6, s[40:43], s82 offen offset:0 nt
    buffer_load_dwordx4 v[64:67], v6, s[40:43], s82 offen offset:1024 nt
    s_branch NX_143
DM_132:
    buffer_load_dword v3, off, s[40:43], s82
    buffer_load_dword v3, off, s[40:43], s82
NX_143:
CK_124:
    s_waitcnt vmcnt(6)
    v_xor_b32 v55, s61, v55
    v_xor_b32 v59, s61, v59
    v_or_b32 v13, v55, v59
    v_cmp_gt_u32 vcc, s68, v13
    s_cmp_eq_u64 vcc, -1
    s_cselect_b32 s3, s79, 0
    s_bitcmp1_b32 s3, 1
    s_cbranch_scc0 SL_126
    s_waitcnt lgkmcnt(15)
RN_125:
    s_bitset0_b32 s79, 1
    s_cmp_eq_u32 s79, 0
    v_mfma_f32_16x16x32_bf16 v[16:19], a[28:31], v[52:55], v[16:19]
    ds_read_b64_tr_b16 v[124:125], v8 offset:18912
    ds_read_b64_tr_b16 v[126:127], v9 offset:18912
    v_mfma_f32_16x16x32_bf16 v[20:23], a[32:35], v[52:55], v[20:23]
    ds_read_b64_tr_b16 v[128:129], v8 offset:18944
    ds_read_b64_tr_b16 v[130:131], v9 offset:18944
    v_mfma_f32_16x16x32_bf16 v[24:27], a[36:39], v[52:55], v[24:27]
    ds_read_b64_tr_b16 v[132:133], v8 offset:18976
    ds_read_b64_tr_b16 v[134:135], v9 offset:18976
    v_mfma_f32_16x16x32_bf16 v[28:31], a[40:43], v[52:55], v[28:31]
    ds_read_b64_tr_b16 v[136:137], v8 offset:19008
    ds_read_b64_tr_b16 v[138:139], v9 offset:19008
    v_mfma_f32_16x16x32_bf16 v[32:35], a[44:47], v[52:55], v[32:35]
    buffer_load_dword v3, off, s[40:43], s81
    v_mfma_f32_16x16x32_bf16 v[36:39], a[48:51], v[52:55], v[36:39]
    buffer_load_dword v3, off, s[40:43], s81
    v_mfma_f32_16x16x32_bf16 v[40:43], a[52:55], v[52:55], v[40:43]
    s_waitcnt lgkmcnt(8)
    v_mfma_f32_16x16x32_bf16 v[16:19], v[88:91], v[56:59], v[16:19]
    v_mfma_f32_16x16x32_bf16 v[20:23], v[92:95], v[56:59], v[20:23]
    v_mfma_f32_16x16x32_bf16 v[24:27], v[96:99], v[56:59], v[24:27]
    s_cbranch_scc1 LS_128
    s_waitcnt vmcnt(6)
    v_xor_b32 v47, s61, v47
    s_waitcnt lgkmcnt(6)
    v_mfma_f32_16x16x32_bf16 v[28:31], v[124:127], v[56:59], v[28:31]
    v_xor_b32 v51, s61, v51
    v_or_b32 v13, v47, v51
    s_waitcnt lgkmcnt(4)
    v_mfma_f32_16x16x32_bf16 v[32:35], v[128:131], v[56:59], v[32:35]
    v_cmp_gt_u32 vcc, s68, v13
    s_cmp_eq_u64 vcc, -1
    s_waitcnt lgkmcnt(2)
    v_mfma_f32_16x16x32_bf16 v[36:39], v[132:135], v[56:59], v[36:39]
    s_cselect_b32 s3, s79, 0
    s_bitcmp1_b32 s3, 0
    s_waitcnt lgkmcnt(0)
    v_mfma_f32_16x16x32_bf16 v[40:43], v[136:139], v[56:59], v[40:43]
    s_cbranch_scc1 RN_120
    s_branch SL_121
LS_128:
    s_waitcnt lgkmcnt(0)
    s_mov_b64 exec, 1
    ds_add_rtn_u32 v15, v11, v4
    ds_read_b32 v13, v11 offset:4
    s_mov_b64 exec, -1
    v_mfma_f32_16x16x32_bf16 v[28:31], v[124:127], v[56:59], v[28:31]
    ds_read_b128 v[76:79], v12 offset:0
    ds_read_b128 v[80:83], v12 offset:1024
    v_mfma_f32_16x16x32_bf16 v[32:35], v[128:131], v[56:59], v[32:35]
    ds_read_b128 v[84:87], v12 offset:2048
    ds_read_b128 v[88:91], v12 offset:3072
    v_mfma_f32_16x16x32_bf16 v[36:39], v[132:135], v[56:59], v[36:39]
    ds_read_b128 v[92:95], v12 offset:4096
    ds_read_b128 v[96:99], v12 offset:5120
    v_mfma_f32_16x16x32_bf16 v[40:43], v[136:139], v[56:59], v[40:43]
    ds_read_b128 v[100:103], v12 offset:6144
    s_branch PDN_139
SL_126:
    s_bitcmp1_b32 s79, 1
    s_cbranch_scc0 DM_127
    s_sleep 2
    buffer_load_dwordx4 v[52:55], v6, s[40:43], s81 offen offset:0 nt
    buffer_load_dwordx4 v[56:59], v6, s[40:43], s81 offen offset:1024 nt
    s_branch NX_144
DM_127:
    buffer_load_dword v3, off, s[40:43], s81
    buffer_load_dword v3, off, s[40:43], s81
NX_144:
CK_119:
    s_waitcnt vmcnt(6)
    v_xor_b32 v47, s61, v47
    v_xor_b32 v51, s61, v51
    v_or_b32 v13, v47, v51
    v_cmp_gt_u32 vcc, s68, v13
    s_cmp_eq_u64 vcc, -1
    s_cselect_b32 s3, s79, 0
    s_bitcmp1_b32 s3, 0
    s_cbranch_scc0 SL_121
    s_waitcnt lgkmcnt(15)
RN_120:
    s_bitset0_b32 s79, 0
    s_cmp_eq_u32 s79, 0
    v_mfma_f32_16x16x32_bf16 v[16:19], a[0:3], v[44:47], v[16:19]
    ds_read_b64_tr_b16 v[124:125], v8 offset:6368
    ds_read_b64_tr_b16 v[126:127], v9 offset:6368
    v_mfma_f32_16x16x32_bf16 v[20:23], a[4:7], v[44:47], v[20:23]
    ds_read_b64_tr_b16 v[128:129], v8 offset:6400
    ds_read_b64_tr_b16 v[130:131], v9 offset:6400
    v_mfma_f32_16x16x32_bf16 v[24:27], a[8:11], v[44:47], v[24:27]
    ds_read_b64_tr_b16 v[132:133], v8 offset:6432
    ds_read_b64_tr_b16 v[134:135], v9 offset:6432
    v_mfma_f32_16x16x32_bf16 v[28:31], a[12:15], v[44:47], v[28:31]
    ds_read_b64_tr_b16 v[136:137], v8 offset:6464
    ds_read_b64_tr_b16 v[138:139], v9 offset:6464
    v_mfma_f32_16x16x32_bf16 v[32:35], a[16:19], v[44:47], v[32:35]
    buffer_load_dword v3, off, s[40:43], s80
    v_mfma_f32_16x16x32_bf16 v[36:39], a[20:23], v[44:47], v[36:39]
    buffer_load_dword v3, off, s[40:43], s80
    v_mfma_f32_16x16x32_bf16 v[40:43], a[24:27], v[44:47], v[40:43]
    s_waitcnt lgkmcnt(8)
    v_mfma_f32_16x16x32_bf16 v[16:19], v[76:79], v[48:51], v[16:19]
    v_mfma_f32_16x16x32_bf16 v[20:23], v[80:83], v[48:51], v[20:23]
    v_mfma_f32_16x16x32_bf16 v[24:27], v[84:87], v[48:51], v[24:27]
    s_cbranch_scc1 LS_123
    s_waitcnt vmcnt(6)
    v_xor_b32 v71, s61, v71
    s_waitcnt lgkmcnt(6)
    v_mfma_f32_16x16x32_bf16 v[28:31], v[124:127], v[48:51], v[28:31]
    v_xor_b32 v75, s61, v75
    v_or_b32 v13, v71, v75
    s_waitcnt lgkmcnt(4)
    v_mfma_f32_16x16x32_bf16 v[32:35], v[128:131], v[48:51], v[32:35]
    v_cmp_gt_u32 vcc, s68, v13
    s_cmp_eq_u64 vcc, -1
    s_waitcnt lgkmcnt(2)
    v_mfma_f32_16x16x32_bf16 v[36:39], v[132:135], v[48:51], v[36:39]
    s_cselect_b32 s3, s79, 0
    s_bitcmp1_b32 s3, 3
    s_waitcnt lgkmcnt(0)
    v_mfma_f32_16x16x32_bf16 v[40:43], v[136:139], v[48:51], v[40:43]
    s_cbranch_scc1 RN_135
    s_branch SL_136
LS_123:
    s_waitcnt lgkmcnt(0)
    s_mov_b64 exec, 1
    ds_add_rtn_u32 v15, v11, v4
    ds_read_b32 v13, v11 offset:4
    s_mov_b64 exec, -1
    v_mfma_f32_16x16x32_bf16 v[28:31], v[124:127], v[48:51], v[28:31]
    ds_read_b128 v[76:79], v12 offset:0
    ds_read_b128 v[80:83], v12 offset:1024
    v_mfma_f32_16x16x32_bf16 v[32:35], v[128:131], v[48:51], v[32:35]
    ds_read_b128 v[84:87], v12 offset:2048
    ds_read_b128 v[88:91], v12 offset:3072
    v_mfma_f32_16x16x32_bf16 v[36:39], v[132:135], v[48:51], v[36:39]
    ds_read_b128 v[92:95], v12 offset:4096
    ds_read_b128 v[96:99], v12 offset:5120
    v_mfma_f32_16x16x32_bf16 v[40:43], v[136:139], v[48:51], v[40:43]
    ds_read_b128 v[100:103], v12 offset:6144
    s_branch PDN_139
SL_121:
    s_bitcmp1_b32 s79, 0
    s_cbranch_scc0 DM_122
    s_sleep 2
    buffer_load_dwordx4 v[44:47], v6, s[40:43], s80 offen offset:0 nt
    buffer_load_dwordx4 v[48:51], v6, s[40:43], s80 offen offset:1024 nt
    s_branch NX_145
DM_122:
    buffer_load_dword v3, off, s[40:43], s80
    buffer_load_dword v3, off, s[40:43], s80
NX_145:
    s_add_u32 s78, s78, 1
    s_cmp_lt_u32 s78, 64
    s_cbranch_scc1 CK_134
    s_branch PFB_140
PDN_139:
    s_waitcnt lgkmcnt(7)
    v_readfirstlane_b32 s3, v13
    v_readfirstlane_b32 s27, v15
    s_nop 2
    s_cmp_eq_u32 s3, 1
    s_cbranch_scc1 FIN_146
    s_cmp_eq_u32 s27, 0
    s_cbranch_scc0 SEC_147
    s_nop 3
    ds_write_b128 v12, v[16:19] offset:0
    ds_write_b128 v12, v[20:23] offset:1024
    ds_write_b128 v12, v[24:27] offset:2048
    ds_write_b128 v12, v[28:31] offset:3072
    ds_write_b128 v12, v[32:35] offset:4096
    ds_write_b128 v12, v[36:39] offset:5120
    ds_write_b128 v12, v[40:43] offset:6144
    s_mov_b64 exec, 1
    s_waitcnt lgkmcnt(0)
    ds_write_b32 v11, v4 offset:4
    s_waitcnt lgkmcnt(0)
    s_mov_b64 exec, -1
    s_endpgm
SEC_147:
    s_mov_b32 s69, 0
SPN_148:
    ds_read_b32 v13, v11 offset:4
    ds_read_b128 v[76:79], v12 offset:0
    ds_read_b128 v[80:83], v12 offset:1024
    ds_read_b128 v[84:87], v12 offset:2048
    ds_read_b128 v[88:91], v12 offset:3072
    ds_read_b128 v[92:95], v12 offset:4096
    ds_read_b128 v[96:99], v12 offset:5120
    ds_read_b128 v[100:103], v12 offset:6144
    s_add_u32 s69, s69, 1
    s_cmp_gt_u32 s69, 0x400000
    s_cbranch_scc1 K_END
    s_waitcnt lgkmcnt(7)
    v_readfirstlane_b32 s3, v13
    s_nop 3
    s_cmp_eq_u32 s3, 1
    s_cbranch_scc0 SPN_148
FIN_146:
    s_and_b32 s3, s48, 3
    s_or_b32 s3, s26, s3
    s_cbranch_scc1 NS_150
    v_mov_b32 v13, s93
    buffer_store_dword v13, off, s[40:43], s60 sc0 sc1
NS_150:
    s_waitcnt lgkmcnt(6)
    v_pk_add_f32 v[16:17], v[16:17], v[76:77]
    v_pk_add_f32 v[18:19], v[18:19], v[78:79]
    v_cvt_pk_bf16_f32 v104, v16, v17
    v_cvt_pk_bf16_f32 v105, v18, v19
    s_waitcnt lgkmcnt(5)
    v_pk_add_f32 v[20:21], v[20:21], v[80:81]
    v_pk_add_f32 v[22:23], v[22:23], v[82:83]
    v_cvt_pk_bf16_f32 v106, v20, v21
    v_cvt_pk_bf16_f32 v107, v22, v23
    s_waitcnt lgkmcnt(4)
    v_pk_add_f32 v[24:25], v[24:25], v[84:85]
    v_pk_add_f32 v[26:27], v[26:27], v[86:87]
    v_cvt_pk_bf16_f32 v108, v24, v25
    v_cvt_pk_bf16_f32 v109, v26, v27
    v_permlane16_swap_b32 v104, v106
    v_permlane16_swap_b32 v105, v107
    s_waitcnt lgkmcnt(3)
    v_pk_add_f32 v[28:29], v[28:29], v[88:89]
    v_pk_add_f32 v[30:31], v[30:31], v[90:91]
    v_cvt_pk_bf16_f32 v110, v28, v29
    v_cvt_pk_bf16_f32 v111, v30, v31
    buffer_store_dwordx4 v[104:107], v10, s[88:91], s87 offen offset:0 nt
    s_waitcnt lgkmcnt(2)
    v_pk_add_f32 v[32:33], v[32:33], v[92:93]
    v_pk_add_f32 v[34:35], v[34:35], v[94:95]
    v_cvt_pk_bf16_f32 v112, v32, v33
    v_cvt_pk_bf16_f32 v113, v34, v35
    v_permlane16_swap_b32 v108, v110
    v_permlane16_swap_b32 v109, v111
    s_waitcnt lgkmcnt(1)
    v_pk_add_f32 v[36:37], v[36:37], v[96:97]
    v_pk_add_f32 v[38:39], v[38:39], v[98:99]
    v_cvt_pk_bf16_f32 v114, v36, v37
    v_cvt_pk_bf16_f32 v115, v38, v39
    buffer_store_dwordx4 v[108:111], v10, s[88:91], s87 offen offset:64 nt
    s_waitcnt lgkmcnt(0)
    v_pk_add_f32 v[40:41], v[40:41], v[100:101]
    v_pk_add_f32 v[42:43], v[42:43], v[102:103]
    v_cvt_pk_bf16_f32 v116, v40, v41
    v_cvt_pk_bf16_f32 v117, v42, v43
    v_permlane16_swap_b32 v112, v114
    v_permlane16_swap_b32 v113, v115
    buffer_store_dwordx2 v[116:117], v14, s[88:91], s87 offen offset:192 nt
    s_nop 0
    buffer_store_dwordx4 v[112:115], v10, s[88:91], s87 offen offset:128 nt
ENDC_149:
    s_endpgm
PFB_140:
    s_waitcnt vmcnt(0)
    s_lshl_b32 s57, s24, 4
    s_add_u32 s57, s57, s25
    s_lshl_b32 s57, s57, 7
    s_add_u32 s57, s57, 0x810000
    s_cmp_eq_u32 s78, 64
    s_cbranch_scc0 NC_151
    s_lshl_b32 s3, s26, 14
    s_add_u32 s62, s59, s3
    s_mov_b32 s69, 0
CP_152:
RL_153:
    v_mov_b32 v13, 0
    s_add_u32 s3, s62, 0
    buffer_load_dwordx4 v[44:47], v6, s[40:43], s3 offen sc0 sc1
    s_add_u32 s3, s62, 1024
    buffer_load_dwordx4 v[48:51], v6, s[40:43], s3 offen sc0 sc1
    s_add_u32 s3, s62, 2048
    buffer_load_dwordx4 v[52:55], v6, s[40:43], s3 offen sc0 sc1
    s_add_u32 s3, s62, 3072
    buffer_load_dwordx4 v[56:59], v6, s[40:43], s3 offen sc0 sc1
    s_add_u32 s3, s62, 4096
    buffer_load_dwordx4 v[60:63], v6, s[40:43], s3 offen sc0 sc1
    s_add_u32 s3, s62, 5120
    buffer_load_dwordx4 v[64:67], v6, s[40:43], s3 offen sc0 sc1
    s_add_u32 s3, s62, 6144
    buffer_load_dwordx4 v[68:71], v6, s[40:43], s3 offen sc0 sc1
    s_add_u32 s3, s62, 7168
    buffer_load_dwordx4 v[72:75], v6, s[40:43], s3 offen sc0 sc1
    s_waitcnt vmcnt(0)
    v_xor_b32 v15, s61, v47
    v_or_b32 v13, v13, v15
    v_xor_b32 v15, s61, v51
    v_or_b32 v13, v13, v15
    v_xor_b32 v15, s61, v55
    v_or_b32 v13, v13, v15
    v_xor_b32 v15, s61, v59
    v_or_b32 v13, v13, v15
    v_xor_b32 v15, s61, v63
    v_or_b32 v13, v13, v15
    v_xor_b32 v15, s61, v67
    v_or_b32 v13, v13, v15
    v_xor_b32 v15, s61, v71
    v_or_b32 v13, v13, v15
    v_xor_b32 v15, s61, v75
    v_or_b32 v13, v13, v15
    v_cmp_gt_u32 vcc, 0x10000, v13
    s_add_u32 s69, s69, 1
    s_cmp_gt_u32 s69, 0x40000
    s_cbranch_scc1 K_END
    s_cmp_eq_u64 vcc, -1
    s_cbranch_scc0 RL_153
    s_add_u32 s3, s62, 0x400000
    buffer_store_dwordx4 v[44:47], v6, s[40:43], s3 offen sc0 sc1
    s_add_u32 s3, s62, 0x400400
    buffer_store_dwordx4 v[48:51], v6, s[40:43], s3 offen sc0 sc1
    s_add_u32 s3, s62, 0x400800
    buffer_store_dwordx4 v[52:55], v6, s[40:43], s3 offen sc0 sc1
    s_add_u32 s3, s62, 0x400c00
    buffer_store_dwordx4 v[56:59], v6, s[40:43], s3 offen sc0 sc1
    s_add_u32 s3, s62, 0x401000
    buffer_store_dwordx4 v[60:63], v6, s[40:43], s3 offen sc0 sc1
    s_add_u32 s3, s62, 0x401400
    buffer_store_dwordx4 v[64:67], v6, s[40:43], s3 offen sc0 sc1
    s_add_u32 s3, s62, 0x401800
    buffer_store_dwordx4 v[68:71], v6, s[40:43], s3 offen sc0 sc1
    s_add_u32 s3, s62, 0x401c00
    buffer_store_dwordx4 v[72:75], v6, s[40:43], s3 offen sc0 sc1
    s_waitcnt vmcnt(0)
RL_154:
    v_mov_b32 v13, 0
    s_add_u32 s3, s62, 8192
    buffer_load_dwordx4 v[44:47], v6, s[40:43], s3 offen sc0 sc1
    s_add_u32 s3, s62, 9216
    buffer_load_dwordx4 v[48:51], v6, s[40:43], s3 offen sc0 sc1
    s_add_u32 s3, s62, 10240
    buffer_load_dwordx4 v[52:55], v6, s[40:43], s3 offen sc0 sc1
    s_add_u32 s3, s62, 11264
    buffer_load_dwordx4 v[56:59], v6, s[40:43], s3 offen sc0 sc1
    s_add_u32 s3, s62, 12288
    buffer_load_dwordx4 v[60:63], v6, s[40:43], s3 offen sc0 sc1
    s_add_u32 s3, s62, 13312
    buffer_load_dwordx4 v[64:67], v6, s[40:43], s3 offen sc0 sc1
    s_add_u32 s3, s62, 14336
    buffer_load_dwordx4 v[68:71], v6, s[40:43], s3 offen sc0 sc1
    s_add_u32 s3, s62, 15360
    buffer_load_dwordx4 v[72:75], v6, s[40:43], s3 offen sc0 sc1
    s_waitcnt vmcnt(0)
    v_xor_b32 v15, s61, v47
    v_or_b32 v13, v13, v15
    v_xor_b32 v15, s61, v51
    v_or_b32 v13, v13, v15
    v_xor_b32 v15, s61, v55
    v_or_b32 v13, v13, v15
    v_xor_b32 v15, s61, v59
    v_or_b32 v13, v13, v15
    v_xor_b32 v15, s61, v63
    v_or_b32 v13, v13, v15
    v_xor_b32 v15, s61, v67
    v_or_b32 v13, v13, v15
    v_xor_b32 v15, s61, v71
    v_or_b32 v13, v13, v15
    v_xor_b32 v15, s61, v75
    v_or_b32 v13, v13, v15
    v_cmp_gt_u32 vcc, 0x10000, v13
    s_add_u32 s69, s69, 1
    s_cmp_gt_u32 s69, 0x40000
    s_cbranch_scc1 K_END
    s_cmp_eq_u64 vcc, -1
    s_cbranch_scc0 RL_154
    s_add_u32 s3, s62, 0x402000
    buffer_store_dwordx4 v[44:47], v6, s[40:43], s3 offen sc0 sc1
    s_add_u32 s3, s62, 0x402400
    buffer_store_dwordx4 v[48:51], v6, s[40:43], s3 offen sc0 sc1
    s_add_u32 s3, s62, 0x402800
    buffer_store_dwordx4 v[52:55], v6, s[40:43], s3 offen sc0 sc1
    s_add_u32 s3, s62, 0x402c00
    buffer_store_dwordx4 v[56:59], v6, s[40:43], s3 offen sc0 sc1
    s_add_u32 s3, s62, 0x403000
    buffer_store_dwordx4 v[60:63], v6, s[40:43], s3 offen sc0 sc1
    s_add_u32 s3, s62, 0x403400
    buffer_store_dwordx4 v[64:67], v6, s[40:43], s3 offen sc0 sc1
    s_add_u32 s3, s62, 0x403800
    buffer_store_dwordx4 v[68:71], v6, s[40:43], s3 offen sc0 sc1
    s_add_u32 s3, s62, 0x403c00
    buffer_store_dwordx4 v[72:75], v6, s[40:43], s3 offen sc0 sc1
    s_waitcnt vmcnt(0)
    s_lshl_b32 s3, s26, 2
    s_add_u32 s3, s3, s57
    v_mov_b32 v15, s93
    buffer_store_dword v15, off, s[40:43], s3 sc0 sc1
    s_mov_b32 s68, 0x100000
NC_151:
    v_and_b32 v15, 3, v2
    v_lshlrev_b32 v15, 2, v15
    buffer_load_dword v13, v15, s[40:43], s57 offen offset:16 sc0 sc1
    s_waitcnt vmcnt(0)
    v_cmp_eq_u32 vcc, s93, v13
    s_or_b32 s3, s80, 0x400000
    s_bitcmp1_b32 vcc_lo, 0
    s_cselect_b32 s80, s3, s80
    s_or_b32 s3, s81, 0x400000
    s_bitcmp1_b32 vcc_lo, 1
    s_cselect_b32 s81, s3, s81
    s_or_b32 s3, s82, 0x400000
    s_bitcmp1_b32 vcc_lo, 2
    s_cselect_b32 s82, s3, s82
    s_or_b32 s3, s83, 0x400000
    s_bitcmp1_b32 vcc_lo, 3
    s_cselect_b32 s83, s3, s83
    buffer_load_dwordx4 v[68:71], v6, s[40:43], s83 offen offset:0 sc0 sc1
    buffer_load_dwordx4 v[72:75], v6, s[40:43], s83 offen offset:1024 sc0 sc1
    buffer_load_dwordx4 v[60:63], v6, s[40:43], s82 offen offset:0 sc0 sc1
    buffer_load_dwordx4 v[64:67], v6, s[40:43], s82 offen offset:1024 sc0 sc1
    buffer_load_dwordx4 v[52:55], v6, s[40:43], s81 offen offset:0 sc0 sc1
    buffer_load_dwordx4 v[56:59], v6, s[40:43], s81 offen offset:1024 sc0 sc1
    buffer_load_dwordx4 v[44:47], v6, s[40:43], s80 offen offset:0 sc0 sc1
    buffer_load_dwordx4 v[48:51], v6, s[40:43], s80 offen offset:1024 sc0 sc1
    s_cmp_lt_u32 s78, 0x40000
    s_cbranch_scc1 CK_134
    s_endpgm
T_A0:
    v_and_b32 v5, 15, v2
    v_lshrrev_b32 v6, 4, v2
    v_lshlrev_b32 v3, 4, v2
    v_add_u32 v51, 0, v3
    s_mul_i32 s3, s26, 4096
    s_add_u32 s57, s3, 0xa00000
    v_lshlrev_b32 v52, 8, v6
    v_lshl_add_u32 v52, v5, 2, v52
    v_cmp_gt_u32 s[66:67], 3, v6
    v_cmp_le_u32 s[18:19], 14, v5
    v_cmp_gt_u32 s[20:21], 2, v5
    v_mov_b32 v10, 0xffff
    v_mov_b32 v11, 0xffff0000
    v_cndmask_b32 v58, -1, v11, s[18:19]
    v_cndmask_b32 v58, v58, v10, s[20:21]
    v_mov_b32 v20, 0x3c003c00
    v_bfi_b32 v59, v58, 0, v20
    v_and_b32 v13, 3, v2
    v_lshrrev_b32 v14, 2, v2
    v_cmp_eq_u32 s[4:5], 3, v13
    v_cmp_eq_u32 s[8:9], 0, v13
    s_or_b64 s[6:7], s[8:9], s[4:5]
    v_cndmask_b32 v62, -1, v10, s[8:9]
    v_cndmask_b32 v63, -1, v11, s[4:5]
    v_cndmask_b32 v64, 16, 0, s[4:5]
    v_mov_b32 v56, v3
    v_lshlrev_b32 v20, 4, v13
    v_add_u32 v20, 55808, v20
    v_add_u32 v13, 0, v14
    v_mul_u32_u24 v10, 37, v13
    v_lshrrev_b32 v10, 8, v10
    v_mul_u32_u24 v15, 7, v10
    v_sub_u32 v15, v13, v15
    v_lshrrev_b32 v21, 2, v15
    v_and_b32 v15, 3, v15
    v_lshl_add_u32 v15, v10, 2, v15
    v_lshl_add_u32 v15, v21, 4, v15
    v_lshl_add_u32 v57, v15, 6, v20
    v_lshrrev_b32 v7, 4, v2
    v_lshrrev_b32 v3, 1, v7
    v_bfe_u32 v8, v2, 2, 2
    v_mul_u32_u24 v9, 14, v3
    v_and_b32 v4, 1, v7
    v_lshl_add_u32 v6, v4, 2, v9
    v_add_u32 v6, v6, v8
    v_mul_u32_u24 v5, 3, v4
    v_min_u32 v8, 2, v8
    v_add3_u32 v9, v9, v5, v8
    v_add_u32 v9, 8, v9
    v_and_b32 v5, 3, v2
    v_lshlrev_b32 v5, 3, v5
    v_add_u32 v5, 111616, v5
    v_mul_u32_u24 v8, 224, v6
    v_add_u32 v8, v8, v5
    v_mul_u32_u24 v9, 224, v9
    v_add_u32 v9, v9, v5
    v_lshlrev_b32 v6, 4, v2
    v_and_b32 v13, 15, v2
    v_lshrrev_b32 v15, 4, v2
    v_mul_u32_u24 v13, 1792, v13
    v_and_b32 v10, 1, v15
    v_lshl_add_u32 v14, v15, 3, v13
    v_lshl_add_u32 v10, v10, 5, v13
    v_lshrrev_b32 v15, 1, v15
    s_and_b32 s3, s48, 3
    v_lshl_add_u32 v10, v15, 4, v10
    s_lshl_b32 s27, s3, 3
    s_mul_i32 s3, s3, 7168
    s_add_u32 s27, s27, 161808
    s_add_u32 s3, s3, 61440
    v_mov_b32 v11, s27
    v_add_u32 v12, s3, v6
    v_mov_b32 v4, 1
    s_mov_b32 s78, 0
    s_mov_b32 s79, 15
    s_mov_b32 s68, 0x10000
    v_mov_b32 v3, 161792
    v_mov_b32 v55, 160
    s_lshl_b32 s65, s26, 2
    s_waitcnt vmcnt(8)
    s_barrier
    buffer_load_dword v54, v55, s[44:47], s65 offen sc0 sc1
    s_mov_b32 exec_hi, 0xffffff
    s_and_b32 s3, s82, 15
    s_lshr_b32 s82, s82, 4
    s_mul_i32 s83, s3, 172032
    s_add_u32 s83, s83, s56
    s_add_u32 m0, s50, 61440
    s_nop 0
    buffer_load_dwordx4 v53, s[32:35], s83 offen  lds
    s_add_u32 m0, s50, 65024
    s_add_u32 s84, s83, 43008
    buffer_load_dwordx4 v53, s[32:35], s84 offen  lds
    s_and_b32 s3, s82, 15
    s_lshr_b32 s82, s82, 4
    s_mul_i32 s83, s3, 172032
    s_add_u32 s83, s83, s56
    s_add_u32 m0, s50, 68608
    s_nop 0
    buffer_load_dwordx4 v53, s[32:35], s83 offen  lds
    s_add_u32 m0, s50, 72192
    s_add_u32 s84, s83, 43008
    buffer_load_dwordx4 v53, s[32:35], s84 offen  lds
    s_and_b32 s3, s82, 15
    s_lshr_b32 s82, s82, 4
    s_mul_i32 s83, s3, 172032
    s_add_u32 s83, s83, s56
    s_add_u32 m0, s50, 75776
    s_nop 0
    buffer_load_dwordx4 v53, s[32:35], s83 offen  lds
    s_add_u32 m0, s50, 79360
    s_add_u32 s84, s83, 43008
    buffer_load_dwordx4 v53, s[32:35], s84 offen  lds
    s_and_b32 s3, s82, 15
    s_lshr_b32 s82, s82, 4
    s_mul_i32 s83, s3, 172032
    s_add_u32 s83, s83, s56
    s_add_u32 m0, s50, 82944
    s_nop 0
    buffer_load_dwordx4 v53, s[32:35], s83 offen  lds
    s_add_u32 m0, s50, 86528
    s_add_u32 s84, s83, 43008
    buffer_load_dwordx4 v53, s[32:35], s84 offen  lds
    s_mov_b32 exec_hi, -1
    s_waitcnt vmcnt(9)
    s_barrier
    s_setprio 3
    s_mov_b32 exec_hi, 0xffffff
    s_and_b32 s3, s82, 15
    s_lshr_b32 s82, s82, 4
    s_mul_i32 s83, s3, 172032
    s_add_u32 s83, s83, s56
    s_add_u32 m0, s50, 90112
    s_nop 0
    buffer_load_dwordx4 v53, s[32:35], s83 offen  lds
    s_add_u32 m0, s50, 93696
    s_add_u32 s84, s83, 43008
    buffer_load_dwordx4 v53, s[32:35], s84 offen  lds
    s_and_b32 s3, s82, 15
    s_lshr_b32 s82, s82, 4
    s_mul_i32 s83, s3, 172032
    s_add_u32 s83, s83, s56
    s_add_u32 m0, s50, 97280
    s_nop 0
    buffer_load_dwordx4 v53, s[32:35], s83 offen  lds
    s_add_u32 m0, s50, 100864
    s_add_u32 s84, s83, 43008
    buffer_load_dwordx4 v53, s[32:35], s84 offen  lds
    s_and_b32 s3, s82, 15
    s_lshr_b32 s82, s82, 4
    s_mul_i32 s83, s3, 172032
    s_add_u32 s83, s83, s56
    s_add_u32 m0, s50, 104448
    s_nop 0
    buffer_load_dwordx4 v53, s[32:35], s83 offen  lds
    s_add_u32 m0, s50, 108032
    s_add_u32 s84, s83, 43008
    buffer_load_dwordx4 v53, s[32:35], s84 offen  lds
    s_mov_b32 exec_hi, -1
    s_and_b32 s3, s48, 3
    s_and_b32 s27, s26, 1
    s_lshl2_add_u32 s3, s27, s3
    s_lshl_b32 s27, s3, 11
    s_add_u32 s80, s59, s27
    s_add_u32 s80, s80, 0x10000
    s_add_u32 s81, s80, 16384
    s_add_u32 s82, s80, 32768
    s_add_u32 s83, s80, 49152
    s_lshl3_add_u32 s3, s25, s3
    s_mul_i32 s87, s3, 28672
    s_mul_i32 s3, s24, 896
    s_add_u32 s87, s87, s3
    s_add_u32 s87, s87, s55
    s_mov_b32 s69, 0
    s_waitcnt vmcnt(14)
    s_branch Z1_157
ZL_155:
    buffer_load_dword v54, v55, s[44:47], s65 offen sc0 sc1
    s_waitcnt vmcnt(0)
Z1_157:
    v_readfirstlane_b32 s3, v54
    s_add_u32 s69, s69, 1
    s_nop 2
    s_cmp_eq_u32 s3, 1
    s_cbranch_scc1 ZD_156
    s_sleep 1
    s_cmp_gt_u32 s69, 0x40000
    s_cbranch_scc0 ZL_155
ZD_156:
    s_setprio 3
    s_waitcnt vmcnt(0)
    s_barrier
    ds_read_b128 v[124:127], v51 offset:0
    ds_read_b128 v[132:135], v51 offset:1024
    ds_read_b128 v[128:131], v51 offset:2048
    ds_read_b128 v[136:139], v51 offset:3072
    s_waitcnt lgkmcnt(1)
    v_pk_add_f32 v[124:125], v[124:125], v[128:129]
    v_pk_add_f32 v[126:127], v[126:127], v[130:131]
    s_waitcnt lgkmcnt(0)
    v_pk_add_f32 v[132:133], v[132:133], v[136:137]
    v_pk_add_f32 v[134:135], v[134:135], v[138:139]
    v_cvt_pk_f16_f32 v124, v124, v132
    v_cvt_pk_f16_f32 v125, v125, v133
    v_cvt_pk_f16_f32 v126, v126, v134
    v_cvt_pk_f16_f32 v127, v127, v135
    v_and_or_b32 v124, v124, v58, v59
    buffer_atomic_pk_add_f16 v124, v52, s[40:43], s57 offen offset:0 sc1
    v_and_or_b32 v125, v125, v58, v59
    buffer_atomic_pk_add_f16 v125, v52, s[40:43], s57 offen offset:64 sc1
    v_and_or_b32 v126, v126, v58, v59
    buffer_atomic_pk_add_f16 v126, v52, s[40:43], s57 offen offset:128 sc1
    v_and_or_b32 v127, v127, v58, v59
    buffer_atomic_pk_add_f16 v127, v52, s[40:43], s57 offen offset:192 sc1
    s_mov_b32 s86, 200704
    s_mov_b32 m0, 111616
    s_nop 0
    buffer_load_dwordx4 v44, s[36:39], s86 offen lds
    s_mov_b32 m0, 112640
    s_nop 0
    buffer_load_dwordx4 v45, s[36:39], s86 offen lds
    s_mov_b32 m0, 113664
    s_nop 0
    buffer_load_dwordx4 v46, s[36:39], s86 offen lds
    s_mov_b32 m0, 114688
    s_nop 0
    buffer_load_dwordx4 v47, s[36:39], s86 offen lds
    s_mov_b32 m0, 115712
    s_nop 0
    buffer_load_dwordx4 v48, s[36:39], s86 offen lds
    s_mov_b32 m0, 116736
    s_nop 0
    buffer_load_dwordx4 v49, s[36:39], s86 offen lds
    s_mov_b64 exec, 0xff
    s_mov_b32 m0, 117760
    s_nop 0
    buffer_load_dwordx4 v50, s[36:39], s86 offen lds
    s_mov_b64 exec, -1
    s_mov_b32 s86, 301056
    s_mov_b32 m0, 136704
    s_nop 0
    buffer_load_dwordx4 v44, s[36:39], s86 offen lds
    s_mov_b32 m0, 137728
    s_nop 0
    buffer_load_dwordx4 v45, s[36:39], s86 offen lds
    s_mov_b32 m0, 138752
    s_nop 0
    buffer_load_dwordx4 v46, s[36:39], s86 offen lds
    s_mov_b32 m0, 139776
    s_nop 0
    buffer_load_dwordx4 v47, s[36:39], s86 offen lds
    s_mov_b32 m0, 140800
    s_nop 0
    buffer_load_dwordx4 v48, s[36:39], s86 offen lds
    s_mov_b32 m0, 141824
    s_nop 0
    buffer_load_dwordx4 v49, s[36:39], s86 offen lds
    s_mov_b64 exec, 0xff
    s_mov_b32 m0, 142848
    s_nop 0
    buffer_load_dwordx4 v50, s[36:39], s86 offen lds
    s_mov_b64 exec, -1
    s_mov_b32 s86, 0
    s_mov_b32 m0, 16384
    s_nop 0
    buffer_load_dwordx4 v44, s[36:39], s86 offen lds
    s_mov_b32 m0, 17408
    s_nop 0
    buffer_load_dwordx4 v45, s[36:39], s86 offen lds
    s_mov_b32 m0, 18432
    s_nop 0
    buffer_load_dwordx4 v46, s[36:39], s86 offen lds
    s_mov_b32 m0, 19456
    s_nop 0
    buffer_load_dwordx4 v47, s[36:39], s86 offen lds
    s_mov_b32 s86, 50176
    s_mov_b32 m0, 30720
    s_nop 0
    buffer_load_dwordx4 v44, s[36:39], s86 offen lds
    s_mov_b32 m0, 31744
    s_nop 0
    buffer_load_dwordx4 v45, s[36:39], s86 offen lds
    s_mov_b32 m0, 32768
    s_nop 0
    buffer_load_dwordx4 v46, s[36:39], s86 offen lds
    buffer_load_dwordx4 v[140:143], v56, s[40:43], s57 offen sc0 sc1
    s_mov_b32 s86, 50176
    s_mov_b32 m0, 33792
    s_nop 0
    buffer_load_dwordx4 v47, s[36:39], s86 offen lds
    s_mov_b32 m0, 34816
    s_nop 0
    buffer_load_dwordx4 v48, s[36:39], s86 offen lds
    s_mov_b32 m0, 35840
    s_nop 0
    buffer_load_dwordx4 v49, s[36:39], s86 offen lds
    s_mov_b64 exec, 0xff
    s_mov_b32 m0, 36864
    s_nop 0
    buffer_load_dwordx4 v50, s[36:39], s86 offen lds
    s_mov_b64 exec, -1
    s_mov_b32 s86, 150528
    s_mov_b32 m0, 0
    s_nop 0
    buffer_load_dwordx4 v44, s[36:39], s86 offen lds
    s_mov_b32 m0, 1024
    s_nop 0
    buffer_load_dwordx4 v45, s[36:39], s86 offen lds
    s_mov_b32 m0, 2048
    s_nop 0
    buffer_load_dwordx4 v46, s[36:39], s86 offen lds
    s_mov_b32 m0, 3072
    s_nop 0
    buffer_load_dwordx4 v47, s[36:39], s86 offen lds
    s_mov_b32 s69, 0
    s_waitcnt vmcnt(8)
    s_branch KV1_160
KVL_158:
    s_sleep 4
    buffer_load_dwordx4 v[140:143], v56, s[40:43], s57 offen sc0 sc1
    s_add_u32 s69, s69, 1
    s_cmp_gt_u32 s69, 0x40000
    s_cbranch_scc1 KVD_159
    s_waitcnt vmcnt(0)
KV1_160:
    v_cndmask_b32 v13, v140, v143, s[4:5]
    v_bfe_u32 v13, v13, v64, 16
    v_cmp_eq_u32 vcc, 0x4c00, v13
    v_and_b32 v140, v140, v62
    v_and_b32 v141, v141, v62
    s_and_b64 s[14:15], vcc, s[6:7]
    v_and_b32 v142, v142, v63
    v_and_b32 v143, v143, v63
    s_cmp_eq_u64 s[14:15], s[6:7]
    s_cbranch_scc0 KVL_158
KVD_159:
    ds_write_b128 v57, v[140:143]
    s_waitcnt lgkmcnt(0)
    s_barrier
    s_setprio 0
    s_branch P2_AL
T_A1:
    v_and_b32 v5, 15, v2
    v_lshrrev_b32 v6, 4, v2
    v_lshlrev_b32 v3, 4, v2
    v_add_u32 v51, 4096, v3
    s_mul_i32 s3, s26, 4096
    s_add_u32 s57, s3, 0xa00400
    v_lshlrev_b32 v52, 8, v6
    v_lshl_add_u32 v52, v5, 2, v52
    v_cmp_gt_u32 s[66:67], 3, v6
    v_cmp_le_u32 s[18:19], 14, v5
    v_cmp_gt_u32 s[20:21], 2, v5
    v_mov_b32 v10, 0xffff
    v_mov_b32 v11, 0xffff0000
    v_cndmask_b32 v58, -1, v11, s[18:19]
    v_cndmask_b32 v58, v58, v10, s[20:21]
    v_mov_b32 v20, 0x3c003c00
    v_bfi_b32 v59, v58, 0, v20
    v_and_b32 v13, 3, v2
    v_lshrrev_b32 v14, 2, v2
    v_cmp_eq_u32 s[4:5], 3, v13
    v_cmp_eq_u32 s[8:9], 0, v13
    s_or_b64 s[6:7], s[8:9], s[4:5]
    v_cndmask_b32 v62, -1, v10, s[8:9]
    v_cndmask_b32 v63, -1, v11, s[4:5]
    v_cndmask_b32 v64, 16, 0, s[4:5]
    v_min_u32 v15, 12, v14
    v_lshlrev_b32 v15, 6, v15
    v_lshl_add_u32 v56, v13, 4, v15
    v_lshlrev_b32 v20, 4, v13
    v_add_u32 v20, 55808, v20
    v_add_u32 v13, 16, v14
    v_mul_u32_u24 v10, 37, v13
    v_lshrrev_b32 v10, 8, v10
    v_mul_u32_u24 v15, 7, v10
    v_sub_u32 v15, v13, v15
    v_lshrrev_b32 v21, 2, v15
    v_and_b32 v15, 3, v15
    v_lshl_add_u32 v15, v10, 2, v15
    v_lshl_add_u32 v15, v21, 4, v15
    v_lshlrev_b32 v21, 2, v14
    v_subrev_u32 v21, 29, v21
    v_cmp_lt_u32 vcc, 11, v14
    v_cndmask_b32 v15, v15, v21, vcc
    v_lshl_add_u32 v57, v15, 6, v20
    v_lshrrev_b32 v7, 4, v2
    v_lshrrev_b32 v3, 1, v7
    v_bfe_u32 v8, v2, 2, 2
    v_mul_u32_u24 v9, 14, v3
    v_and_b32 v4, 1, v7
    v_lshl_add_u32 v6, v4, 2, v9
    v_add_u32 v6, v6, v8
    v_mul_u32_u24 v5, 3, v4
    v_min_u32 v8, 2, v8
    v_add3_u32 v9, v9, v5, v8
    v_add_u32 v9, 8, v9
    v_and_b32 v5, 3, v2
    v_lshlrev_b32 v5, 3, v5
    v_add_u32 v5, 111616, v5
    v_mul_u32_u24 v8, 224, v6
    v_add_u32 v8, v8, v5
    v_mul_u32_u24 v9, 224, v9
    v_add_u32 v9, v9, v5
    v_lshlrev_b32 v6, 4, v2
    v_and_b32 v13, 15, v2
    v_lshrrev_b32 v15, 4, v2
    v_mul_u32_u24 v13, 1792, v13
    v_and_b32 v10, 1, v15
    v_lshl_add_u32 v14, v15, 3, v13
    v_lshl_add_u32 v10, v10, 5, v13
    v_lshrrev_b32 v15, 1, v15
    s_and_b32 s3, s48, 3
    v_lshl_add_u32 v10, v15, 4, v10
    s_lshl_b32 s27, s3, 3
    s_mul_i32 s3, s3, 7168
    s_add_u32 s27, s27, 161808
    s_add_u32 s3, s3, 61440
    v_mov_b32 v11, s27
    v_add_u32 v12, s3, v6
    v_mov_b32 v4, 1
    s_mov_b32 s78, 0
    s_mov_b32 s79, 15
    s_mov_b32 s68, 0x10000
    v_mov_b32 v3, 161792
    v_mov_b32 v55, 160
    s_lshl_b32 s65, s26, 2
    s_waitcnt vmcnt(8)
    s_barrier
    buffer_load_dword v54, v55, s[44:47], s65 offen sc0 sc1
    s_mov_b32 exec_hi, 0xffffff
    s_and_b32 s3, s82, 15
    s_lshr_b32 s82, s82, 4
    s_mul_i32 s83, s3, 172032
    s_add_u32 s83, s83, s56
    s_add_u32 m0, s50, 61440
    s_nop 0
    buffer_load_dwordx4 v53, s[32:35], s83 offen  lds
    s_add_u32 m0, s50, 65024
    s_add_u32 s84, s83, 43008
    buffer_load_dwordx4 v53, s[32:35], s84 offen  lds
    s_and_b32 s3, s82, 15
    s_lshr_b32 s82, s82, 4
    s_mul_i32 s83, s3, 172032
    s_add_u32 s83, s83, s56
    s_add_u32 m0, s50, 68608
    s_nop 0
    buffer_load_dwordx4 v53, s[32:35], s83 offen  lds
    s_add_u32 m0, s50, 72192
    s_add_u32 s84, s83, 43008
    buffer_load_dwordx4 v53, s[32:35], s84 offen  lds
    s_and_b32 s3, s82, 15
    s_lshr_b32 s82, s82, 4
    s_mul_i32 s83, s3, 172032
    s_add_u32 s83, s83, s56
    s_add_u32 m0, s50, 75776
    s_nop 0
    buffer_load_dwordx4 v53, s[32:35], s83 offen  lds
    s_add_u32 m0, s50, 79360
    s_add_u32 s84, s83, 43008
    buffer_load_dwordx4 v53, s[32:35], s84 offen  lds
    s_and_b32 s3, s82, 15
    s_lshr_b32 s82, s82, 4
    s_mul_i32 s83, s3, 172032
    s_add_u32 s83, s83, s56
    s_add_u32 m0, s50, 82944
    s_nop 0
    buffer_load_dwordx4 v53, s[32:35], s83 offen  lds
    s_add_u32 m0, s50, 86528
    s_add_u32 s84, s83, 43008
    buffer_load_dwordx4 v53, s[32:35], s84 offen  lds
    s_mov_b32 exec_hi, -1
    s_waitcnt vmcnt(9)
    s_barrier
    s_setprio 3
    s_mov_b32 exec_hi, 0xffffff
    s_and_b32 s3, s82, 15
    s_lshr_b32 s82, s82, 4
    s_mul_i32 s83, s3, 172032
    s_add_u32 s83, s83, s56
    s_add_u32 m0, s50, 90112
    s_nop 0
    buffer_load_dwordx4 v53, s[32:35], s83 offen  lds
    s_add_u32 m0, s50, 93696
    s_add_u32 s84, s83, 43008
    buffer_load_dwordx4 v53, s[32:35], s84 offen  lds
    s_and_b32 s3, s82, 15
    s_lshr_b32 s82, s82, 4
    s_mul_i32 s83, s3, 172032
    s_add_u32 s83, s83, s56
    s_add_u32 m0, s50, 97280
    s_nop 0
    buffer_load_dwordx4 v53, s[32:35], s83 offen  lds
    s_add_u32 m0, s50, 100864
    s_add_u32 s84, s83, 43008
    buffer_load_dwordx4 v53, s[32:35], s84 offen  lds
    s_and_b32 s3, s82, 15
    s_lshr_b32 s82, s82, 4
    s_mul_i32 s83, s3, 172032
    s_add_u32 s83, s83, s56
    s_add_u32 m0, s50, 104448
    s_nop 0
    buffer_load_dwordx4 v53, s[32:35], s83 offen  lds
    s_add_u32 m0, s50, 108032
    s_add_u32 s84, s83, 43008
    buffer_load_dwordx4 v53, s[32:35], s84 offen  lds
    s_mov_b32 exec_hi, -1
    s_and_b32 s3, s48, 3
    s_and_b32 s27, s26, 1
    s_lshl2_add_u32 s3, s27, s3
    s_lshl_b32 s27, s3, 11
    s_add_u32 s80, s59, s27
    s_add_u32 s80, s80, 0x10000
    s_add_u32 s81, s80, 16384
    s_add_u32 s82, s80, 32768
    s_add_u32 s83, s80, 49152
    s_lshl3_add_u32 s3, s25, s3
    s_mul_i32 s87, s3, 28672
    s_mul_i32 s3, s24, 896
    s_add_u32 s87, s87, s3
    s_add_u32 s87, s87, s55
    s_mov_b32 s69, 0
    s_waitcnt vmcnt(14)
    s_branch Z1_163
ZL_161:
    buffer_load_dword v54, v55, s[44:47], s65 offen sc0 sc1
    s_waitcnt vmcnt(0)
Z1_163:
    v_readfirstlane_b32 s3, v54
    s_add_u32 s69, s69, 1
    s_nop 2
    s_cmp_eq_u32 s3, 1
    s_cbranch_scc1 ZD_162
    s_sleep 1
    s_cmp_gt_u32 s69, 0x40000
    s_cbranch_scc0 ZL_161
ZD_162:
    s_setprio 3
    s_waitcnt vmcnt(0)
    s_barrier
    ds_read_b128 v[124:127], v51 offset:0
    ds_read_b128 v[132:135], v51 offset:1024
    ds_read_b128 v[128:131], v51 offset:2048
    ds_read_b128 v[136:139], v51 offset:3072
    s_waitcnt lgkmcnt(1)
    v_pk_add_f32 v[124:125], v[124:125], v[128:129]
    v_pk_add_f32 v[126:127], v[126:127], v[130:131]
    s_waitcnt lgkmcnt(0)
    v_pk_add_f32 v[132:133], v[132:133], v[136:137]
    v_pk_add_f32 v[134:135], v[134:135], v[138:139]
    v_cvt_pk_f16_f32 v124, v124, v132
    v_cvt_pk_f16_f32 v125, v125, v133
    v_cvt_pk_f16_f32 v126, v126, v134
    v_cvt_pk_f16_f32 v127, v127, v135
    v_and_or_b32 v124, v124, v58, v59
    buffer_atomic_pk_add_f16 v124, v52, s[40:43], s57 offen offset:0 sc1
    v_and_or_b32 v125, v125, v58, v59
    s_mov_b64 exec, s[66:67]
    buffer_atomic_pk_add_f16 v125, v52, s[40:43], s57 offen offset:64 sc1
    v_and_or_b32 v126, v126, v58, v59
    buffer_atomic_pk_add_f16 v126, v52, s[40:43], s57 offen offset:128 sc1
    v_and_or_b32 v127, v127, v58, v59
    buffer_atomic_pk_add_f16 v127, v52, s[40:43], s57 offen offset:192 sc1
    s_mov_b64 exec, -1
    s_mov_b32 s86, 225792
    s_mov_b32 m0, 117888
    s_nop 0
    buffer_load_dwordx4 v44, s[36:39], s86 offen lds
    s_mov_b32 m0, 118912
    s_nop 0
    buffer_load_dwordx4 v45, s[36:39], s86 offen lds
    s_mov_b32 m0, 119936
    s_nop 0
    buffer_load_dwordx4 v46, s[36:39], s86 offen lds
    s_mov_b32 m0, 120960
    s_nop 0
    buffer_load_dwordx4 v47, s[36:39], s86 offen lds
    s_mov_b32 m0, 121984
    s_nop 0
    buffer_load_dwordx4 v48, s[36:39], s86 offen lds
    s_mov_b32 m0, 123008
    s_nop 0
    buffer_load_dwordx4 v49, s[36:39], s86 offen lds
    s_mov_b64 exec, 0xff
    s_mov_b32 m0, 124032
    s_nop 0
    buffer_load_dwordx4 v50, s[36:39], s86 offen lds
    s_mov_b64 exec, -1
    s_mov_b32 s86, 326144
    s_mov_b32 m0, 142976
    s_nop 0
    buffer_load_dwordx4 v44, s[36:39], s86 offen lds
    s_mov_b32 m0, 144000
    s_nop 0
    buffer_load_dwordx4 v45, s[36:39], s86 offen lds
    s_mov_b32 m0, 145024
    s_nop 0
    buffer_load_dwordx4 v46, s[36:39], s86 offen lds
    s_mov_b32 m0, 146048
    s_nop 0
    buffer_load_dwordx4 v47, s[36:39], s86 offen lds
    s_mov_b32 m0, 147072
    s_nop 0
    buffer_load_dwordx4 v48, s[36:39], s86 offen lds
    s_mov_b32 m0, 148096
    s_nop 0
    buffer_load_dwordx4 v49, s[36:39], s86 offen lds
    s_mov_b64 exec, 0xff
    s_mov_b32 m0, 149120
    s_nop 0
    buffer_load_dwordx4 v50, s[36:39], s86 offen lds
    s_mov_b64 exec, -1
    s_mov_b32 s86, 0
    s_mov_b32 m0, 20480
    s_nop 0
    buffer_load_dwordx4 v48, s[36:39], s86 offen lds
    s_mov_b32 m0, 21504
    s_nop 0
    buffer_load_dwordx4 v49, s[36:39], s86 offen lds
    s_mov_b64 exec, 0xff
    s_mov_b32 m0, 22528
    s_nop 0
    buffer_load_dwordx4 v50, s[36:39], s86 offen lds
    s_mov_b64 exec, -1
    s_mov_b32 s86, 75264
    s_mov_b32 m0, 36992
    s_nop 0
    buffer_load_dwordx4 v44, s[36:39], s86 offen lds
    s_mov_b32 m0, 38016
    s_nop 0
    buffer_load_dwordx4 v45, s[36:39], s86 offen lds
    s_mov_b32 m0, 39040
    s_nop 0
    buffer_load_dwordx4 v46, s[36:39], s86 offen lds
    s_mov_b32 m0, 40064
    s_nop 0
    buffer_load_dwordx4 v47, s[36:39], s86 offen lds
    buffer_load_dwordx4 v[140:143], v56, s[40:43], s57 offen sc0 sc1
    s_mov_b32 s86, 75264
    s_mov_b32 m0, 41088
    s_nop 0
    buffer_load_dwordx4 v48, s[36:39], s86 offen lds
    s_mov_b32 m0, 42112
    s_nop 0
    buffer_load_dwordx4 v49, s[36:39], s86 offen lds
    s_mov_b64 exec, 0xff
    s_mov_b32 m0, 43136
    s_nop 0
    buffer_load_dwordx4 v50, s[36:39], s86 offen lds
    s_mov_b64 exec, -1
    s_mov_b32 s86, 150528
    s_mov_b32 m0, 4096
    s_nop 0
    buffer_load_dwordx4 v48, s[36:39], s86 offen lds
    s_mov_b32 m0, 5120
    s_nop 0
    buffer_load_dwordx4 v49, s[36:39], s86 offen lds
    s_mov_b64 exec, 0xff
    s_mov_b32 m0, 6144
    s_nop 0
    buffer_load_dwordx4 v50, s[36:39], s86 offen lds
    s_mov_b64 exec, -1
    s_mov_b32 s69, 0
    s_waitcnt vmcnt(6)
    s_branch KV1_166
KVL_164:
    s_sleep 4
    buffer_load_dwordx4 v[140:143], v56, s[40:43], s57 offen sc0 sc1
    s_add_u32 s69, s69, 1
    s_cmp_gt_u32 s69, 0x40000
    s_cbranch_scc1 KVD_165
    s_waitcnt vmcnt(0)
KV1_166:
    v_cndmask_b32 v13, v140, v143, s[4:5]
    v_bfe_u32 v13, v13, v64, 16
    v_cmp_eq_u32 vcc, 0x4c00, v13
    v_and_b32 v140, v140, v62
    v_and_b32 v141, v141, v62
    s_and_b64 s[14:15], vcc, s[6:7]
    v_and_b32 v142, v142, v63
    v_and_b32 v143, v143, v63
    s_cmp_eq_u64 s[14:15], s[6:7]
    s_cbranch_scc0 KVL_164
KVD_165:
    ds_write_b128 v57, v[140:143]
    s_waitcnt lgkmcnt(0)
    s_barrier
    s_setprio 0
    s_branch P2_AL
T_A2:
    v_and_b32 v5, 15, v2
    v_lshrrev_b32 v6, 4, v2
    v_lshlrev_b32 v3, 4, v2
    v_add_u32 v51, 8192, v3
    s_mul_i32 s3, s26, 4096
    s_add_u32 s57, s3, 0xa00800
    v_lshlrev_b32 v52, 8, v6
    v_lshl_add_u32 v52, v5, 2, v52
    v_cmp_gt_u32 s[66:67], 3, v6
    v_cmp_le_u32 s[18:19], 14, v5
    v_cmp_gt_u32 s[20:21], 2, v5
    v_mov_b32 v10, 0xffff
    v_mov_b32 v11, 0xffff0000
    v_cndmask_b32 v58, -1, v11, s[18:19]
    v_cndmask_b32 v58, v58, v10, s[20:21]
    v_mov_b32 v20, 0x3c003c00
    v_bfi_b32 v59, v58, 0, v20
    v_and_b32 v13, 3, v2
    v_lshrrev_b32 v14, 2, v2
    v_cmp_eq_u32 s[4:5], 3, v13
    v_cmp_eq_u32 s[8:9], 0, v13
    s_or_b64 s[6:7], s[8:9], s[4:5]
    v_cndmask_b32 v62, -1, v10, s[8:9]
    v_cndmask_b32 v63, -1, v11, s[4:5]
    v_cndmask_b32 v64, 16, 0, s[4:5]
    v_mov_b32 v56, v3
    v_lshlrev_b32 v20, 4, v13
    v_add_u32 v20, 57856, v20
    v_add_u32 v13, 0, v14
    v_mul_u32_u24 v10, 37, v13
    v_lshrrev_b32 v10, 8, v10
    v_mul_u32_u24 v15, 7, v10
    v_sub_u32 v15, v13, v15
    v_lshrrev_b32 v21, 2, v15
    v_and_b32 v15, 3, v15
    v_lshl_add_u32 v15, v10, 2, v15
    v_lshl_add_u32 v15, v21, 4, v15
    v_lshl_add_u32 v57, v15, 6, v20
    v_lshrrev_b32 v7, 4, v2
    v_lshrrev_b32 v3, 1, v7
    v_bfe_u32 v8, v2, 2, 2
    v_mul_u32_u24 v9, 14, v3
    v_and_b32 v4, 1, v7
    v_lshl_add_u32 v6, v4, 2, v9
    v_add_u32 v6, v6, v8
    v_mul_u32_u24 v5, 3, v4
    v_min_u32 v8, 2, v8
    v_add3_u32 v9, v9, v5, v8
    v_add_u32 v9, 8, v9
    v_and_b32 v5, 3, v2
    v_lshlrev_b32 v5, 3, v5
    v_add_u32 v5, 111616, v5
    v_mul_u32_u24 v8, 224, v6
    v_add_u32 v8, v8, v5
    v_mul_u32_u24 v9, 224, v9
    v_add_u32 v9, v9, v5
    v_lshlrev_b32 v6, 4, v2
    v_and_b32 v13, 15, v2
    v_lshrrev_b32 v15, 4, v2
    v_mul_u32_u24 v13, 1792, v13
    v_and_b32 v10, 1, v15
    v_lshl_add_u32 v14, v15, 3, v13
    v_lshl_add_u32 v10, v10, 5, v13
    v_lshrrev_b32 v15, 1, v15
    s_and_b32 s3, s48, 3
    v_lshl_add_u32 v10, v15, 4, v10
    s_lshl_b32 s27, s3, 3
    s_mul_i32 s3, s3, 7168
    s_add_u32 s27, s27, 161808
    s_add_u32 s3, s3, 61440
    v_mov_b32 v11, s27
    v_add_u32 v12, s3, v6
    v_mov_b32 v4, 1
    s_mov_b32 s78, 0
    s_mov_b32 s79, 15
    s_mov_b32 s68, 0x10000
    v_mov_b32 v3, 161792
    v_mov_b32 v55, 160
    s_lshl_b32 s65, s26, 2
    s_waitcnt vmcnt(8)
    s_barrier
    buffer_load_dword v54, v55, s[44:47], s65 offen sc0 sc1
    s_mov_b32 exec_hi, 0xffffff
    s_and_b32 s3, s82, 15
    s_lshr_b32 s82, s82, 4
    s_mul_i32 s83, s3, 172032
    s_add_u32 s83, s83, s56
    s_add_u32 m0, s50, 61440
    s_nop 0
    buffer_load_dwordx4 v53, s[32:35], s83 offen  lds
    s_add_u32 m0, s50, 65024
    s_add_u32 s84, s83, 43008
    buffer_load_dwordx4 v53, s[32:35], s84 offen  lds
    s_and_b32 s3, s82, 15
    s_lshr_b32 s82, s82, 4
    s_mul_i32 s83, s3, 172032
    s_add_u32 s83, s83, s56
    s_add_u32 m0, s50, 68608
    s_nop 0
    buffer_load_dwordx4 v53, s[32:35], s83 offen  lds
    s_add_u32 m0, s50, 72192
    s_add_u32 s84, s83, 43008
    buffer_load_dwordx4 v53, s[32:35], s84 offen  lds
    s_and_b32 s3, s82, 15
    s_lshr_b32 s82, s82, 4
    s_mul_i32 s83, s3, 172032
    s_add_u32 s83, s83, s56
    s_add_u32 m0, s50, 75776
    s_nop 0
    buffer_load_dwordx4 v53, s[32:35], s83 offen  lds
    s_add_u32 m0, s50, 79360
    s_add_u32 s84, s83, 43008
    buffer_load_dwordx4 v53, s[32:35], s84 offen  lds
    s_and_b32 s3, s82, 15
    s_lshr_b32 s82, s82, 4
    s_mul_i32 s83, s3, 172032
    s_add_u32 s83, s83, s56
    s_add_u32 m0, s50, 82944
    s_nop 0
    buffer_load_dwordx4 v53, s[32:35], s83 offen  lds
    s_add_u32 m0, s50, 86528
    s_add_u32 s84, s83, 43008
    buffer_load_dwordx4 v53, s[32:35], s84 offen  lds
    s_mov_b32 exec_hi, -1
    s_waitcnt vmcnt(9)
    s_barrier
    s_setprio 3
    s_mov_b32 exec_hi, 0xffffff
    s_and_b32 s3, s82, 15
    s_lshr_b32 s82, s82, 4
    s_mul_i32 s83, s3, 172032
    s_add_u32 s83, s83, s56
    s_add_u32 m0, s50, 90112
    s_nop 0
    buffer_load_dwordx4 v53, s[32:35], s83 offen  lds
    s_add_u32 m0, s50, 93696
    s_add_u32 s84, s83, 43008
    buffer_load_dwordx4 v53, s[32:35], s84 offen  lds
    s_and_b32 s3, s82, 15
    s_lshr_b32 s82, s82, 4
    s_mul_i32 s83, s3, 172032
    s_add_u32 s83, s83, s56
    s_add_u32 m0, s50, 97280
    s_nop 0
    buffer_load_dwordx4 v53, s[32:35], s83 offen  lds
    s_add_u32 m0, s50, 100864
    s_add_u32 s84, s83, 43008
    buffer_load_dwordx4 v53, s[32:35], s84 offen  lds
    s_and_b32 s3, s82, 15
    s_lshr_b32 s82, s82, 4
    s_mul_i32 s83, s3, 172032
    s_add_u32 s83, s83, s56
    s_add_u32 m0, s50, 104448
    s_nop 0
    buffer_load_dwordx4 v53, s[32:35], s83 offen  lds
    s_add_u32 m0, s50, 108032
    s_add_u32 s84, s83, 43008
    buffer_load_dwordx4 v53, s[32:35], s84 offen  lds
    s_mov_b32 exec_hi, -1
    s_and_b32 s3, s48, 3
    s_and_b32 s27, s26, 1
    s_lshl2_add_u32 s3, s27, s3
    s_lshl_b32 s27, s3, 11
    s_add_u32 s80, s59, s27
    s_add_u32 s80, s80, 0x10000
    s_add_u32 s81, s80, 16384
    s_add_u32 s82, s80, 32768
    s_add_u32 s83, s80, 49152
    s_lshl3_add_u32 s3, s25, s3
    s_mul_i32 s87, s3, 28672
    s_mul_i32 s3, s24, 896
    s_add_u32 s87, s87, s3
    s_add_u32 s87, s87, s55
    s_mov_b32 s69, 0
    s_waitcnt vmcnt(14)
    s_branch Z1_169
ZL_167:
    buffer_load_dword v54, v55, s[44:47], s65 offen sc0 sc1
    s_waitcnt vmcnt(0)
Z1_169:
    v_readfirstlane_b32 s3, v54
    s_add_u32 s69, s69, 1
    s_nop 2
    s_cmp_eq_u32 s3, 1
    s_cbranch_scc1 ZD_168
    s_sleep 1
    s_cmp_gt_u32 s69, 0x40000
    s_cbranch_scc0 ZL_167
ZD_168:
    s_setprio 3
    s_waitcnt vmcnt(0)
    s_barrier
    ds_read_b128 v[124:127], v51 offset:0
    ds_read_b128 v[132:135], v51 offset:1024
    ds_read_b128 v[128:131], v51 offset:2048
    ds_read_b128 v[136:139], v51 offset:3072
    s_waitcnt lgkmcnt(1)
    v_pk_add_f32 v[124:125], v[124:125], v[128:129]
    v_pk_add_f32 v[126:127], v[126:127], v[130:131]
    s_waitcnt lgkmcnt(0)
    v_pk_add_f32 v[132:133], v[132:133], v[136:137]
    v_pk_add_f32 v[134:135], v[134:135], v[138:139]
    v_cvt_pk_f16_f32 v124, v124, v132
    v_cvt_pk_f16_f32 v125, v125, v133
    v_cvt_pk_f16_f32 v126, v126, v134
    v_cvt_pk_f16_f32 v127, v127, v135
    v_and_or_b32 v124, v124, v58, v59
    buffer_atomic_pk_add_f16 v124, v52, s[40:43], s57 offen offset:0 sc1
    v_and_or_b32 v125, v125, v58, v59
    buffer_atomic_pk_add_f16 v125, v52, s[40:43], s57 offen offset:64 sc1
    v_and_or_b32 v126, v126, v58, v59
    buffer_atomic_pk_add_f16 v126, v52, s[40:43], s57 offen offset:128 sc1
    v_and_or_b32 v127, v127, v58, v59
    buffer_atomic_pk_add_f16 v127, v52, s[40:43], s57 offen offset:192 sc1
    s_mov_b32 s86, 250880
    s_mov_b32 m0, 124160
    s_nop 0
    buffer_load_dwordx4 v44, s[36:39], s86 offen lds
    s_mov_b32 m0, 125184
    s_nop 0
    buffer_load_dwordx4 v45, s[36:39], s86 offen lds
    s_mov_b32 m0, 126208
    s_nop 0
    buffer_load_dwordx4 v46, s[36:39], s86 offen lds
    s_mov_b32 m0, 127232
    s_nop 0
    buffer_load_dwordx4 v47, s[36:39], s86 offen lds
    s_mov_b32 m0, 128256
    s_nop 0
    buffer_load_dwordx4 v48, s[36:39], s86 offen lds
    s_mov_b32 m0, 129280
    s_nop 0
    buffer_load_dwordx4 v49, s[36:39], s86 offen lds
    s_mov_b64 exec, 0xff
    s_mov_b32 m0, 130304
    s_nop 0
    buffer_load_dwordx4 v50, s[36:39], s86 offen lds
    s_mov_b64 exec, -1
    s_mov_b32 s86, 351232
    s_mov_b32 m0, 149248
    s_nop 0
    buffer_load_dwordx4 v44, s[36:39], s86 offen lds
    s_mov_b32 m0, 150272
    s_nop 0
    buffer_load_dwordx4 v45, s[36:39], s86 offen lds
    s_mov_b32 m0, 151296
    s_nop 0
    buffer_load_dwordx4 v46, s[36:39], s86 offen lds
    s_mov_b32 m0, 152320
    s_nop 0
    buffer_load_dwordx4 v47, s[36:39], s86 offen lds
    s_mov_b32 m0, 153344
    s_nop 0
    buffer_load_dwordx4 v48, s[36:39], s86 offen lds
    s_mov_b32 m0, 154368
    s_nop 0
    buffer_load_dwordx4 v49, s[36:39], s86 offen lds
    s_mov_b64 exec, 0xff
    s_mov_b32 m0, 155392
    s_nop 0
    buffer_load_dwordx4 v50, s[36:39], s86 offen lds
    s_mov_b64 exec, -1
    s_mov_b32 s86, 25088
    s_mov_b32 m0, 22656
    s_nop 0
    buffer_load_dwordx4 v44, s[36:39], s86 offen lds
    s_mov_b32 m0, 23680
    s_nop 0
    buffer_load_dwordx4 v45, s[36:39], s86 offen lds
    s_mov_b32 m0, 24704
    s_nop 0
    buffer_load_dwordx4 v46, s[36:39], s86 offen lds
    s_mov_b32 m0, 25728
    s_nop 0
    buffer_load_dwordx4 v47, s[36:39], s86 offen lds
    s_mov_b32 s86, 100352
    s_mov_b32 m0, 43264
    s_nop 0
    buffer_load_dwordx4 v44, s[36:39], s86 offen lds
    s_mov_b32 m0, 44288
    s_nop 0
    buffer_load_dwordx4 v45, s[36:39], s86 offen lds
    s_mov_b32 m0, 45312
    s_nop 0
    buffer_load_dwordx4 v46, s[36:39], s86 offen lds
    buffer_load_dwordx4 v[140:143], v56, s[40:43], s57 offen sc0 sc1
    s_mov_b32 s86, 100352
    s_mov_b32 m0, 46336
    s_nop 0
    buffer_load_dwordx4 v47, s[36:39], s86 offen lds
    s_mov_b32 m0, 47360
    s_nop 0
    buffer_load_dwordx4 v48, s[36:39], s86 offen lds
    s_mov_b32 m0, 48384
    s_nop 0
    buffer_load_dwordx4 v49, s[36:39], s86 offen lds
    s_mov_b64 exec, 0xff
    s_mov_b32 m0, 49408
    s_nop 0
    buffer_load_dwordx4 v50, s[36:39], s86 offen lds
    s_mov_b64 exec, -1
    s_mov_b32 s86, 175616
    s_mov_b32 m0, 8192
    s_nop 0
    buffer_load_dwordx4 v44, s[36:39], s86 offen lds
    s_mov_b32 m0, 9216
    s_nop 0
    buffer_load_dwordx4 v45, s[36:39], s86 offen lds
    s_mov_b32 m0, 10240
    s_nop 0
    buffer_load_dwordx4 v46, s[36:39], s86 offen lds
    s_mov_b32 m0, 11264
    s_nop 0
    buffer_load_dwordx4 v47, s[36:39], s86 offen lds
    s_mov_b32 s69, 0
    s_waitcnt vmcnt(8)
    s_branch KV1_172
KVL_170:
    s_sleep 4
    buffer_load_dwordx4 v[140:143], v56, s[40:43], s57 offen sc0 sc1
    s_add_u32 s69, s69, 1
    s_cmp_gt_u32 s69, 0x40000
    s_cbranch_scc1 KVD_171
    s_waitcnt vmcnt(0)
KV1_172:
    v_cndmask_b32 v13, v140, v143, s[4:5]
    v_bfe_u32 v13, v13, v64, 16
    v_cmp_eq_u32 vcc, 0x4c00, v13
    v_and_b32 v140, v140, v62
    v_and_b32 v141, v141, v62
    s_and_b64 s[14:15], vcc, s[6:7]
    v_and_b32 v142, v142, v63
    v_and_b32 v143, v143, v63
    s_cmp_eq_u64 s[14:15], s[6:7]
    s_cbranch_scc0 KVL_170
KVD_171:
    ds_write_b128 v57, v[140:143]
    s_waitcnt lgkmcnt(0)
    s_barrier
    s_setprio 0
    s_branch P2_AL
T_A3:
    v_and_b32 v5, 15, v2
    v_lshrrev_b32 v6, 4, v2
    v_lshlrev_b32 v3, 4, v2
    v_add_u32 v51, 12288, v3
    s_mul_i32 s3, s26, 4096
    s_add_u32 s57, s3, 0xa00c00
    v_lshlrev_b32 v52, 8, v6
    v_lshl_add_u32 v52, v5, 2, v52
    v_cmp_gt_u32 s[66:67], 3, v6
    v_cmp_le_u32 s[18:19], 14, v5
    v_cmp_gt_u32 s[20:21], 2, v5
    v_mov_b32 v10, 0xffff
    v_mov_b32 v11, 0xffff0000
    v_cndmask_b32 v58, -1, v11, s[18:19]
    v_cndmask_b32 v58, v58, v10, s[20:21]
    v_mov_b32 v20, 0x3c003c00
    v_bfi_b32 v59, v58, 0, v20
    v_and_b32 v13, 3, v2
    v_lshrrev_b32 v14, 2, v2
    v_cmp_eq_u32 s[4:5], 3, v13
    v_cmp_eq_u32 s[8:9], 0, v13
    s_or_b64 s[6:7], s[8:9], s[4:5]
    v_cndmask_b32 v62, -1, v10, s[8:9]
    v_cndmask_b32 v63, -1, v11, s[4:5]
    v_cndmask_b32 v64, 16, 0, s[4:5]
    v_min_u32 v15, 12, v14
    v_lshlrev_b32 v15, 6, v15
    v_lshl_add_u32 v56, v13, 4, v15
    v_lshlrev_b32 v20, 4, v13
    v_add_u32 v20, 57856, v20
    v_add_u32 v13, 16, v14
    v_mul_u32_u24 v10, 37, v13
    v_lshrrev_b32 v10, 8, v10
    v_mul_u32_u24 v15, 7, v10
    v_sub_u32 v15, v13, v15
    v_lshrrev_b32 v21, 2, v15
    v_and_b32 v15, 3, v15
    v_lshl_add_u32 v15, v10, 2, v15
    v_lshl_add_u32 v15, v21, 4, v15
    v_lshlrev_b32 v21, 2, v14
    v_subrev_u32 v21, 29, v21
    v_cmp_lt_u32 vcc, 11, v14
    v_cndmask_b32 v15, v15, v21, vcc
    v_lshl_add_u32 v57, v15, 6, v20
    v_lshrrev_b32 v7, 4, v2
    v_lshrrev_b32 v3, 1, v7
    v_bfe_u32 v8, v2, 2, 2
    v_mul_u32_u24 v9, 14, v3
    v_and_b32 v4, 1, v7
    v_lshl_add_u32 v6, v4, 2, v9
    v_add_u32 v6, v6, v8
    v_mul_u32_u24 v5, 3, v4
    v_min_u32 v8, 2, v8
    v_add3_u32 v9, v9, v5, v8
    v_add_u32 v9, 8, v9
    v_and_b32 v5, 3, v2
    v_lshlrev_b32 v5, 3, v5
    v_add_u32 v5, 111616, v5
    v_mul_u32_u24 v8, 224, v6
    v_add_u32 v8, v8, v5
    v_mul_u32_u24 v9, 224, v9
    v_add_u32 v9, v9, v5
    v_lshlrev_b32 v6, 4, v2
    v_and_b32 v13, 15, v2
    v_lshrrev_b32 v15, 4, v2
    v_mul_u32_u24 v13, 1792, v13
    v_and_b32 v10, 1, v15
    v_lshl_add_u32 v14, v15, 3, v13
    v_lshl_add_u32 v10, v10, 5, v13
    v_lshrrev_b32 v15, 1, v15
    s_and_b32 s3, s48, 3
    v_lshl_add_u32 v10, v15, 4, v10
    s_lshl_b32 s27, s3, 3
    s_mul_i32 s3, s3, 7168
    s_add_u32 s27, s27, 161808
    s_add_u32 s3, s3, 61440
    v_mov_b32 v11, s27
    v_add_u32 v12, s3, v6
    v_mov_b32 v4, 1
    s_mov_b32 s78, 0
    s_mov_b32 s79, 15
    s_mov_b32 s68, 0x10000
    v_mov_b32 v3, 161792
    v_mov_b32 v55, 160
    s_lshl_b32 s65, s26, 2
    s_waitcnt vmcnt(8)
    s_barrier
    buffer_load_dword v54, v55, s[44:47], s65 offen sc0 sc1
    s_mov_b32 exec_hi, 0xffffff
    s_and_b32 s3, s82, 15
    s_lshr_b32 s82, s82, 4
    s_mul_i32 s83, s3, 172032
    s_add_u32 s83, s83, s56
    s_add_u32 m0, s50, 61440
    s_nop 0
    buffer_load_dwordx4 v53, s[32:35], s83 offen  lds
    s_add_u32 m0, s50, 65024
    s_add_u32 s84, s83, 43008
    buffer_load_dwordx4 v53, s[32:35], s84 offen  lds
    s_and_b32 s3, s82, 15
    s_lshr_b32 s82, s82, 4
    s_mul_i32 s83, s3, 172032
    s_add_u32 s83, s83, s56
    s_add_u32 m0, s50, 68608
    s_nop 0
    buffer_load_dwordx4 v53, s[32:35], s83 offen  lds
    s_add_u32 m0, s50, 72192
    s_add_u32 s84, s83, 43008
    buffer_load_dwordx4 v53, s[32:35], s84 offen  lds
    s_and_b32 s3, s82, 15
    s_lshr_b32 s82, s82, 4
    s_mul_i32 s83, s3, 172032
    s_add_u32 s83, s83, s56
    s_add_u32 m0, s50, 75776
    s_nop 0
    buffer_load_dwordx4 v53, s[32:35], s83 offen  lds
    s_add_u32 m0, s50, 79360
    s_add_u32 s84, s83, 43008
    buffer_load_dwordx4 v53, s[32:35], s84 offen  lds
    s_and_b32 s3, s82, 15
    s_lshr_b32 s82, s82, 4
    s_mul_i32 s83, s3, 172032
    s_add_u32 s83, s83, s56
    s_add_u32 m0, s50, 82944
    s_nop 0
    buffer_load_dwordx4 v53, s[32:35], s83 offen  lds
    s_add_u32 m0, s50, 86528
    s_add_u32 s84, s83, 43008
    buffer_load_dwordx4 v53, s[32:35], s84 offen  lds
    s_mov_b32 exec_hi, -1
    s_waitcnt vmcnt(9)
    s_barrier
    s_setprio 3
    s_mov_b32 exec_hi, 0xffffff
    s_and_b32 s3, s82, 15
    s_lshr_b32 s82, s82, 4
    s_mul_i32 s83, s3, 172032
    s_add_u32 s83, s83, s56
    s_add_u32 m0, s50, 90112
    s_nop 0
    buffer_load_dwordx4 v53, s[32:35], s83 offen  lds
    s_add_u32 m0, s50, 93696
    s_add_u32 s84, s83, 43008
    buffer_load_dwordx4 v53, s[32:35], s84 offen  lds
    s_and_b32 s3, s82, 15
    s_lshr_b32 s82, s82, 4
    s_mul_i32 s83, s3, 172032
    s_add_u32 s83, s83, s56
    s_add_u32 m0, s50, 97280
    s_nop 0
    buffer_load_dwordx4 v53, s[32:35], s83 offen  lds
    s_add_u32 m0, s50, 100864
    s_add_u32 s84, s83, 43008
    buffer_load_dwordx4 v53, s[32:35], s84 offen  lds
    s_and_b32 s3, s82, 15
    s_lshr_b32 s82, s82, 4
    s_mul_i32 s83, s3, 172032
    s_add_u32 s83, s83, s56
    s_add_u32 m0, s50, 104448
    s_nop 0
    buffer_load_dwordx4 v53, s[32:35], s83 offen  lds
    s_add_u32 m0, s50, 108032
    s_add_u32 s84, s83, 43008
    buffer_load_dwordx4 v53, s[32:35], s84 offen  lds
    s_mov_b32 exec_hi, -1
    s_and_b32 s3, s48, 3
    s_and_b32 s27, s26, 1
    s_lshl2_add_u32 s3, s27, s3
    s_lshl_b32 s27, s3, 11
    s_add_u32 s80, s59, s27
    s_add_u32 s80, s80, 0x10000
    s_add_u32 s81, s80, 16384
    s_add_u32 s82, s80, 32768
    s_add_u32 s83, s80, 49152
    s_lshl3_add_u32 s3, s25, s3
    s_mul_i32 s87, s3, 28672
    s_mul_i32 s3, s24, 896
    s_add_u32 s87, s87, s3
    s_add_u32 s87, s87, s55
    s_mov_b32 s69, 0
    s_waitcnt vmcnt(14)
    s_branch Z1_175
ZL_173:
    buffer_load_dword v54, v55, s[44:47], s65 offen sc0 sc1
    s_waitcnt vmcnt(0)
Z1_175:
    v_readfirstlane_b32 s3, v54
    s_add_u32 s69, s69, 1
    s_nop 2
    s_cmp_eq_u32 s3, 1
    s_cbranch_scc1 ZD_174
    s_sleep 1
    s_cmp_gt_u32 s69, 0x40000
    s_cbranch_scc0 ZL_173
ZD_174:
    s_setprio 3
    s_waitcnt vmcnt(0)
    s_barrier
    ds_read_b128 v[124:127], v51 offset:0
    ds_read_b128 v[132:135], v51 offset:1024
    ds_read_b128 v[128:131], v51 offset:2048
    ds_read_b128 v[136:139], v51 offset:3072
    s_waitcnt lgkmcnt(1)
    v_pk_add_f32 v[124:125], v[124:125], v[128:129]
    v_pk_add_f32 v[126:127], v[126:127], v[130:131]
    s_waitcnt lgkmcnt(0)
    v_pk_add_f32 v[132:133], v[132:133], v[136:137]
    v_pk_add_f32 v[134:135], v[134:135], v[138:139]
    v_cvt_pk_f16_f32 v124, v124, v132
    v_cvt_pk_f16_f32 v125, v125, v133
    v_cvt_pk_f16_f32 v126, v126, v134
    v_cvt_pk_f16_f32 v127, v127, v135
    v_and_or_b32 v124, v124, v58, v59
    buffer_atomic_pk_add_f16 v124, v52, s[40:43], s57 offen offset:0 sc1
    v_and_or_b32 v125, v125, v58, v59
    s_mov_b64 exec, s[66:67]
    buffer_atomic_pk_add_f16 v125, v52, s[40:43], s57 offen offset:64 sc1
    v_and_or_b32 v126, v126, v58, v59
    buffer_atomic_pk_add_f16 v126, v52, s[40:43], s57 offen offset:128 sc1
    v_and_or_b32 v127, v127, v58, v59
    buffer_atomic_pk_add_f16 v127, v52, s[40:43], s57 offen offset:192 sc1
    s_mov_b64 exec, -1
    s_mov_b32 s86, 275968
    s_mov_b32 m0, 130432
    s_nop 0
    buffer_load_dwordx4 v44, s[36:39], s86 offen lds
    s_mov_b32 m0, 131456
    s_nop 0
    buffer_load_dwordx4 v45, s[36:39], s86 offen lds
    s_mov_b32 m0, 132480
    s_nop 0
    buffer_load_dwordx4 v46, s[36:39], s86 offen lds
    s_mov_b32 m0, 133504
    s_nop 0
    buffer_load_dwordx4 v47, s[36:39], s86 offen lds
    s_mov_b32 m0, 134528
    s_nop 0
    buffer_load_dwordx4 v48, s[36:39], s86 offen lds
    s_mov_b32 m0, 135552
    s_nop 0
    buffer_load_dwordx4 v49, s[36:39], s86 offen lds
    s_mov_b64 exec, 0xff
    s_mov_b32 m0, 136576
    s_nop 0
    buffer_load_dwordx4 v50, s[36:39], s86 offen lds
    s_mov_b64 exec, -1
    s_mov_b32 s86, 376320
    s_mov_b32 m0, 155520
    s_nop 0
    buffer_load_dwordx4 v44, s[36:39], s86 offen lds
    s_mov_b32 m0, 156544
    s_nop 0
    buffer_load_dwordx4 v45, s[36:39], s86 offen lds
    s_mov_b32 m0, 157568
    s_nop 0
    buffer_load_dwordx4 v46, s[36:39], s86 offen lds
    s_mov_b32 m0, 158592
    s_nop 0
    buffer_load_dwordx4 v47, s[36:39], s86 offen lds
    s_mov_b32 m0, 159616
    s_nop 0
    buffer_load_dwordx4 v48, s[36:39], s86 offen lds
    s_mov_b32 m0, 160640
    s_nop 0
    buffer_load_dwordx4 v49, s[36:39], s86 offen lds
    s_mov_b64 exec, 0xff
    s_mov_b32 m0, 161664
    s_nop 0
    buffer_load_dwordx4 v50, s[36:39], s86 offen lds
    s_mov_b64 exec, -1
    s_mov_b32 s86, 25088
    s_mov_b32 m0, 26752
    s_nop 0
    buffer_load_dwordx4 v48, s[36:39], s86 offen lds
    s_mov_b32 m0, 27776
    s_nop 0
    buffer_load_dwordx4 v49, s[36:39], s86 offen lds
    s_mov_b64 exec, 0xff
    s_mov_b32 m0, 28800
    s_nop 0
    buffer_load_dwordx4 v50, s[36:39], s86 offen lds
    s_mov_b64 exec, -1
    s_mov_b32 s86, 125440
    s_mov_b32 m0, 49536
    s_nop 0
    buffer_load_dwordx4 v44, s[36:39], s86 offen lds
    s_mov_b32 m0, 50560
    s_nop 0
    buffer_load_dwordx4 v45, s[36:39], s86 offen lds
    s_mov_b32 m0, 51584
    s_nop 0
    buffer_load_dwordx4 v46, s[36:39], s86 offen lds
    s_mov_b32 m0, 52608
    s_nop 0
    buffer_load_dwordx4 v47, s[36:39], s86 offen lds
    buffer_load_dwordx4 v[140:143], v56, s[40:43], s57 offen sc0 sc1
    s_mov_b32 s86, 125440
    s_mov_b32 m0, 53632
    s_nop 0
    buffer_load_dwordx4 v48, s[36:39], s86 offen lds
    s_mov_b32 m0, 54656
    s_nop 0
    buffer_load_dwordx4 v49, s[36:39], s86 offen lds
    s_mov_b64 exec, 0xff
    s_mov_b32 m0, 55680
    s_nop 0
    buffer_load_dwordx4 v50, s[36:39], s86 offen lds
    s_mov_b64 exec, -1
    s_mov_b32 s86, 175616
    s_mov_b32 m0, 12288
    s_nop 0
    buffer_load_dwordx4 v48, s[36:39], s86 offen lds
    s_mov_b32 m0, 13312
    s_nop 0
    buffer_load_dwordx4 v49, s[36:39], s86 offen lds
    s_mov_b64 exec, 0xff
    s_mov_b32 m0, 14336
    s_nop 0
    buffer_load_dwordx4 v50, s[36:39], s86 offen lds
    s_mov_b64 exec, -1
    s_mov_b32 s69, 0
    s_waitcnt vmcnt(6)
    s_branch KV1_178
KVL_176:
    s_sleep 4
    buffer_load_dwordx4 v[140:143], v56, s[40:43], s57 offen sc0 sc1
    s_add_u32 s69, s69, 1
    s_cmp_gt_u32 s69, 0x40000
    s_cbranch_scc1 KVD_177
    s_waitcnt vmcnt(0)
KV1_178:
    v_cndmask_b32 v13, v140, v143, s[4:5]
    v_bfe_u32 v13, v13, v64, 16
    v_cmp_eq_u32 vcc, 0x4c00, v13
    v_and_b32 v140, v140, v62
    v_and_b32 v141, v141, v62
    s_and_b64 s[14:15], vcc, s[6:7]
    v_and_b32 v142, v142, v63
    v_and_b32 v143, v143, v63
    s_cmp_eq_u64 s[14:15], s[6:7]
    s_cbranch_scc0 KVL_176
KVD_177:
    ds_write_b128 v57, v[140:143]
    s_waitcnt lgkmcnt(0)
    s_barrier
    s_setprio 0
    s_branch P2_AL
K_END:
    s_endpgm
.section .rodata,"a"
.p2align 6
.amdhsa_kernel concat_heads__linear_attn_block__sliding_local_dilated__prompt_kernel
  .amdhsa_next_free_vgpr 256
  .amdhsa_next_free_sgpr 96
  .amdhsa_accum_offset 144
  .amdhsa_group_segment_fixed_size 0
  .amdhsa_kernarg_size 72
  .amdhsa_user_sgpr_count 2
  .amdhsa_user_sgpr_kernarg_segment_ptr 1
  .amdhsa_system_sgpr_workgroup_id_x 1
.end_amdhsa_kernel
```
